```python
import torch

def _softmax(x, axis=-1):
    return torch.softmax(x, dim=axis)
def _gelu(x):
    return torch.nn.functional.gelu(x, approximate="tanh")
def _silu(x):
    return torch.nn.functional.silu(x)
def _sigmoid(x):
    return torch.sigmoid(x)
def _layernorm(x, axis=-1, eps=1e-5):
    m = x.mean(dim=axis, keepdim=True)
    v = x.var(dim=axis, keepdim=True, unbiased=False)
    return (x - m) / torch.sqrt(v + eps)
def _scatter_add(tgt, idx, src, axis=0):
    return tgt.clone().index_add_(axis, idx, src)
def _segment_sum(src, seg, n):
    out = torch.zeros((n,) + src.shape[1:], dtype=src.dtype)
    return out.index_add_(0, seg, src)
def _pad(x, pw):
    flat = tuple(v for pair in reversed(pw) for v in pair)
    return torch.nn.functional.pad(x, flat)

kernel_name = 'gated_mix__grouped_kv_mqa__mha_block__prompt'

def setup_inputs():

    _w = (lambda a: (lambda t: t.to(torch.bfloat16) if t.is_floating_point() else t)(torch.as_tensor(a)))
    def _A_setup():
        B, S, D, H = 1, 2048, 512, 32
        Dh = D // H
        return {
            "x": _w((lambda *s: torch.randn(*s, dtype=torch.bfloat16) * 0.05)(B, S, D)),
            "wq": _w((lambda *s: torch.randn(*s, dtype=torch.bfloat16) * 1.6)(D, H * Dh)),
            "wk": _w((lambda *s: torch.randn(*s, dtype=torch.bfloat16) * 1.6)(D, Dh)),
            "wv": _w((lambda *s: torch.randn(*s, dtype=torch.bfloat16) * 0.8)(D, Dh)),
            "wo": _w((lambda *s: torch.randn(*s, dtype=torch.bfloat16) * 0.8)(H * Dh, D)),
        }
    _A_in = _A_setup()

    def _B_setup():
        B, S, D, H = 1, 2048, 512, 32
        return {
            "x": _w((lambda *s: torch.randn(*s, dtype=torch.bfloat16) * 0.05)(B, S, D)),
            "wqkv": _w((lambda *s: torch.randn(*s, dtype=torch.bfloat16) * 3.2)(D, 3 * D)),
            "wo": _w((lambda *s: torch.randn(*s, dtype=torch.bfloat16) * 0.05)(D, D)),
        }
    _B_in = _B_setup()

    return {
        "A_x": _A_in["x"],
        "A_wq": _A_in["wq"],
        "A_wk": _A_in["wk"],
        "A_wv": _A_in["wv"],
        "A_wo": _A_in["wo"],
        "B_x": _B_in["x"],
        "B_wqkv": _B_in["wqkv"],
        "B_wo": _B_in["wo"],
        "gate_w": _w((lambda *s: torch.randn(*s, dtype=torch.bfloat16) * 0.1)(512) * 16.0),
    }

def reference(A_x, A_wq, A_wk, A_wv, A_wo, B_x, B_wqkv, B_wo, gate_w):
    def _A_ref(x, wq, wk, wv, wo):
        B, S, D = x.shape
        H = 32
        Dh = D // H
        q = (lambda x, *d: x.permute(*d))((x @ wq).reshape(B, S, H, Dh), 0, 2, 1, 3)
        k = x @ wk
        v = x @ wv
        scores = torch.einsum("bhqd,bkd->bhqk", q, k) * (Dh ** -0.5)
        p = _softmax(scores, axis=-1)
        o = torch.einsum("bhqk,bkd->bhqd", p, v)
        return (lambda x, *d: x.permute(*d))(o, 0, 2, 1, 3).reshape(B, S, H * Dh) @ wo

    def _B_ref(x, wqkv, wo):
        B, S, D = x.shape
        H = 32
        Dh = D // H
        qkv = (lambda x, *d: x.permute(*d))((x @ wqkv).reshape(B, S, 3, H, Dh), 2, 0, 3, 1, 4)
        q, k, v = qkv[0], qkv[1], qkv[2]
        scores = torch.einsum("bhqd,bhkd->bhqk", q, k) * (Dh ** -0.5)
        p = _softmax(scores, axis=-1)
        o = torch.einsum("bhqk,bhkd->bhqd", p, v)
        return (lambda x, *d: x.permute(*d))(o, 0, 2, 1, 3).reshape(B, S, D) @ wo

    x = A_x
    g = _sigmoid((x * gate_w).sum(-1, keepdims=True))
    a = _A_ref(x, A_wq, A_wk, A_wv, A_wo)
    b = _B_ref(x, B_wqkv, B_wo)
    return g * a + (1 - g) * b
```

```asm
; @launch kernel=proj_kernel grid=(256,1,1) block=(512,1,1) lds=147456
; @launch kernel=attn_kernel grid=(256,1,1) block=(512,1,1) lds=135232
; @launch kernel=outp_kernel grid=(256,1,1) block=(512,1,1) lds=131072
.amdgcn_target "amdgcn-amd-amdhsa--gfx950"
.text
.globl proj_kernel
.p2align 8
.type proj_kernel,@function
proj_kernel:
  s_cmp_ge_u32 s2, 256
  s_cbranch_scc1 proj_done
  s_load_dwordx4 s[4:7], s[0:1], 0
  s_load_dwordx4 s[8:11], s[0:1], 16
  s_load_dwordx2 s[12:13], s[0:1], 48
  s_load_dwordx2 s[16:17], s[0:1], 88
  s_and_b32 s42, s2, 3
  s_lshl_b32 s42, s42, 2
  s_bfe_u32 s43, s2, 0x20003
  s_add_u32 s41, s42, s43
  s_bfe_u32 s42, s2, 0x10002
  s_lshl_b32 s42, s42, 3
  s_lshr_b32 s43, s2, 5
  s_add_u32 s40, s42, s43
  v_and_b32 v1, 63, v0
  v_lshrrev_b32 v8, 6, v0
  s_nop 0
  v_readfirstlane_b32 s47, v8
  s_sub_u32 s53, s40, s41
  s_and_b32 s53, s53, 15
  s_and_b32 s51, s47, 3
  s_lshr_b32 s52, s47, 2
  s_lshl_b32 s57, s41, 2
  s_add_u32 s57, s57, s51
  v_lshrrev_b32 v8, 3, v1
  v_lshrrev_b32 v9, 4, v1
  v_and_b32 v10, 7, v1
  v_xor_b32 v10, v10, v9
  v_lshlrev_b32 v10, 4, v10
  v_lshl_add_u32 v2, v8, 10, v10
  v_xor_b32 v3, 64, v2
  v_add_u32 v3, 8192, v3
  v_lshrrev_b32 v8, 2, v1
  v_and_b32 v10, 1, v1
  v_lshlrev_b32 v10, 4, v10
  v_lshl_add_u32 v6, v8, 5, v10
  v_and_b32 v10, 15, v1
  v_lshlrev_b32 v11, 2, v9
  v_xor_b32 v10, v10, v11
  v_lshlrev_b32 v10, 4, v10
  s_waitcnt lgkmcnt(0)
  s_mov_b32 s20, s4
  s_and_b32 s21, s5, 0xffff
  s_mov_b32 s22, 2097152
  s_mov_b32 s23, 0x00020000
  s_mov_b32 s28, s16
  s_and_b32 s29, s17, 0xffff
  s_mov_b32 s30, 268435456
  s_mov_b32 s31, 0x00020000
  s_lshl_b32 s42, s2, 14
  s_lshl_b32 s43, s47, 11
  s_add_u32 s42, s42, s43
  s_cmp_lt_u32 s2, 128
  s_cselect_b32 s62, s4, s6
  s_cselect_b32 s63, s5, s7
  s_cselect_b32 s43, 0, 2097152
  s_cmp_lt_u32 s2, 160
  s_cselect_b32 s62, s62, s12
  s_cselect_b32 s63, s63, s13
  s_cselect_b32 s43, s43, 2621440
  s_sub_u32 s42, s42, s43
  s_mov_b32 s32, s62
  s_and_b32 s33, s63, 0xffff
  s_mov_b32 s34, 524288
  s_mov_b32 s35, 0x00020000
  s_cmp_lt_u32 s2, 128
  s_cselect_b32 s34, 2097152, s34
  s_cmp_lt_u32 s2, 160
  s_cselect_b32 s34, s34, 1572864
  v_lshlrev_b32 v11, 4, v1
  buffer_load_dwordx4 v[156:159], v11, s[32:35], s42 offen
  buffer_load_dwordx4 v[160:163], v11, s[32:35], s42 offen offset:1024
  s_cmp_lt_u32 s40, 4
  s_cbranch_scc1 proj_wq
  s_mov_b32 s24, s12
  s_and_b32 s25, s13, 0xffff
  s_mov_b32 s26, 1572864
  s_mov_b32 s27, 0x00020000
  s_sub_u32 s46, s40, 4
  s_lshl_b32 s46, s46, 8
  s_mov_b32 s45, 3072
  s_branch proj_wcommon
proj_wq:
  s_mov_b32 s24, s6
  s_and_b32 s25, s7, 0xffff
  s_mov_b32 s26, 524288
  s_mov_b32 s27, 0x00020000
  s_lshl_b32 s46, s40, 8
  s_mov_b32 s45, 1024
proj_wcommon:
  v_mul_lo_u32 v4, v9, s45
  v_add_u32 v4, v4, v10
  s_lshl_b32 s54, s41, 17
  s_lshl_b32 s42, s47, 14
  s_add_u32 s54, s54, s42
  s_lshl_b32 s42, s47, 3
  s_mul_i32 s55, s42, s45
  s_add_u32 s55, s55, s46
  s_lshl_b32 s56, s47, 11
  s_lshl_b32 s44, s45, 2
  s_lshl_b32 s45, s45, 6
  s_mov_b32 s58, 0
  s_bitcmp1_b32 s47, 0
  s_cselect_b32 s42, s10, s8
  s_cselect_b32 s43, s11, s9
  s_mov_b32 s36, 0x33333333
  s_cselect_b32 s36, 0xcccccccc, s36
  s_mov_b32 s37, s36
  s_mov_b32 s32, s42
  s_and_b32 s33, s43, 0xffff
  s_mov_b32 s34, 16384
  s_mov_b32 s35, 0x00020000
  s_lshr_b32 s42, s47, 1
  s_lshl_b32 s59, s42, 9
  s_lshl_b32 s60, s42, 10
  s_cmp_ge_u32 s40, 12
  s_cbranch_scc1 proj_v_sel
  s_cmp_ge_u32 s53, 8
  s_cbranch_scc1 proj_T_plain
  s_cmp_lg_u32 s53, s47
  s_cbranch_scc1 proj_T_none
  s_cmp_eq_u32 s52, 0
  s_cbranch_scc1 proj_T_T
proj_T_N:
  s_lshl_b32 s42, s58, 7
  s_add_u32 s42, s42, s54
  s_add_u32 m0, s56, 0
  s_mul_i32 s43, s58, s45
  buffer_load_dwordx4 v2, s[20:23], s42 offen lds
  s_add_u32 m0, s56, 1024
  s_add_u32 s43, s43, s55
  buffer_load_dwordx4 v3, s[20:23], s42 offen lds
  s_add_u32 m0, s56, 16384
  s_add_u32 s42, s43, s44
  buffer_load_dwordx4 v4, s[24:27], s43 offen lds
  s_add_u32 m0, s56, 17408
  s_lshl_b32 s43, s58, 11
  buffer_load_dwordx4 v4, s[24:27], s42 offen lds
  s_add_u32 m0, s60, 32768
  s_add_u32 s43, s43, s59
  s_mov_b64 exec, s[36:37]
  buffer_load_dwordx4 v6, s[32:35], s43 offen lds
  s_mov_b64 exec, -1
  s_add_u32 s58, s58, 1
  s_and_b32 s58, s58, 7
  s_lshl_b32 s42, s58, 7
  s_add_u32 s42, s42, s54
  s_add_u32 m0, s56, 36864
  s_mul_i32 s43, s58, s45
  buffer_load_dwordx4 v2, s[20:23], s42 offen lds
  s_add_u32 m0, s56, 37888
  s_add_u32 s43, s43, s55
  buffer_load_dwordx4 v3, s[20:23], s42 offen lds
  s_add_u32 m0, s56, 53248
  s_add_u32 s42, s43, s44
  buffer_load_dwordx4 v4, s[24:27], s43 offen lds
  s_add_u32 m0, s56, 54272
  s_lshl_b32 s43, s58, 11
  buffer_load_dwordx4 v4, s[24:27], s42 offen lds
  s_add_u32 m0, s60, 69632
  s_add_u32 s43, s43, s59
  s_mov_b64 exec, s[36:37]
  buffer_load_dwordx4 v6, s[32:35], s43 offen lds
  s_mov_b64 exec, -1
  s_add_u32 s58, s58, 1
  s_and_b32 s58, s58, 7
  v_and_b32 v8, 31, v1
  v_lshrrev_b32 v9, 5, v1
  v_bfe_u32 v10, v1, 1, 3
  v_xor_b32 v9, v9, v10
  v_lshlrev_b32 v9, 4, v9
  v_lshl_add_u32 v8, v8, 7, v9
  s_lshl_b32 s50, s51, 12
  v_add_u32 v8, s50, v8
  v_xor_b32 v12, 0, v8
  v_add_u32 v16, 73728, v12
  v_xor_b32 v13, 32, v8
  v_add_u32 v17, 73728, v13
  v_xor_b32 v14, 64, v8
  v_add_u32 v18, 73728, v14
  v_xor_b32 v15, 96, v8
  v_add_u32 v19, 73728, v15
  v_lshrrev_b32 v8, 5, v1
  v_bfe_u32 v9, v1, 2, 2
  v_lshl_add_u32 v8, v8, 3, v9
  v_bfe_u32 v10, v1, 4, 1
  v_and_b32 v11, 3, v1
  v_lshl_add_u32 v10, v10, 2, v11
  v_lshlrev_b32 v10, 3, v10
  v_lshl_add_u32 v24, v8, 6, v10
  v_add_u32 v24, 32768, v24
  v_add_u32 v25, 73728, v24
  v_lshl_add_u32 v8, v8, 8, v10
  s_lshl_b32 s50, s52, 1
  v_xor_b32 v9, s50, v9
  v_lshl_add_u32 v8, v9, 6, v8
  v_add_u32 v20, 16384, v8
  v_xor_b32 v21, 64, v20
  v_add_u32 v22, 73728, v20
  v_add_u32 v23, 73728, v21
  s_waitcnt vmcnt(5)
  s_barrier
  ds_read_b128 v[28:31], v12 offset:0
  ds_read_b64_tr_b16 v[44:45], v20 offset:0
  ds_read_b64_tr_b16 v[46:47], v20 offset:1024
  ds_read_b64_tr_b16 v[48:49], v21 offset:0
  ds_read_b64_tr_b16 v[50:51], v21 offset:1024
  ds_read_b64_tr_b16 v[76:77], v24 offset:0
  ds_read_b64_tr_b16 v[78:79], v24 offset:256
  ds_read_b128 v[32:35], v13 offset:0
  ds_read_b64_tr_b16 v[52:53], v20 offset:4096
  ds_read_b64_tr_b16 v[54:55], v20 offset:5120
  ds_read_b64_tr_b16 v[56:57], v21 offset:4096
  ds_read_b64_tr_b16 v[58:59], v21 offset:5120
  ds_read_b64_tr_b16 v[80:81], v24 offset:1024
  ds_read_b64_tr_b16 v[82:83], v24 offset:1280
  ds_read_b128 v[36:39], v14 offset:0
  ds_read_b64_tr_b16 v[60:61], v20 offset:8192
  ds_read_b64_tr_b16 v[62:63], v20 offset:9216
  ds_read_b64_tr_b16 v[64:65], v21 offset:8192
  ds_read_b64_tr_b16 v[66:67], v21 offset:9216
  ds_read_b64_tr_b16 v[84:85], v24 offset:2048
  ds_read_b64_tr_b16 v[86:87], v24 offset:2304
  ds_read_b128 v[40:43], v15 offset:0
  ds_read_b64_tr_b16 v[68:69], v20 offset:12288
  ds_read_b64_tr_b16 v[70:71], v20 offset:13312
  ds_read_b64_tr_b16 v[72:73], v21 offset:12288
  ds_read_b64_tr_b16 v[74:75], v21 offset:13312
  ds_read_b64_tr_b16 v[88:89], v24 offset:3072
  ds_read_b64_tr_b16 v[90:91], v24 offset:3328
  s_lshl_b32 s42, s58, 7
  s_add_u32 s42, s42, s54
  s_add_u32 m0, s56, 73728
  s_mul_i32 s43, s58, s45
  buffer_load_dwordx4 v2, s[20:23], s42 offen lds
  s_add_u32 m0, s56, 74752
  s_add_u32 s43, s43, s55
  buffer_load_dwordx4 v3, s[20:23], s42 offen lds
  s_add_u32 m0, s56, 90112
  s_add_u32 s42, s43, s44
  buffer_load_dwordx4 v4, s[24:27], s43 offen lds
  s_add_u32 m0, s56, 91136
  s_lshl_b32 s43, s58, 11
  buffer_load_dwordx4 v4, s[24:27], s42 offen lds
  s_add_u32 m0, s60, 106496
  s_add_u32 s43, s43, s59
  s_mov_b64 exec, s[36:37]
  buffer_load_dwordx4 v6, s[32:35], s43 offen lds
  s_mov_b64 exec, -1
  s_add_u32 s58, s58, 1
  s_and_b32 s58, s58, 7
  s_lshl_b32 s42, s58, 7
  s_add_u32 s42, s42, s54
  s_add_u32 m0, s56, 110592
  s_mul_i32 s43, s58, s45
  buffer_load_dwordx4 v2, s[20:23], s42 offen lds
  s_add_u32 m0, s56, 111616
  s_add_u32 s43, s43, s55
  buffer_load_dwordx4 v3, s[20:23], s42 offen lds
  s_add_u32 m0, s56, 126976
  s_add_u32 s42, s43, s44
  buffer_load_dwordx4 v4, s[24:27], s43 offen lds
  s_add_u32 m0, s56, 128000
  s_lshl_b32 s43, s58, 11
  buffer_load_dwordx4 v4, s[24:27], s42 offen lds
  s_add_u32 m0, s60, 143360
  s_add_u32 s43, s43, s59
  s_mov_b64 exec, s[36:37]
  buffer_load_dwordx4 v6, s[32:35], s43 offen lds
  s_mov_b64 exec, -1
  s_add_u32 s58, s58, 1
  s_and_b32 s58, s58, 7
  s_waitcnt vmcnt(10) lgkmcnt(0)
  s_barrier
  ds_read_b128 v[92:95], v12 offset:36864
  ds_read_b64_tr_b16 v[108:109], v20 offset:36864
  ds_read_b64_tr_b16 v[110:111], v20 offset:37888
  ds_read_b64_tr_b16 v[112:113], v21 offset:36864
  ds_read_b64_tr_b16 v[114:115], v21 offset:37888
  ds_read_b64_tr_b16 v[140:141], v24 offset:36864
  ds_read_b64_tr_b16 v[142:143], v24 offset:37120
  v_mfma_f32_32x32x16_bf16 v[156:171], v[44:47], v[28:31], 0
  v_mfma_f32_32x32x16_bf16 v[172:187], v[48:51], v[28:31], 0
  v_mfma_f32_32x32x16_bf16 v[188:203], v[28:31], v[76:79], 0
  s_lshl_b32 s42, s58, 7
  s_add_u32 s42, s42, s54
  s_add_u32 m0, s56, 0
  s_mul_i32 s43, s58, s45
  buffer_load_dwordx4 v2, s[20:23], s42 offen lds
  ds_read_b128 v[96:99], v13 offset:36864
  ds_read_b64_tr_b16 v[116:117], v20 offset:40960
  ds_read_b64_tr_b16 v[118:119], v20 offset:41984
  ds_read_b64_tr_b16 v[120:121], v21 offset:40960
  ds_read_b64_tr_b16 v[122:123], v21 offset:41984
  ds_read_b64_tr_b16 v[144:145], v24 offset:37888
  ds_read_b64_tr_b16 v[146:147], v24 offset:38144
  v_mfma_f32_32x32x16_bf16 v[156:171], v[52:55], v[32:35], v[156:171]
  v_mfma_f32_32x32x16_bf16 v[172:187], v[56:59], v[32:35], v[172:187]
  v_mfma_f32_32x32x16_bf16 v[188:203], v[32:35], v[80:83], v[188:203]
  s_add_u32 m0, s56, 1024
  s_add_u32 s43, s43, s55
  buffer_load_dwordx4 v3, s[20:23], s42 offen lds
  ds_read_b128 v[100:103], v14 offset:36864
  ds_read_b64_tr_b16 v[124:125], v20 offset:45056
  ds_read_b64_tr_b16 v[126:127], v20 offset:46080
  ds_read_b64_tr_b16 v[128:129], v21 offset:45056
  ds_read_b64_tr_b16 v[130:131], v21 offset:46080
  ds_read_b64_tr_b16 v[148:149], v24 offset:38912
  ds_read_b64_tr_b16 v[150:151], v24 offset:39168
  v_mfma_f32_32x32x16_bf16 v[156:171], v[60:63], v[36:39], v[156:171]
  v_mfma_f32_32x32x16_bf16 v[172:187], v[64:67], v[36:39], v[172:187]
  v_mfma_f32_32x32x16_bf16 v[188:203], v[36:39], v[84:87], v[188:203]
  s_add_u32 m0, s56, 16384
  s_add_u32 s42, s43, s44
  buffer_load_dwordx4 v4, s[24:27], s43 offen lds
  ds_read_b128 v[104:107], v15 offset:36864
  ds_read_b64_tr_b16 v[132:133], v20 offset:49152
  ds_read_b64_tr_b16 v[134:135], v20 offset:50176
  ds_read_b64_tr_b16 v[136:137], v21 offset:49152
  ds_read_b64_tr_b16 v[138:139], v21 offset:50176
  ds_read_b64_tr_b16 v[152:153], v24 offset:39936
  ds_read_b64_tr_b16 v[154:155], v24 offset:40192
  v_mfma_f32_32x32x16_bf16 v[156:171], v[68:71], v[40:43], v[156:171]
  v_mfma_f32_32x32x16_bf16 v[172:187], v[72:75], v[40:43], v[172:187]
  v_mfma_f32_32x32x16_bf16 v[188:203], v[40:43], v[88:91], v[188:203]
  s_add_u32 m0, s56, 17408
  s_lshl_b32 s43, s58, 11
  buffer_load_dwordx4 v4, s[24:27], s42 offen lds
  s_add_u32 m0, s60, 32768
  s_add_u32 s43, s43, s59
  s_mov_b64 exec, s[36:37]
  buffer_load_dwordx4 v6, s[32:35], s43 offen lds
  s_mov_b64 exec, -1
  s_add_u32 s58, s58, 1
  s_and_b32 s58, s58, 7
  s_waitcnt vmcnt(10) lgkmcnt(0)
  s_barrier
  ds_read_b128 v[28:31], v16 offset:0
  ds_read_b64_tr_b16 v[44:45], v22 offset:0
  ds_read_b64_tr_b16 v[46:47], v22 offset:1024
  ds_read_b64_tr_b16 v[48:49], v23 offset:0
  ds_read_b64_tr_b16 v[50:51], v23 offset:1024
  ds_read_b64_tr_b16 v[76:77], v25 offset:0
  ds_read_b64_tr_b16 v[78:79], v25 offset:256
  v_mfma_f32_32x32x16_bf16 v[156:171], v[108:111], v[92:95], v[156:171]
  v_mfma_f32_32x32x16_bf16 v[172:187], v[112:115], v[92:95], v[172:187]
  v_mfma_f32_32x32x16_bf16 v[188:203], v[92:95], v[140:143], v[188:203]
  s_lshl_b32 s42, s58, 7
  s_add_u32 s42, s42, s54
  s_add_u32 m0, s56, 36864
  s_mul_i32 s43, s58, s45
  buffer_load_dwordx4 v2, s[20:23], s42 offen lds
  ds_read_b128 v[32:35], v17 offset:0
  ds_read_b64_tr_b16 v[52:53], v22 offset:4096
  ds_read_b64_tr_b16 v[54:55], v22 offset:5120
  ds_read_b64_tr_b16 v[56:57], v23 offset:4096
  ds_read_b64_tr_b16 v[58:59], v23 offset:5120
  ds_read_b64_tr_b16 v[80:81], v25 offset:1024
  ds_read_b64_tr_b16 v[82:83], v25 offset:1280
  v_mfma_f32_32x32x16_bf16 v[156:171], v[116:119], v[96:99], v[156:171]
  v_mfma_f32_32x32x16_bf16 v[172:187], v[120:123], v[96:99], v[172:187]
  v_mfma_f32_32x32x16_bf16 v[188:203], v[96:99], v[144:147], v[188:203]
  s_add_u32 m0, s56, 37888
  s_add_u32 s43, s43, s55
  buffer_load_dwordx4 v3, s[20:23], s42 offen lds
  ds_read_b128 v[36:39], v18 offset:0
  ds_read_b64_tr_b16 v[60:61], v22 offset:8192
  ds_read_b64_tr_b16 v[62:63], v22 offset:9216
  ds_read_b64_tr_b16 v[64:65], v23 offset:8192
  ds_read_b64_tr_b16 v[66:67], v23 offset:9216
  ds_read_b64_tr_b16 v[84:85], v25 offset:2048
  ds_read_b64_tr_b16 v[86:87], v25 offset:2304
  v_mfma_f32_32x32x16_bf16 v[156:171], v[124:127], v[100:103], v[156:171]
  v_mfma_f32_32x32x16_bf16 v[172:187], v[128:131], v[100:103], v[172:187]
  v_mfma_f32_32x32x16_bf16 v[188:203], v[100:103], v[148:151], v[188:203]
  s_add_u32 m0, s56, 53248
  s_add_u32 s42, s43, s44
  buffer_load_dwordx4 v4, s[24:27], s43 offen lds
  ds_read_b128 v[40:43], v19 offset:0
  ds_read_b64_tr_b16 v[68:69], v22 offset:12288
  ds_read_b64_tr_b16 v[70:71], v22 offset:13312
  ds_read_b64_tr_b16 v[72:73], v23 offset:12288
  ds_read_b64_tr_b16 v[74:75], v23 offset:13312
  ds_read_b64_tr_b16 v[88:89], v25 offset:3072
  ds_read_b64_tr_b16 v[90:91], v25 offset:3328
  v_mfma_f32_32x32x16_bf16 v[156:171], v[132:135], v[104:107], v[156:171]
  v_mfma_f32_32x32x16_bf16 v[172:187], v[136:139], v[104:107], v[172:187]
  v_mfma_f32_32x32x16_bf16 v[188:203], v[104:107], v[152:155], v[188:203]
  s_add_u32 m0, s56, 54272
  s_lshl_b32 s43, s58, 11
  buffer_load_dwordx4 v4, s[24:27], s42 offen lds
  s_add_u32 m0, s60, 69632
  s_add_u32 s43, s43, s59
  s_mov_b64 exec, s[36:37]
  buffer_load_dwordx4 v6, s[32:35], s43 offen lds
  s_mov_b64 exec, -1
  s_add_u32 s58, s58, 1
  s_and_b32 s58, s58, 7
  s_waitcnt vmcnt(10) lgkmcnt(0)
  s_barrier
  ds_read_b128 v[92:95], v16 offset:36864
  ds_read_b64_tr_b16 v[108:109], v22 offset:36864
  ds_read_b64_tr_b16 v[110:111], v22 offset:37888
  ds_read_b64_tr_b16 v[112:113], v23 offset:36864
  ds_read_b64_tr_b16 v[114:115], v23 offset:37888
  ds_read_b64_tr_b16 v[140:141], v25 offset:36864
  ds_read_b64_tr_b16 v[142:143], v25 offset:37120
  v_mfma_f32_32x32x16_bf16 v[156:171], v[44:47], v[28:31], v[156:171]
  v_mfma_f32_32x32x16_bf16 v[172:187], v[48:51], v[28:31], v[172:187]
  v_mfma_f32_32x32x16_bf16 v[188:203], v[28:31], v[76:79], v[188:203]
  s_lshl_b32 s42, s58, 7
  s_add_u32 s42, s42, s54
  s_add_u32 m0, s56, 73728
  s_mul_i32 s43, s58, s45
  buffer_load_dwordx4 v2, s[20:23], s42 offen lds
  ds_read_b128 v[96:99], v17 offset:36864
  ds_read_b64_tr_b16 v[116:117], v22 offset:40960
  ds_read_b64_tr_b16 v[118:119], v22 offset:41984
  ds_read_b64_tr_b16 v[120:121], v23 offset:40960
  ds_read_b64_tr_b16 v[122:123], v23 offset:41984
  ds_read_b64_tr_b16 v[144:145], v25 offset:37888
  ds_read_b64_tr_b16 v[146:147], v25 offset:38144
  v_mfma_f32_32x32x16_bf16 v[156:171], v[52:55], v[32:35], v[156:171]
  v_mfma_f32_32x32x16_bf16 v[172:187], v[56:59], v[32:35], v[172:187]
  v_mfma_f32_32x32x16_bf16 v[188:203], v[32:35], v[80:83], v[188:203]
  s_add_u32 m0, s56, 74752
  s_add_u32 s43, s43, s55
  buffer_load_dwordx4 v3, s[20:23], s42 offen lds
  ds_read_b128 v[100:103], v18 offset:36864
  ds_read_b64_tr_b16 v[124:125], v22 offset:45056
  ds_read_b64_tr_b16 v[126:127], v22 offset:46080
  ds_read_b64_tr_b16 v[128:129], v23 offset:45056
  ds_read_b64_tr_b16 v[130:131], v23 offset:46080
  ds_read_b64_tr_b16 v[148:149], v25 offset:38912
  ds_read_b64_tr_b16 v[150:151], v25 offset:39168
  v_mfma_f32_32x32x16_bf16 v[156:171], v[60:63], v[36:39], v[156:171]
  v_mfma_f32_32x32x16_bf16 v[172:187], v[64:67], v[36:39], v[172:187]
  v_mfma_f32_32x32x16_bf16 v[188:203], v[36:39], v[84:87], v[188:203]
  s_add_u32 m0, s56, 90112
  s_add_u32 s42, s43, s44
  buffer_load_dwordx4 v4, s[24:27], s43 offen lds
  ds_read_b128 v[104:107], v19 offset:36864
  ds_read_b64_tr_b16 v[132:133], v22 offset:49152
  ds_read_b64_tr_b16 v[134:135], v22 offset:50176
  ds_read_b64_tr_b16 v[136:137], v23 offset:49152
  ds_read_b64_tr_b16 v[138:139], v23 offset:50176
  ds_read_b64_tr_b16 v[152:153], v25 offset:39936
  ds_read_b64_tr_b16 v[154:155], v25 offset:40192
  v_mfma_f32_32x32x16_bf16 v[156:171], v[68:71], v[40:43], v[156:171]
  v_mfma_f32_32x32x16_bf16 v[172:187], v[72:75], v[40:43], v[172:187]
  v_mfma_f32_32x32x16_bf16 v[188:203], v[40:43], v[88:91], v[188:203]
  s_add_u32 m0, s56, 91136
  s_lshl_b32 s43, s58, 11
  buffer_load_dwordx4 v4, s[24:27], s42 offen lds
  s_add_u32 m0, s60, 106496
  s_add_u32 s43, s43, s59
  s_mov_b64 exec, s[36:37]
  buffer_load_dwordx4 v6, s[32:35], s43 offen lds
  s_mov_b64 exec, -1
  s_add_u32 s58, s58, 1
  s_and_b32 s58, s58, 7
  s_waitcnt vmcnt(10) lgkmcnt(0)
  s_barrier
  ds_read_b128 v[28:31], v12 offset:0
  ds_read_b64_tr_b16 v[44:45], v20 offset:0
  ds_read_b64_tr_b16 v[46:47], v20 offset:1024
  ds_read_b64_tr_b16 v[48:49], v21 offset:0
  ds_read_b64_tr_b16 v[50:51], v21 offset:1024
  ds_read_b64_tr_b16 v[76:77], v24 offset:0
  ds_read_b64_tr_b16 v[78:79], v24 offset:256
  v_mfma_f32_32x32x16_bf16 v[156:171], v[108:111], v[92:95], v[156:171]
  v_mfma_f32_32x32x16_bf16 v[172:187], v[112:115], v[92:95], v[172:187]
  v_mfma_f32_32x32x16_bf16 v[188:203], v[92:95], v[140:143], v[188:203]
  s_lshl_b32 s42, s58, 7
  s_add_u32 s42, s42, s54
  s_add_u32 m0, s56, 110592
  s_mul_i32 s43, s58, s45
  buffer_load_dwordx4 v2, s[20:23], s42 offen lds
  ds_read_b128 v[32:35], v13 offset:0
  ds_read_b64_tr_b16 v[52:53], v20 offset:4096
  ds_read_b64_tr_b16 v[54:55], v20 offset:5120
  ds_read_b64_tr_b16 v[56:57], v21 offset:4096
  ds_read_b64_tr_b16 v[58:59], v21 offset:5120
  ds_read_b64_tr_b16 v[80:81], v24 offset:1024
  ds_read_b64_tr_b16 v[82:83], v24 offset:1280
  v_mfma_f32_32x32x16_bf16 v[156:171], v[116:119], v[96:99], v[156:171]
  v_mfma_f32_32x32x16_bf16 v[172:187], v[120:123], v[96:99], v[172:187]
  v_mfma_f32_32x32x16_bf16 v[188:203], v[96:99], v[144:147], v[188:203]
  s_add_u32 m0, s56, 111616
  s_add_u32 s43, s43, s55
  buffer_load_dwordx4 v3, s[20:23], s42 offen lds
  ds_read_b128 v[36:39], v14 offset:0
  ds_read_b64_tr_b16 v[60:61], v20 offset:8192
  ds_read_b64_tr_b16 v[62:63], v20 offset:9216
  ds_read_b64_tr_b16 v[64:65], v21 offset:8192
  ds_read_b64_tr_b16 v[66:67], v21 offset:9216
  ds_read_b64_tr_b16 v[84:85], v24 offset:2048
  ds_read_b64_tr_b16 v[86:87], v24 offset:2304
  v_mfma_f32_32x32x16_bf16 v[156:171], v[124:127], v[100:103], v[156:171]
  v_mfma_f32_32x32x16_bf16 v[172:187], v[128:131], v[100:103], v[172:187]
  v_mfma_f32_32x32x16_bf16 v[188:203], v[100:103], v[148:151], v[188:203]
  s_add_u32 m0, s56, 126976
  s_add_u32 s42, s43, s44
  buffer_load_dwordx4 v4, s[24:27], s43 offen lds
  ds_read_b128 v[40:43], v15 offset:0
  ds_read_b64_tr_b16 v[68:69], v20 offset:12288
  ds_read_b64_tr_b16 v[70:71], v20 offset:13312
  ds_read_b64_tr_b16 v[72:73], v21 offset:12288
  ds_read_b64_tr_b16 v[74:75], v21 offset:13312
  ds_read_b64_tr_b16 v[88:89], v24 offset:3072
  ds_read_b64_tr_b16 v[90:91], v24 offset:3328
  v_mfma_f32_32x32x16_bf16 v[156:171], v[132:135], v[104:107], v[156:171]
  v_mfma_f32_32x32x16_bf16 v[172:187], v[136:139], v[104:107], v[172:187]
  v_mfma_f32_32x32x16_bf16 v[188:203], v[104:107], v[152:155], v[188:203]
  s_add_u32 m0, s56, 128000
  s_lshl_b32 s43, s58, 11
  buffer_load_dwordx4 v4, s[24:27], s42 offen lds
  s_add_u32 m0, s60, 143360
  s_add_u32 s43, s43, s59
  s_mov_b64 exec, s[36:37]
  buffer_load_dwordx4 v6, s[32:35], s43 offen lds
  s_mov_b64 exec, -1
  s_add_u32 s58, s58, 1
  s_and_b32 s58, s58, 7
  s_waitcnt vmcnt(10) lgkmcnt(0)
  s_barrier
  ds_read_b128 v[92:95], v12 offset:36864
  ds_read_b64_tr_b16 v[108:109], v20 offset:36864
  ds_read_b64_tr_b16 v[110:111], v20 offset:37888
  ds_read_b64_tr_b16 v[112:113], v21 offset:36864
  ds_read_b64_tr_b16 v[114:115], v21 offset:37888
  ds_read_b64_tr_b16 v[140:141], v24 offset:36864
  ds_read_b64_tr_b16 v[142:143], v24 offset:37120
  v_mfma_f32_32x32x16_bf16 v[156:171], v[44:47], v[28:31], v[156:171]
  v_mfma_f32_32x32x16_bf16 v[172:187], v[48:51], v[28:31], v[172:187]
  v_mfma_f32_32x32x16_bf16 v[188:203], v[28:31], v[76:79], v[188:203]
  ds_read_b128 v[96:99], v13 offset:36864
  ds_read_b64_tr_b16 v[116:117], v20 offset:40960
  ds_read_b64_tr_b16 v[118:119], v20 offset:41984
  ds_read_b64_tr_b16 v[120:121], v21 offset:40960
  ds_read_b64_tr_b16 v[122:123], v21 offset:41984
  ds_read_b64_tr_b16 v[144:145], v24 offset:37888
  ds_read_b64_tr_b16 v[146:147], v24 offset:38144
  v_mfma_f32_32x32x16_bf16 v[156:171], v[52:55], v[32:35], v[156:171]
  v_mfma_f32_32x32x16_bf16 v[172:187], v[56:59], v[32:35], v[172:187]
  v_mfma_f32_32x32x16_bf16 v[188:203], v[32:35], v[80:83], v[188:203]
  ds_read_b128 v[100:103], v14 offset:36864
  ds_read_b64_tr_b16 v[124:125], v20 offset:45056
  ds_read_b64_tr_b16 v[126:127], v20 offset:46080
  ds_read_b64_tr_b16 v[128:129], v21 offset:45056
  ds_read_b64_tr_b16 v[130:131], v21 offset:46080
  ds_read_b64_tr_b16 v[148:149], v24 offset:38912
  ds_read_b64_tr_b16 v[150:151], v24 offset:39168
  v_mfma_f32_32x32x16_bf16 v[156:171], v[60:63], v[36:39], v[156:171]
  v_mfma_f32_32x32x16_bf16 v[172:187], v[64:67], v[36:39], v[172:187]
  v_mfma_f32_32x32x16_bf16 v[188:203], v[36:39], v[84:87], v[188:203]
  ds_read_b128 v[104:107], v15 offset:36864
  ds_read_b64_tr_b16 v[132:133], v20 offset:49152
  ds_read_b64_tr_b16 v[134:135], v20 offset:50176
  ds_read_b64_tr_b16 v[136:137], v21 offset:49152
  ds_read_b64_tr_b16 v[138:139], v21 offset:50176
  ds_read_b64_tr_b16 v[152:153], v24 offset:39936
  ds_read_b64_tr_b16 v[154:155], v24 offset:40192
  v_mfma_f32_32x32x16_bf16 v[156:171], v[68:71], v[40:43], v[156:171]
  v_mfma_f32_32x32x16_bf16 v[172:187], v[72:75], v[40:43], v[172:187]
  v_mfma_f32_32x32x16_bf16 v[188:203], v[40:43], v[88:91], v[188:203]
  s_waitcnt vmcnt(5) lgkmcnt(0)
  s_barrier
  ds_read_b128 v[28:31], v16 offset:0
  ds_read_b64_tr_b16 v[44:45], v22 offset:0
  ds_read_b64_tr_b16 v[46:47], v22 offset:1024
  ds_read_b64_tr_b16 v[48:49], v23 offset:0
  ds_read_b64_tr_b16 v[50:51], v23 offset:1024
  ds_read_b64_tr_b16 v[76:77], v25 offset:0
  ds_read_b64_tr_b16 v[78:79], v25 offset:256
  v_mfma_f32_32x32x16_bf16 v[156:171], v[108:111], v[92:95], v[156:171]
  v_mfma_f32_32x32x16_bf16 v[172:187], v[112:115], v[92:95], v[172:187]
  v_mfma_f32_32x32x16_bf16 v[188:203], v[92:95], v[140:143], v[188:203]
  ds_read_b128 v[32:35], v17 offset:0
  ds_read_b64_tr_b16 v[52:53], v22 offset:4096
  ds_read_b64_tr_b16 v[54:55], v22 offset:5120
  ds_read_b64_tr_b16 v[56:57], v23 offset:4096
  ds_read_b64_tr_b16 v[58:59], v23 offset:5120
  ds_read_b64_tr_b16 v[80:81], v25 offset:1024
  ds_read_b64_tr_b16 v[82:83], v25 offset:1280
  v_mfma_f32_32x32x16_bf16 v[156:171], v[116:119], v[96:99], v[156:171]
  v_mfma_f32_32x32x16_bf16 v[172:187], v[120:123], v[96:99], v[172:187]
  v_mfma_f32_32x32x16_bf16 v[188:203], v[96:99], v[144:147], v[188:203]
  ds_read_b128 v[36:39], v18 offset:0
  ds_read_b64_tr_b16 v[60:61], v22 offset:8192
  ds_read_b64_tr_b16 v[62:63], v22 offset:9216
  ds_read_b64_tr_b16 v[64:65], v23 offset:8192
  ds_read_b64_tr_b16 v[66:67], v23 offset:9216
  ds_read_b64_tr_b16 v[84:85], v25 offset:2048
  ds_read_b64_tr_b16 v[86:87], v25 offset:2304
  v_mfma_f32_32x32x16_bf16 v[156:171], v[124:127], v[100:103], v[156:171]
  v_mfma_f32_32x32x16_bf16 v[172:187], v[128:131], v[100:103], v[172:187]
  v_mfma_f32_32x32x16_bf16 v[188:203], v[100:103], v[148:151], v[188:203]
  ds_read_b128 v[40:43], v19 offset:0
  ds_read_b64_tr_b16 v[68:69], v22 offset:12288
  ds_read_b64_tr_b16 v[70:71], v22 offset:13312
  ds_read_b64_tr_b16 v[72:73], v23 offset:12288
  ds_read_b64_tr_b16 v[74:75], v23 offset:13312
  ds_read_b64_tr_b16 v[88:89], v25 offset:3072
  ds_read_b64_tr_b16 v[90:91], v25 offset:3328
  v_mfma_f32_32x32x16_bf16 v[156:171], v[132:135], v[104:107], v[156:171]
  v_mfma_f32_32x32x16_bf16 v[172:187], v[136:139], v[104:107], v[172:187]
  v_mfma_f32_32x32x16_bf16 v[188:203], v[104:107], v[152:155], v[188:203]
  s_waitcnt vmcnt(0) lgkmcnt(0)
  s_barrier
  ds_read_b128 v[92:95], v16 offset:36864
  ds_read_b64_tr_b16 v[108:109], v22 offset:36864
  ds_read_b64_tr_b16 v[110:111], v22 offset:37888
  ds_read_b64_tr_b16 v[112:113], v23 offset:36864
  ds_read_b64_tr_b16 v[114:115], v23 offset:37888
  ds_read_b64_tr_b16 v[140:141], v25 offset:36864
  ds_read_b64_tr_b16 v[142:143], v25 offset:37120
  v_mfma_f32_32x32x16_bf16 v[156:171], v[44:47], v[28:31], v[156:171]
  v_mfma_f32_32x32x16_bf16 v[172:187], v[48:51], v[28:31], v[172:187]
  v_mfma_f32_32x32x16_bf16 v[188:203], v[28:31], v[76:79], v[188:203]
  ds_read_b128 v[96:99], v17 offset:36864
  ds_read_b64_tr_b16 v[116:117], v22 offset:40960
  ds_read_b64_tr_b16 v[118:119], v22 offset:41984
  ds_read_b64_tr_b16 v[120:121], v23 offset:40960
  ds_read_b64_tr_b16 v[122:123], v23 offset:41984
  ds_read_b64_tr_b16 v[144:145], v25 offset:37888
  ds_read_b64_tr_b16 v[146:147], v25 offset:38144
  v_mfma_f32_32x32x16_bf16 v[156:171], v[52:55], v[32:35], v[156:171]
  v_mfma_f32_32x32x16_bf16 v[172:187], v[56:59], v[32:35], v[172:187]
  v_mfma_f32_32x32x16_bf16 v[188:203], v[32:35], v[80:83], v[188:203]
  ds_read_b128 v[100:103], v18 offset:36864
  ds_read_b64_tr_b16 v[124:125], v22 offset:45056
  ds_read_b64_tr_b16 v[126:127], v22 offset:46080
  ds_read_b64_tr_b16 v[128:129], v23 offset:45056
  ds_read_b64_tr_b16 v[130:131], v23 offset:46080
  ds_read_b64_tr_b16 v[148:149], v25 offset:38912
  ds_read_b64_tr_b16 v[150:151], v25 offset:39168
  v_mfma_f32_32x32x16_bf16 v[156:171], v[60:63], v[36:39], v[156:171]
  v_mfma_f32_32x32x16_bf16 v[172:187], v[64:67], v[36:39], v[172:187]
  v_mfma_f32_32x32x16_bf16 v[188:203], v[36:39], v[84:87], v[188:203]
  ds_read_b128 v[104:107], v19 offset:36864
  ds_read_b64_tr_b16 v[132:133], v22 offset:49152
  ds_read_b64_tr_b16 v[134:135], v22 offset:50176
  ds_read_b64_tr_b16 v[136:137], v23 offset:49152
  ds_read_b64_tr_b16 v[138:139], v23 offset:50176
  ds_read_b64_tr_b16 v[152:153], v25 offset:39936
  ds_read_b64_tr_b16 v[154:155], v25 offset:40192
  v_mfma_f32_32x32x16_bf16 v[156:171], v[68:71], v[40:43], v[156:171]
  v_mfma_f32_32x32x16_bf16 v[172:187], v[72:75], v[40:43], v[172:187]
  v_mfma_f32_32x32x16_bf16 v[188:203], v[40:43], v[88:91], v[188:203]
  s_waitcnt lgkmcnt(0)
  v_mfma_f32_32x32x16_bf16 v[156:171], v[108:111], v[92:95], v[156:171]
  v_mfma_f32_32x32x16_bf16 v[172:187], v[112:115], v[92:95], v[172:187]
  v_mfma_f32_32x32x16_bf16 v[188:203], v[92:95], v[140:143], v[188:203]
  v_mfma_f32_32x32x16_bf16 v[156:171], v[116:119], v[96:99], v[156:171]
  v_mfma_f32_32x32x16_bf16 v[172:187], v[120:123], v[96:99], v[172:187]
  v_mfma_f32_32x32x16_bf16 v[188:203], v[96:99], v[144:147], v[188:203]
  v_mfma_f32_32x32x16_bf16 v[156:171], v[124:127], v[100:103], v[156:171]
  v_mfma_f32_32x32x16_bf16 v[172:187], v[128:131], v[100:103], v[172:187]
  v_mfma_f32_32x32x16_bf16 v[188:203], v[100:103], v[148:151], v[188:203]
  v_mfma_f32_32x32x16_bf16 v[156:171], v[132:135], v[104:107], v[156:171]
  v_mfma_f32_32x32x16_bf16 v[172:187], v[136:139], v[104:107], v[172:187]
  v_mfma_f32_32x32x16_bf16 v[188:203], v[104:107], v[152:155], v[188:203]
  s_nop 15
  s_lshl_b32 s50, s57, 11
  s_add_u32 s50, s50, 8257536
  v_and_b32 v8, 3, v1
  v_and_b32 v9, 4, v1
  v_lshl_or_b32 v8, v9, 1, v8
  v_and_b32 v9, 8, v1
  v_lshrrev_b32 v9, 1, v9
  v_or_b32 v8, v8, v9
  v_lshlrev_b32 v8, 4, v8
  v_lshrrev_b32 v9, 5, v1
  v_lshl_add_u32 v8, v9, 9, v8
  v_bfe_u32 v9, v1, 4, 1
  v_lshl_add_u32 v5, v9, 17, v8
  v_cvt_pk_bf16_f32 v44, v188, v189
  v_cvt_pk_bf16_f32 v45, v190, v191
  v_cvt_pk_bf16_f32 v46, v192, v193
  v_cvt_pk_bf16_f32 v47, v194, v195
  v_cvt_pk_bf16_f32 v48, v196, v197
  v_cvt_pk_bf16_f32 v49, v198, v199
  v_cvt_pk_bf16_f32 v50, v200, v201
  v_cvt_pk_bf16_f32 v51, v202, v203
  v_and_b32 v8, 16, v1
  v_cmp_ne_u32 vcc, 0, v8
  s_and_saveexec_b64 s[48:49], vcc
  buffer_store_dwordx4 v[44:47], v5, s[28:31], s50 offen offset:1024 sc0 sc1
  buffer_store_dwordx4 v[48:51], v5, s[28:31], s50 offen offset:1280 sc0 sc1
  s_mov_b64 exec, s[48:49]
  s_branch proj_T_epi
proj_T_T:
  s_lshl_b32 s42, s58, 7
  s_add_u32 s42, s42, s54
  s_add_u32 m0, s56, 0
  s_mul_i32 s43, s58, s45
  buffer_load_dwordx4 v2, s[20:23], s42 offen lds
  s_add_u32 m0, s56, 1024
  s_add_u32 s43, s43, s55
  buffer_load_dwordx4 v3, s[20:23], s42 offen lds
  s_add_u32 m0, s56, 16384
  s_add_u32 s42, s43, s44
  buffer_load_dwordx4 v4, s[24:27], s43 offen lds
  s_add_u32 m0, s56, 17408
  s_lshl_b32 s43, s58, 11
  buffer_load_dwordx4 v4, s[24:27], s42 offen lds
  s_add_u32 m0, s60, 32768
  s_add_u32 s43, s43, s59
  s_mov_b64 exec, s[36:37]
  buffer_load_dwordx4 v6, s[32:35], s43 offen lds
  s_mov_b64 exec, -1
  s_add_u32 s58, s58, 1
  s_and_b32 s58, s58, 7
  s_lshl_b32 s42, s58, 7
  s_add_u32 s42, s42, s54
  s_add_u32 m0, s56, 36864
  s_mul_i32 s43, s58, s45
  buffer_load_dwordx4 v2, s[20:23], s42 offen lds
  s_add_u32 m0, s56, 37888
  s_add_u32 s43, s43, s55
  buffer_load_dwordx4 v3, s[20:23], s42 offen lds
  s_add_u32 m0, s56, 53248
  s_add_u32 s42, s43, s44
  buffer_load_dwordx4 v4, s[24:27], s43 offen lds
  s_add_u32 m0, s56, 54272
  s_lshl_b32 s43, s58, 11
  buffer_load_dwordx4 v4, s[24:27], s42 offen lds
  s_add_u32 m0, s60, 69632
  s_add_u32 s43, s43, s59
  s_mov_b64 exec, s[36:37]
  buffer_load_dwordx4 v6, s[32:35], s43 offen lds
  s_mov_b64 exec, -1
  s_add_u32 s58, s58, 1
  s_and_b32 s58, s58, 7
  v_and_b32 v8, 31, v1
  v_lshrrev_b32 v9, 5, v1
  v_bfe_u32 v10, v1, 1, 3
  v_xor_b32 v9, v9, v10
  v_lshlrev_b32 v9, 4, v9
  v_lshl_add_u32 v8, v8, 7, v9
  s_lshl_b32 s50, s51, 12
  v_add_u32 v8, s50, v8
  v_xor_b32 v12, 0, v8
  v_add_u32 v16, 73728, v12
  v_xor_b32 v13, 32, v8
  v_add_u32 v17, 73728, v13
  v_xor_b32 v14, 64, v8
  v_add_u32 v18, 73728, v14
  v_xor_b32 v15, 96, v8
  v_add_u32 v19, 73728, v15
  v_lshrrev_b32 v8, 5, v1
  v_bfe_u32 v9, v1, 2, 2
  v_lshl_add_u32 v8, v8, 3, v9
  v_bfe_u32 v10, v1, 4, 1
  v_and_b32 v11, 3, v1
  v_lshl_add_u32 v10, v10, 2, v11
  v_lshlrev_b32 v10, 3, v10
  v_lshl_add_u32 v24, v8, 6, v10
  v_add_u32 v24, 32768, v24
  v_add_u32 v25, 73728, v24
  v_lshl_add_u32 v8, v8, 8, v10
  s_lshl_b32 s50, s52, 1
  v_xor_b32 v9, s50, v9
  v_lshl_add_u32 v8, v9, 6, v8
  v_add_u32 v20, 16384, v8
  v_xor_b32 v21, 64, v20
  v_add_u32 v22, 73728, v20
  v_add_u32 v23, 73728, v21
  s_waitcnt vmcnt(5)
  s_barrier
  ds_read_b128 v[28:31], v12 offset:0
  ds_read_b64_tr_b16 v[44:45], v20 offset:0
  ds_read_b64_tr_b16 v[46:47], v20 offset:1024
  ds_read_b64_tr_b16 v[48:49], v21 offset:0
  ds_read_b64_tr_b16 v[50:51], v21 offset:1024
  ds_read_b64_tr_b16 v[76:77], v24 offset:0
  ds_read_b64_tr_b16 v[78:79], v24 offset:256
  ds_read_b128 v[32:35], v13 offset:0
  ds_read_b64_tr_b16 v[52:53], v20 offset:4096
  ds_read_b64_tr_b16 v[54:55], v20 offset:5120
  ds_read_b64_tr_b16 v[56:57], v21 offset:4096
  ds_read_b64_tr_b16 v[58:59], v21 offset:5120
  ds_read_b64_tr_b16 v[80:81], v24 offset:1024
  ds_read_b64_tr_b16 v[82:83], v24 offset:1280
  ds_read_b128 v[36:39], v14 offset:0
  ds_read_b64_tr_b16 v[60:61], v20 offset:8192
  ds_read_b64_tr_b16 v[62:63], v20 offset:9216
  ds_read_b64_tr_b16 v[64:65], v21 offset:8192
  ds_read_b64_tr_b16 v[66:67], v21 offset:9216
  ds_read_b64_tr_b16 v[84:85], v24 offset:2048
  ds_read_b64_tr_b16 v[86:87], v24 offset:2304
  ds_read_b128 v[40:43], v15 offset:0
  ds_read_b64_tr_b16 v[68:69], v20 offset:12288
  ds_read_b64_tr_b16 v[70:71], v20 offset:13312
  ds_read_b64_tr_b16 v[72:73], v21 offset:12288
  ds_read_b64_tr_b16 v[74:75], v21 offset:13312
  ds_read_b64_tr_b16 v[88:89], v24 offset:3072
  ds_read_b64_tr_b16 v[90:91], v24 offset:3328
  s_lshl_b32 s42, s58, 7
  s_add_u32 s42, s42, s54
  s_add_u32 m0, s56, 73728
  s_mul_i32 s43, s58, s45
  buffer_load_dwordx4 v2, s[20:23], s42 offen lds
  s_add_u32 m0, s56, 74752
  s_add_u32 s43, s43, s55
  buffer_load_dwordx4 v3, s[20:23], s42 offen lds
  s_add_u32 m0, s56, 90112
  s_add_u32 s42, s43, s44
  buffer_load_dwordx4 v4, s[24:27], s43 offen lds
  s_add_u32 m0, s56, 91136
  s_lshl_b32 s43, s58, 11
  buffer_load_dwordx4 v4, s[24:27], s42 offen lds
  s_add_u32 m0, s60, 106496
  s_add_u32 s43, s43, s59
  s_mov_b64 exec, s[36:37]
  buffer_load_dwordx4 v6, s[32:35], s43 offen lds
  s_mov_b64 exec, -1
  s_add_u32 s58, s58, 1
  s_and_b32 s58, s58, 7
  s_lshl_b32 s42, s58, 7
  s_add_u32 s42, s42, s54
  s_add_u32 m0, s56, 110592
  s_mul_i32 s43, s58, s45
  buffer_load_dwordx4 v2, s[20:23], s42 offen lds
  s_add_u32 m0, s56, 111616
  s_add_u32 s43, s43, s55
  buffer_load_dwordx4 v3, s[20:23], s42 offen lds
  s_add_u32 m0, s56, 126976
  s_add_u32 s42, s43, s44
  buffer_load_dwordx4 v4, s[24:27], s43 offen lds
  s_add_u32 m0, s56, 128000
  s_lshl_b32 s43, s58, 11
  buffer_load_dwordx4 v4, s[24:27], s42 offen lds
  s_add_u32 m0, s60, 143360
  s_add_u32 s43, s43, s59
  s_mov_b64 exec, s[36:37]
  buffer_load_dwordx4 v6, s[32:35], s43 offen lds
  s_mov_b64 exec, -1
  s_add_u32 s58, s58, 1
  s_and_b32 s58, s58, 7
  s_waitcnt vmcnt(10) lgkmcnt(0)
  s_barrier
  ds_read_b128 v[92:95], v12 offset:36864
  ds_read_b64_tr_b16 v[108:109], v20 offset:36864
  ds_read_b64_tr_b16 v[110:111], v20 offset:37888
  ds_read_b64_tr_b16 v[112:113], v21 offset:36864
  ds_read_b64_tr_b16 v[114:115], v21 offset:37888
  ds_read_b64_tr_b16 v[140:141], v24 offset:36864
  ds_read_b64_tr_b16 v[142:143], v24 offset:37120
  v_mfma_f32_32x32x16_bf16 v[156:171], v[44:47], v[28:31], 0
  v_mfma_f32_32x32x16_bf16 v[172:187], v[48:51], v[28:31], 0
  v_mfma_f32_32x32x16_bf16 v[188:203], v[76:79], v[28:31], 0
  s_lshl_b32 s42, s58, 7
  s_add_u32 s42, s42, s54
  s_add_u32 m0, s56, 0
  s_mul_i32 s43, s58, s45
  buffer_load_dwordx4 v2, s[20:23], s42 offen lds
  ds_read_b128 v[96:99], v13 offset:36864
  ds_read_b64_tr_b16 v[116:117], v20 offset:40960
  ds_read_b64_tr_b16 v[118:119], v20 offset:41984
  ds_read_b64_tr_b16 v[120:121], v21 offset:40960
  ds_read_b64_tr_b16 v[122:123], v21 offset:41984
  ds_read_b64_tr_b16 v[144:145], v24 offset:37888
  ds_read_b64_tr_b16 v[146:147], v24 offset:38144
  v_mfma_f32_32x32x16_bf16 v[156:171], v[52:55], v[32:35], v[156:171]
  v_mfma_f32_32x32x16_bf16 v[172:187], v[56:59], v[32:35], v[172:187]
  v_mfma_f32_32x32x16_bf16 v[188:203], v[80:83], v[32:35], v[188:203]
  s_add_u32 m0, s56, 1024
  s_add_u32 s43, s43, s55
  buffer_load_dwordx4 v3, s[20:23], s42 offen lds
  ds_read_b128 v[100:103], v14 offset:36864
  ds_read_b64_tr_b16 v[124:125], v20 offset:45056
  ds_read_b64_tr_b16 v[126:127], v20 offset:46080
  ds_read_b64_tr_b16 v[128:129], v21 offset:45056
  ds_read_b64_tr_b16 v[130:131], v21 offset:46080
  ds_read_b64_tr_b16 v[148:149], v24 offset:38912
  ds_read_b64_tr_b16 v[150:151], v24 offset:39168
  v_mfma_f32_32x32x16_bf16 v[156:171], v[60:63], v[36:39], v[156:171]
  v_mfma_f32_32x32x16_bf16 v[172:187], v[64:67], v[36:39], v[172:187]
  v_mfma_f32_32x32x16_bf16 v[188:203], v[84:87], v[36:39], v[188:203]
  s_add_u32 m0, s56, 16384
  s_add_u32 s42, s43, s44
  buffer_load_dwordx4 v4, s[24:27], s43 offen lds
  ds_read_b128 v[104:107], v15 offset:36864
  ds_read_b64_tr_b16 v[132:133], v20 offset:49152
  ds_read_b64_tr_b16 v[134:135], v20 offset:50176
  ds_read_b64_tr_b16 v[136:137], v21 offset:49152
  ds_read_b64_tr_b16 v[138:139], v21 offset:50176
  ds_read_b64_tr_b16 v[152:153], v24 offset:39936
  ds_read_b64_tr_b16 v[154:155], v24 offset:40192
  v_mfma_f32_32x32x16_bf16 v[156:171], v[68:71], v[40:43], v[156:171]
  v_mfma_f32_32x32x16_bf16 v[172:187], v[72:75], v[40:43], v[172:187]
  v_mfma_f32_32x32x16_bf16 v[188:203], v[88:91], v[40:43], v[188:203]
  s_add_u32 m0, s56, 17408
  s_lshl_b32 s43, s58, 11
  buffer_load_dwordx4 v4, s[24:27], s42 offen lds
  s_add_u32 m0, s60, 32768
  s_add_u32 s43, s43, s59
  s_mov_b64 exec, s[36:37]
  buffer_load_dwordx4 v6, s[32:35], s43 offen lds
  s_mov_b64 exec, -1
  s_add_u32 s58, s58, 1
  s_and_b32 s58, s58, 7
  s_waitcnt vmcnt(10) lgkmcnt(0)
  s_barrier
  ds_read_b128 v[28:31], v16 offset:0
  ds_read_b64_tr_b16 v[44:45], v22 offset:0
  ds_read_b64_tr_b16 v[46:47], v22 offset:1024
  ds_read_b64_tr_b16 v[48:49], v23 offset:0
  ds_read_b64_tr_b16 v[50:51], v23 offset:1024
  ds_read_b64_tr_b16 v[76:77], v25 offset:0
  ds_read_b64_tr_b16 v[78:79], v25 offset:256
  v_mfma_f32_32x32x16_bf16 v[156:171], v[108:111], v[92:95], v[156:171]
  v_mfma_f32_32x32x16_bf16 v[172:187], v[112:115], v[92:95], v[172:187]
  v_mfma_f32_32x32x16_bf16 v[188:203], v[140:143], v[92:95], v[188:203]
  s_lshl_b32 s42, s58, 7
  s_add_u32 s42, s42, s54
  s_add_u32 m0, s56, 36864
  s_mul_i32 s43, s58, s45
  buffer_load_dwordx4 v2, s[20:23], s42 offen lds
  ds_read_b128 v[32:35], v17 offset:0
  ds_read_b64_tr_b16 v[52:53], v22 offset:4096
  ds_read_b64_tr_b16 v[54:55], v22 offset:5120
  ds_read_b64_tr_b16 v[56:57], v23 offset:4096
  ds_read_b64_tr_b16 v[58:59], v23 offset:5120
  ds_read_b64_tr_b16 v[80:81], v25 offset:1024
  ds_read_b64_tr_b16 v[82:83], v25 offset:1280
  v_mfma_f32_32x32x16_bf16 v[156:171], v[116:119], v[96:99], v[156:171]
  v_mfma_f32_32x32x16_bf16 v[172:187], v[120:123], v[96:99], v[172:187]
  v_mfma_f32_32x32x16_bf16 v[188:203], v[144:147], v[96:99], v[188:203]
  s_add_u32 m0, s56, 37888
  s_add_u32 s43, s43, s55
  buffer_load_dwordx4 v3, s[20:23], s42 offen lds
  ds_read_b128 v[36:39], v18 offset:0
  ds_read_b64_tr_b16 v[60:61], v22 offset:8192
  ds_read_b64_tr_b16 v[62:63], v22 offset:9216
  ds_read_b64_tr_b16 v[64:65], v23 offset:8192
  ds_read_b64_tr_b16 v[66:67], v23 offset:9216
  ds_read_b64_tr_b16 v[84:85], v25 offset:2048
  ds_read_b64_tr_b16 v[86:87], v25 offset:2304
  v_mfma_f32_32x32x16_bf16 v[156:171], v[124:127], v[100:103], v[156:171]
  v_mfma_f32_32x32x16_bf16 v[172:187], v[128:131], v[100:103], v[172:187]
  v_mfma_f32_32x32x16_bf16 v[188:203], v[148:151], v[100:103], v[188:203]
  s_add_u32 m0, s56, 53248
  s_add_u32 s42, s43, s44
  buffer_load_dwordx4 v4, s[24:27], s43 offen lds
  ds_read_b128 v[40:43], v19 offset:0
  ds_read_b64_tr_b16 v[68:69], v22 offset:12288
  ds_read_b64_tr_b16 v[70:71], v22 offset:13312
  ds_read_b64_tr_b16 v[72:73], v23 offset:12288
  ds_read_b64_tr_b16 v[74:75], v23 offset:13312
  ds_read_b64_tr_b16 v[88:89], v25 offset:3072
  ds_read_b64_tr_b16 v[90:91], v25 offset:3328
  v_mfma_f32_32x32x16_bf16 v[156:171], v[132:135], v[104:107], v[156:171]
  v_mfma_f32_32x32x16_bf16 v[172:187], v[136:139], v[104:107], v[172:187]
  v_mfma_f32_32x32x16_bf16 v[188:203], v[152:155], v[104:107], v[188:203]
  s_add_u32 m0, s56, 54272
  s_lshl_b32 s43, s58, 11
  buffer_load_dwordx4 v4, s[24:27], s42 offen lds
  s_add_u32 m0, s60, 69632
  s_add_u32 s43, s43, s59
  s_mov_b64 exec, s[36:37]
  buffer_load_dwordx4 v6, s[32:35], s43 offen lds
  s_mov_b64 exec, -1
  s_add_u32 s58, s58, 1
  s_and_b32 s58, s58, 7
  s_waitcnt vmcnt(10) lgkmcnt(0)
  s_barrier
  ds_read_b128 v[92:95], v16 offset:36864
  ds_read_b64_tr_b16 v[108:109], v22 offset:36864
  ds_read_b64_tr_b16 v[110:111], v22 offset:37888
  ds_read_b64_tr_b16 v[112:113], v23 offset:36864
  ds_read_b64_tr_b16 v[114:115], v23 offset:37888
  ds_read_b64_tr_b16 v[140:141], v25 offset:36864
  ds_read_b64_tr_b16 v[142:143], v25 offset:37120
  v_mfma_f32_32x32x16_bf16 v[156:171], v[44:47], v[28:31], v[156:171]
  v_mfma_f32_32x32x16_bf16 v[172:187], v[48:51], v[28:31], v[172:187]
  v_mfma_f32_32x32x16_bf16 v[188:203], v[76:79], v[28:31], v[188:203]
  s_lshl_b32 s42, s58, 7
  s_add_u32 s42, s42, s54
  s_add_u32 m0, s56, 73728
  s_mul_i32 s43, s58, s45
  buffer_load_dwordx4 v2, s[20:23], s42 offen lds
  ds_read_b128 v[96:99], v17 offset:36864
  ds_read_b64_tr_b16 v[116:117], v22 offset:40960
  ds_read_b64_tr_b16 v[118:119], v22 offset:41984
  ds_read_b64_tr_b16 v[120:121], v23 offset:40960
  ds_read_b64_tr_b16 v[122:123], v23 offset:41984
  ds_read_b64_tr_b16 v[144:145], v25 offset:37888
  ds_read_b64_tr_b16 v[146:147], v25 offset:38144
  v_mfma_f32_32x32x16_bf16 v[156:171], v[52:55], v[32:35], v[156:171]
  v_mfma_f32_32x32x16_bf16 v[172:187], v[56:59], v[32:35], v[172:187]
  v_mfma_f32_32x32x16_bf16 v[188:203], v[80:83], v[32:35], v[188:203]
  s_add_u32 m0, s56, 74752
  s_add_u32 s43, s43, s55
  buffer_load_dwordx4 v3, s[20:23], s42 offen lds
  ds_read_b128 v[100:103], v18 offset:36864
  ds_read_b64_tr_b16 v[124:125], v22 offset:45056
  ds_read_b64_tr_b16 v[126:127], v22 offset:46080
  ds_read_b64_tr_b16 v[128:129], v23 offset:45056
  ds_read_b64_tr_b16 v[130:131], v23 offset:46080
  ds_read_b64_tr_b16 v[148:149], v25 offset:38912
  ds_read_b64_tr_b16 v[150:151], v25 offset:39168
  v_mfma_f32_32x32x16_bf16 v[156:171], v[60:63], v[36:39], v[156:171]
  v_mfma_f32_32x32x16_bf16 v[172:187], v[64:67], v[36:39], v[172:187]
  v_mfma_f32_32x32x16_bf16 v[188:203], v[84:87], v[36:39], v[188:203]
  s_add_u32 m0, s56, 90112
  s_add_u32 s42, s43, s44
  buffer_load_dwordx4 v4, s[24:27], s43 offen lds
  ds_read_b128 v[104:107], v19 offset:36864
  ds_read_b64_tr_b16 v[132:133], v22 offset:49152
  ds_read_b64_tr_b16 v[134:135], v22 offset:50176
  ds_read_b64_tr_b16 v[136:137], v23 offset:49152
  ds_read_b64_tr_b16 v[138:139], v23 offset:50176
  ds_read_b64_tr_b16 v[152:153], v25 offset:39936
  ds_read_b64_tr_b16 v[154:155], v25 offset:40192
  v_mfma_f32_32x32x16_bf16 v[156:171], v[68:71], v[40:43], v[156:171]
  v_mfma_f32_32x32x16_bf16 v[172:187], v[72:75], v[40:43], v[172:187]
  v_mfma_f32_32x32x16_bf16 v[188:203], v[88:91], v[40:43], v[188:203]
  s_add_u32 m0, s56, 91136
  s_lshl_b32 s43, s58, 11
  buffer_load_dwordx4 v4, s[24:27], s42 offen lds
  s_add_u32 m0, s60, 106496
  s_add_u32 s43, s43, s59
  s_mov_b64 exec, s[36:37]
  buffer_load_dwordx4 v6, s[32:35], s43 offen lds
  s_mov_b64 exec, -1
  s_add_u32 s58, s58, 1
  s_and_b32 s58, s58, 7
  s_waitcnt vmcnt(10) lgkmcnt(0)
  s_barrier
  ds_read_b128 v[28:31], v12 offset:0
  ds_read_b64_tr_b16 v[44:45], v20 offset:0
  ds_read_b64_tr_b16 v[46:47], v20 offset:1024
  ds_read_b64_tr_b16 v[48:49], v21 offset:0
  ds_read_b64_tr_b16 v[50:51], v21 offset:1024
  ds_read_b64_tr_b16 v[76:77], v24 offset:0
  ds_read_b64_tr_b16 v[78:79], v24 offset:256
  v_mfma_f32_32x32x16_bf16 v[156:171], v[108:111], v[92:95], v[156:171]
  v_mfma_f32_32x32x16_bf16 v[172:187], v[112:115], v[92:95], v[172:187]
  v_mfma_f32_32x32x16_bf16 v[188:203], v[140:143], v[92:95], v[188:203]
  s_lshl_b32 s42, s58, 7
  s_add_u32 s42, s42, s54
  s_add_u32 m0, s56, 110592
  s_mul_i32 s43, s58, s45
  buffer_load_dwordx4 v2, s[20:23], s42 offen lds
  ds_read_b128 v[32:35], v13 offset:0
  ds_read_b64_tr_b16 v[52:53], v20 offset:4096
  ds_read_b64_tr_b16 v[54:55], v20 offset:5120
  ds_read_b64_tr_b16 v[56:57], v21 offset:4096
  ds_read_b64_tr_b16 v[58:59], v21 offset:5120
  ds_read_b64_tr_b16 v[80:81], v24 offset:1024
  ds_read_b64_tr_b16 v[82:83], v24 offset:1280
  v_mfma_f32_32x32x16_bf16 v[156:171], v[116:119], v[96:99], v[156:171]
  v_mfma_f32_32x32x16_bf16 v[172:187], v[120:123], v[96:99], v[172:187]
  v_mfma_f32_32x32x16_bf16 v[188:203], v[144:147], v[96:99], v[188:203]
  s_add_u32 m0, s56, 111616
  s_add_u32 s43, s43, s55
  buffer_load_dwordx4 v3, s[20:23], s42 offen lds
  ds_read_b128 v[36:39], v14 offset:0
  ds_read_b64_tr_b16 v[60:61], v20 offset:8192
  ds_read_b64_tr_b16 v[62:63], v20 offset:9216
  ds_read_b64_tr_b16 v[64:65], v21 offset:8192
  ds_read_b64_tr_b16 v[66:67], v21 offset:9216
  ds_read_b64_tr_b16 v[84:85], v24 offset:2048
  ds_read_b64_tr_b16 v[86:87], v24 offset:2304
  v_mfma_f32_32x32x16_bf16 v[156:171], v[124:127], v[100:103], v[156:171]
  v_mfma_f32_32x32x16_bf16 v[172:187], v[128:131], v[100:103], v[172:187]
  v_mfma_f32_32x32x16_bf16 v[188:203], v[148:151], v[100:103], v[188:203]
  s_add_u32 m0, s56, 126976
  s_add_u32 s42, s43, s44
  buffer_load_dwordx4 v4, s[24:27], s43 offen lds
  ds_read_b128 v[40:43], v15 offset:0
  ds_read_b64_tr_b16 v[68:69], v20 offset:12288
  ds_read_b64_tr_b16 v[70:71], v20 offset:13312
  ds_read_b64_tr_b16 v[72:73], v21 offset:12288
  ds_read_b64_tr_b16 v[74:75], v21 offset:13312
  ds_read_b64_tr_b16 v[88:89], v24 offset:3072
  ds_read_b64_tr_b16 v[90:91], v24 offset:3328
  v_mfma_f32_32x32x16_bf16 v[156:171], v[132:135], v[104:107], v[156:171]
  v_mfma_f32_32x32x16_bf16 v[172:187], v[136:139], v[104:107], v[172:187]
  v_mfma_f32_32x32x16_bf16 v[188:203], v[152:155], v[104:107], v[188:203]
  s_add_u32 m0, s56, 128000
  s_lshl_b32 s43, s58, 11
  buffer_load_dwordx4 v4, s[24:27], s42 offen lds
  s_add_u32 m0, s60, 143360
  s_add_u32 s43, s43, s59
  s_mov_b64 exec, s[36:37]
  buffer_load_dwordx4 v6, s[32:35], s43 offen lds
  s_mov_b64 exec, -1
  s_add_u32 s58, s58, 1
  s_and_b32 s58, s58, 7
  s_waitcnt vmcnt(10) lgkmcnt(0)
  s_barrier
  ds_read_b128 v[92:95], v12 offset:36864
  ds_read_b64_tr_b16 v[108:109], v20 offset:36864
  ds_read_b64_tr_b16 v[110:111], v20 offset:37888
  ds_read_b64_tr_b16 v[112:113], v21 offset:36864
  ds_read_b64_tr_b16 v[114:115], v21 offset:37888
  ds_read_b64_tr_b16 v[140:141], v24 offset:36864
  ds_read_b64_tr_b16 v[142:143], v24 offset:37120
  v_mfma_f32_32x32x16_bf16 v[156:171], v[44:47], v[28:31], v[156:171]
  v_mfma_f32_32x32x16_bf16 v[172:187], v[48:51], v[28:31], v[172:187]
  v_mfma_f32_32x32x16_bf16 v[188:203], v[76:79], v[28:31], v[188:203]
  ds_read_b128 v[96:99], v13 offset:36864
  ds_read_b64_tr_b16 v[116:117], v20 offset:40960
  ds_read_b64_tr_b16 v[118:119], v20 offset:41984
  ds_read_b64_tr_b16 v[120:121], v21 offset:40960
  ds_read_b64_tr_b16 v[122:123], v21 offset:41984
  ds_read_b64_tr_b16 v[144:145], v24 offset:37888
  ds_read_b64_tr_b16 v[146:147], v24 offset:38144
  v_mfma_f32_32x32x16_bf16 v[156:171], v[52:55], v[32:35], v[156:171]
  v_mfma_f32_32x32x16_bf16 v[172:187], v[56:59], v[32:35], v[172:187]
  v_mfma_f32_32x32x16_bf16 v[188:203], v[80:83], v[32:35], v[188:203]
  ds_read_b128 v[100:103], v14 offset:36864
  ds_read_b64_tr_b16 v[124:125], v20 offset:45056
  ds_read_b64_tr_b16 v[126:127], v20 offset:46080
  ds_read_b64_tr_b16 v[128:129], v21 offset:45056
  ds_read_b64_tr_b16 v[130:131], v21 offset:46080
  ds_read_b64_tr_b16 v[148:149], v24 offset:38912
  ds_read_b64_tr_b16 v[150:151], v24 offset:39168
  v_mfma_f32_32x32x16_bf16 v[156:171], v[60:63], v[36:39], v[156:171]
  v_mfma_f32_32x32x16_bf16 v[172:187], v[64:67], v[36:39], v[172:187]
  v_mfma_f32_32x32x16_bf16 v[188:203], v[84:87], v[36:39], v[188:203]
  ds_read_b128 v[104:107], v15 offset:36864
  ds_read_b64_tr_b16 v[132:133], v20 offset:49152
  ds_read_b64_tr_b16 v[134:135], v20 offset:50176
  ds_read_b64_tr_b16 v[136:137], v21 offset:49152
  ds_read_b64_tr_b16 v[138:139], v21 offset:50176
  ds_read_b64_tr_b16 v[152:153], v24 offset:39936
  ds_read_b64_tr_b16 v[154:155], v24 offset:40192
  v_mfma_f32_32x32x16_bf16 v[156:171], v[68:71], v[40:43], v[156:171]
  v_mfma_f32_32x32x16_bf16 v[172:187], v[72:75], v[40:43], v[172:187]
  v_mfma_f32_32x32x16_bf16 v[188:203], v[88:91], v[40:43], v[188:203]
  s_waitcnt vmcnt(5) lgkmcnt(0)
  s_barrier
  ds_read_b128 v[28:31], v16 offset:0
  ds_read_b64_tr_b16 v[44:45], v22 offset:0
  ds_read_b64_tr_b16 v[46:47], v22 offset:1024
  ds_read_b64_tr_b16 v[48:49], v23 offset:0
  ds_read_b64_tr_b16 v[50:51], v23 offset:1024
  ds_read_b64_tr_b16 v[76:77], v25 offset:0
  ds_read_b64_tr_b16 v[78:79], v25 offset:256
  v_mfma_f32_32x32x16_bf16 v[156:171], v[108:111], v[92:95], v[156:171]
  v_mfma_f32_32x32x16_bf16 v[172:187], v[112:115], v[92:95], v[172:187]
  v_mfma_f32_32x32x16_bf16 v[188:203], v[140:143], v[92:95], v[188:203]
  ds_read_b128 v[32:35], v17 offset:0
  ds_read_b64_tr_b16 v[52:53], v22 offset:4096
  ds_read_b64_tr_b16 v[54:55], v22 offset:5120
  ds_read_b64_tr_b16 v[56:57], v23 offset:4096
  ds_read_b64_tr_b16 v[58:59], v23 offset:5120
  ds_read_b64_tr_b16 v[80:81], v25 offset:1024
  ds_read_b64_tr_b16 v[82:83], v25 offset:1280
  v_mfma_f32_32x32x16_bf16 v[156:171], v[116:119], v[96:99], v[156:171]
  v_mfma_f32_32x32x16_bf16 v[172:187], v[120:123], v[96:99], v[172:187]
  v_mfma_f32_32x32x16_bf16 v[188:203], v[144:147], v[96:99], v[188:203]
  ds_read_b128 v[36:39], v18 offset:0
  ds_read_b64_tr_b16 v[60:61], v22 offset:8192
  ds_read_b64_tr_b16 v[62:63], v22 offset:9216
  ds_read_b64_tr_b16 v[64:65], v23 offset:8192
  ds_read_b64_tr_b16 v[66:67], v23 offset:9216
  ds_read_b64_tr_b16 v[84:85], v25 offset:2048
  ds_read_b64_tr_b16 v[86:87], v25 offset:2304
  v_mfma_f32_32x32x16_bf16 v[156:171], v[124:127], v[100:103], v[156:171]
  v_mfma_f32_32x32x16_bf16 v[172:187], v[128:131], v[100:103], v[172:187]
  v_mfma_f32_32x32x16_bf16 v[188:203], v[148:151], v[100:103], v[188:203]
  ds_read_b128 v[40:43], v19 offset:0
  ds_read_b64_tr_b16 v[68:69], v22 offset:12288
  ds_read_b64_tr_b16 v[70:71], v22 offset:13312
  ds_read_b64_tr_b16 v[72:73], v23 offset:12288
  ds_read_b64_tr_b16 v[74:75], v23 offset:13312
  ds_read_b64_tr_b16 v[88:89], v25 offset:3072
  ds_read_b64_tr_b16 v[90:91], v25 offset:3328
  v_mfma_f32_32x32x16_bf16 v[156:171], v[132:135], v[104:107], v[156:171]
  v_mfma_f32_32x32x16_bf16 v[172:187], v[136:139], v[104:107], v[172:187]
  v_mfma_f32_32x32x16_bf16 v[188:203], v[152:155], v[104:107], v[188:203]
  s_waitcnt vmcnt(0) lgkmcnt(0)
  s_barrier
  ds_read_b128 v[92:95], v16 offset:36864
  ds_read_b64_tr_b16 v[108:109], v22 offset:36864
  ds_read_b64_tr_b16 v[110:111], v22 offset:37888
  ds_read_b64_tr_b16 v[112:113], v23 offset:36864
  ds_read_b64_tr_b16 v[114:115], v23 offset:37888
  ds_read_b64_tr_b16 v[140:141], v25 offset:36864
  ds_read_b64_tr_b16 v[142:143], v25 offset:37120
  v_mfma_f32_32x32x16_bf16 v[156:171], v[44:47], v[28:31], v[156:171]
  v_mfma_f32_32x32x16_bf16 v[172:187], v[48:51], v[28:31], v[172:187]
  v_mfma_f32_32x32x16_bf16 v[188:203], v[76:79], v[28:31], v[188:203]
  ds_read_b128 v[96:99], v17 offset:36864
  ds_read_b64_tr_b16 v[116:117], v22 offset:40960
  ds_read_b64_tr_b16 v[118:119], v22 offset:41984
  ds_read_b64_tr_b16 v[120:121], v23 offset:40960
  ds_read_b64_tr_b16 v[122:123], v23 offset:41984
  ds_read_b64_tr_b16 v[144:145], v25 offset:37888
  ds_read_b64_tr_b16 v[146:147], v25 offset:38144
  v_mfma_f32_32x32x16_bf16 v[156:171], v[52:55], v[32:35], v[156:171]
  v_mfma_f32_32x32x16_bf16 v[172:187], v[56:59], v[32:35], v[172:187]
  v_mfma_f32_32x32x16_bf16 v[188:203], v[80:83], v[32:35], v[188:203]
  ds_read_b128 v[100:103], v18 offset:36864
  ds_read_b64_tr_b16 v[124:125], v22 offset:45056
  ds_read_b64_tr_b16 v[126:127], v22 offset:46080
  ds_read_b64_tr_b16 v[128:129], v23 offset:45056
  ds_read_b64_tr_b16 v[130:131], v23 offset:46080
  ds_read_b64_tr_b16 v[148:149], v25 offset:38912
  ds_read_b64_tr_b16 v[150:151], v25 offset:39168
  v_mfma_f32_32x32x16_bf16 v[156:171], v[60:63], v[36:39], v[156:171]
  v_mfma_f32_32x32x16_bf16 v[172:187], v[64:67], v[36:39], v[172:187]
  v_mfma_f32_32x32x16_bf16 v[188:203], v[84:87], v[36:39], v[188:203]
  ds_read_b128 v[104:107], v19 offset:36864
  ds_read_b64_tr_b16 v[132:133], v22 offset:49152
  ds_read_b64_tr_b16 v[134:135], v22 offset:50176
  ds_read_b64_tr_b16 v[136:137], v23 offset:49152
  ds_read_b64_tr_b16 v[138:139], v23 offset:50176
  ds_read_b64_tr_b16 v[152:153], v25 offset:39936
  ds_read_b64_tr_b16 v[154:155], v25 offset:40192
  v_mfma_f32_32x32x16_bf16 v[156:171], v[68:71], v[40:43], v[156:171]
  v_mfma_f32_32x32x16_bf16 v[172:187], v[72:75], v[40:43], v[172:187]
  v_mfma_f32_32x32x16_bf16 v[188:203], v[88:91], v[40:43], v[188:203]
  s_waitcnt lgkmcnt(0)
  v_mfma_f32_32x32x16_bf16 v[156:171], v[108:111], v[92:95], v[156:171]
  v_mfma_f32_32x32x16_bf16 v[172:187], v[112:115], v[92:95], v[172:187]
  v_mfma_f32_32x32x16_bf16 v[188:203], v[140:143], v[92:95], v[188:203]
  v_mfma_f32_32x32x16_bf16 v[156:171], v[116:119], v[96:99], v[156:171]
  v_mfma_f32_32x32x16_bf16 v[172:187], v[120:123], v[96:99], v[172:187]
  v_mfma_f32_32x32x16_bf16 v[188:203], v[144:147], v[96:99], v[188:203]
  v_mfma_f32_32x32x16_bf16 v[156:171], v[124:127], v[100:103], v[156:171]
  v_mfma_f32_32x32x16_bf16 v[172:187], v[128:131], v[100:103], v[172:187]
  v_mfma_f32_32x32x16_bf16 v[188:203], v[148:151], v[100:103], v[188:203]
  v_mfma_f32_32x32x16_bf16 v[156:171], v[132:135], v[104:107], v[156:171]
  v_mfma_f32_32x32x16_bf16 v[172:187], v[136:139], v[104:107], v[172:187]
  v_mfma_f32_32x32x16_bf16 v[188:203], v[152:155], v[104:107], v[188:203]
  s_nop 15
  s_lshl_b32 s50, s57, 11
  s_add_u32 s50, s50, 8388608
  v_lshlrev_b32 v10, 4, v1
  v_cvt_pk_bf16_f32 v44, v188, v189
  v_cvt_pk_bf16_f32 v45, v190, v191
  v_cvt_pk_bf16_f32 v46, v192, v193
  v_cvt_pk_bf16_f32 v47, v194, v195
  buffer_store_dwordx4 v[44:47], v10, s[28:31], s50 offen sc0 sc1
  s_branch proj_T_epi
proj_T_none:
  s_lshl_b32 s42, s58, 7
  s_add_u32 s42, s42, s54
  s_add_u32 m0, s56, 0
  s_mul_i32 s43, s58, s45
  buffer_load_dwordx4 v2, s[20:23], s42 offen lds
  s_add_u32 m0, s56, 1024
  s_add_u32 s43, s43, s55
  buffer_load_dwordx4 v3, s[20:23], s42 offen lds
  s_add_u32 m0, s56, 16384
  s_add_u32 s42, s43, s44
  buffer_load_dwordx4 v4, s[24:27], s43 offen lds
  s_add_u32 m0, s56, 17408
  s_lshl_b32 s43, s58, 11
  buffer_load_dwordx4 v4, s[24:27], s42 offen lds
  s_add_u32 m0, s60, 32768
  s_add_u32 s43, s43, s59
  s_mov_b64 exec, s[36:37]
  buffer_load_dwordx4 v6, s[32:35], s43 offen lds
  s_mov_b64 exec, -1
  s_add_u32 s58, s58, 1
  s_and_b32 s58, s58, 7
  s_lshl_b32 s42, s58, 7
  s_add_u32 s42, s42, s54
  s_add_u32 m0, s56, 36864
  s_mul_i32 s43, s58, s45
  buffer_load_dwordx4 v2, s[20:23], s42 offen lds
  s_add_u32 m0, s56, 37888
  s_add_u32 s43, s43, s55
  buffer_load_dwordx4 v3, s[20:23], s42 offen lds
  s_add_u32 m0, s56, 53248
  s_add_u32 s42, s43, s44
  buffer_load_dwordx4 v4, s[24:27], s43 offen lds
  s_add_u32 m0, s56, 54272
  s_lshl_b32 s43, s58, 11
  buffer_load_dwordx4 v4, s[24:27], s42 offen lds
  s_add_u32 m0, s60, 69632
  s_add_u32 s43, s43, s59
  s_mov_b64 exec, s[36:37]
  buffer_load_dwordx4 v6, s[32:35], s43 offen lds
  s_mov_b64 exec, -1
  s_add_u32 s58, s58, 1
  s_and_b32 s58, s58, 7
  v_and_b32 v8, 31, v1
  v_lshrrev_b32 v9, 5, v1
  v_bfe_u32 v10, v1, 1, 3
  v_xor_b32 v9, v9, v10
  v_lshlrev_b32 v9, 4, v9
  v_lshl_add_u32 v8, v8, 7, v9
  s_lshl_b32 s50, s51, 12
  v_add_u32 v8, s50, v8
  v_xor_b32 v12, 0, v8
  v_add_u32 v16, 73728, v12
  v_xor_b32 v13, 32, v8
  v_add_u32 v17, 73728, v13
  v_xor_b32 v14, 64, v8
  v_add_u32 v18, 73728, v14
  v_xor_b32 v15, 96, v8
  v_add_u32 v19, 73728, v15
  v_lshrrev_b32 v8, 5, v1
  v_bfe_u32 v9, v1, 2, 2
  v_lshl_add_u32 v8, v8, 3, v9
  v_bfe_u32 v10, v1, 4, 1
  v_and_b32 v11, 3, v1
  v_lshl_add_u32 v10, v10, 2, v11
  v_lshlrev_b32 v10, 3, v10
  v_lshl_add_u32 v24, v8, 6, v10
  v_add_u32 v24, 32768, v24
  v_add_u32 v25, 73728, v24
  v_lshl_add_u32 v8, v8, 8, v10
  s_lshl_b32 s50, s52, 1
  v_xor_b32 v9, s50, v9
  v_lshl_add_u32 v8, v9, 6, v8
  v_add_u32 v20, 16384, v8
  v_xor_b32 v21, 64, v20
  v_add_u32 v22, 73728, v20
  v_add_u32 v23, 73728, v21
  s_waitcnt vmcnt(5)
  s_barrier
  ds_read_b128 v[28:31], v12 offset:0
  ds_read_b64_tr_b16 v[44:45], v20 offset:0
  ds_read_b64_tr_b16 v[46:47], v20 offset:1024
  ds_read_b64_tr_b16 v[48:49], v21 offset:0
  ds_read_b64_tr_b16 v[50:51], v21 offset:1024
  ds_read_b128 v[32:35], v13 offset:0
  ds_read_b64_tr_b16 v[52:53], v20 offset:4096
  ds_read_b64_tr_b16 v[54:55], v20 offset:5120
  ds_read_b64_tr_b16 v[56:57], v21 offset:4096
  ds_read_b64_tr_b16 v[58:59], v21 offset:5120
  ds_read_b128 v[36:39], v14 offset:0
  ds_read_b64_tr_b16 v[60:61], v20 offset:8192
  ds_read_b64_tr_b16 v[62:63], v20 offset:9216
  ds_read_b64_tr_b16 v[64:65], v21 offset:8192
  ds_read_b64_tr_b16 v[66:67], v21 offset:9216
  ds_read_b128 v[40:43], v15 offset:0
  ds_read_b64_tr_b16 v[68:69], v20 offset:12288
  ds_read_b64_tr_b16 v[70:71], v20 offset:13312
  ds_read_b64_tr_b16 v[72:73], v21 offset:12288
  ds_read_b64_tr_b16 v[74:75], v21 offset:13312
  s_lshl_b32 s42, s58, 7
  s_add_u32 s42, s42, s54
  s_add_u32 m0, s56, 73728
  s_mul_i32 s43, s58, s45
  buffer_load_dwordx4 v2, s[20:23], s42 offen lds
  s_add_u32 m0, s56, 74752
  s_add_u32 s43, s43, s55
  buffer_load_dwordx4 v3, s[20:23], s42 offen lds
  s_add_u32 m0, s56, 90112
  s_add_u32 s42, s43, s44
  buffer_load_dwordx4 v4, s[24:27], s43 offen lds
  s_add_u32 m0, s56, 91136
  s_lshl_b32 s43, s58, 11
  buffer_load_dwordx4 v4, s[24:27], s42 offen lds
  s_add_u32 m0, s60, 106496
  s_add_u32 s43, s43, s59
  s_mov_b64 exec, s[36:37]
  buffer_load_dwordx4 v6, s[32:35], s43 offen lds
  s_mov_b64 exec, -1
  s_add_u32 s58, s58, 1
  s_and_b32 s58, s58, 7
  s_lshl_b32 s42, s58, 7
  s_add_u32 s42, s42, s54
  s_add_u32 m0, s56, 110592
  s_mul_i32 s43, s58, s45
  buffer_load_dwordx4 v2, s[20:23], s42 offen lds
  s_add_u32 m0, s56, 111616
  s_add_u32 s43, s43, s55
  buffer_load_dwordx4 v3, s[20:23], s42 offen lds
  s_add_u32 m0, s56, 126976
  s_add_u32 s42, s43, s44
  buffer_load_dwordx4 v4, s[24:27], s43 offen lds
  s_add_u32 m0, s56, 128000
  s_lshl_b32 s43, s58, 11
  buffer_load_dwordx4 v4, s[24:27], s42 offen lds
  s_add_u32 m0, s60, 143360
  s_add_u32 s43, s43, s59
  s_mov_b64 exec, s[36:37]
  buffer_load_dwordx4 v6, s[32:35], s43 offen lds
  s_mov_b64 exec, -1
  s_add_u32 s58, s58, 1
  s_and_b32 s58, s58, 7
  s_waitcnt vmcnt(10) lgkmcnt(0)
  s_barrier
  ds_read_b128 v[92:95], v12 offset:36864
  ds_read_b64_tr_b16 v[108:109], v20 offset:36864
  ds_read_b64_tr_b16 v[110:111], v20 offset:37888
  ds_read_b64_tr_b16 v[112:113], v21 offset:36864
  ds_read_b64_tr_b16 v[114:115], v21 offset:37888
  v_mfma_f32_32x32x16_bf16 v[156:171], v[44:47], v[28:31], 0
  v_mfma_f32_32x32x16_bf16 v[172:187], v[48:51], v[28:31], 0
  s_lshl_b32 s42, s58, 7
  s_add_u32 s42, s42, s54
  s_add_u32 m0, s56, 0
  s_mul_i32 s43, s58, s45
  buffer_load_dwordx4 v2, s[20:23], s42 offen lds
  ds_read_b128 v[96:99], v13 offset:36864
  ds_read_b64_tr_b16 v[116:117], v20 offset:40960
  ds_read_b64_tr_b16 v[118:119], v20 offset:41984
  ds_read_b64_tr_b16 v[120:121], v21 offset:40960
  ds_read_b64_tr_b16 v[122:123], v21 offset:41984
  v_mfma_f32_32x32x16_bf16 v[156:171], v[52:55], v[32:35], v[156:171]
  v_mfma_f32_32x32x16_bf16 v[172:187], v[56:59], v[32:35], v[172:187]
  s_add_u32 m0, s56, 1024
  s_add_u32 s43, s43, s55
  buffer_load_dwordx4 v3, s[20:23], s42 offen lds
  ds_read_b128 v[100:103], v14 offset:36864
  ds_read_b64_tr_b16 v[124:125], v20 offset:45056
  ds_read_b64_tr_b16 v[126:127], v20 offset:46080
  ds_read_b64_tr_b16 v[128:129], v21 offset:45056
  ds_read_b64_tr_b16 v[130:131], v21 offset:46080
  v_mfma_f32_32x32x16_bf16 v[156:171], v[60:63], v[36:39], v[156:171]
  v_mfma_f32_32x32x16_bf16 v[172:187], v[64:67], v[36:39], v[172:187]
  s_add_u32 m0, s56, 16384
  s_add_u32 s42, s43, s44
  buffer_load_dwordx4 v4, s[24:27], s43 offen lds
  ds_read_b128 v[104:107], v15 offset:36864
  ds_read_b64_tr_b16 v[132:133], v20 offset:49152
  ds_read_b64_tr_b16 v[134:135], v20 offset:50176
  ds_read_b64_tr_b16 v[136:137], v21 offset:49152
  ds_read_b64_tr_b16 v[138:139], v21 offset:50176
  v_mfma_f32_32x32x16_bf16 v[156:171], v[68:71], v[40:43], v[156:171]
  v_mfma_f32_32x32x16_bf16 v[172:187], v[72:75], v[40:43], v[172:187]
  s_add_u32 m0, s56, 17408
  s_lshl_b32 s43, s58, 11
  buffer_load_dwordx4 v4, s[24:27], s42 offen lds
  s_add_u32 m0, s60, 32768
  s_add_u32 s43, s43, s59
  s_mov_b64 exec, s[36:37]
  buffer_load_dwordx4 v6, s[32:35], s43 offen lds
  s_mov_b64 exec, -1
  s_add_u32 s58, s58, 1
  s_and_b32 s58, s58, 7
  s_waitcnt vmcnt(10) lgkmcnt(0)
  s_barrier
  ds_read_b128 v[28:31], v16 offset:0
  ds_read_b64_tr_b16 v[44:45], v22 offset:0
  ds_read_b64_tr_b16 v[46:47], v22 offset:1024
  ds_read_b64_tr_b16 v[48:49], v23 offset:0
  ds_read_b64_tr_b16 v[50:51], v23 offset:1024
  v_mfma_f32_32x32x16_bf16 v[156:171], v[108:111], v[92:95], v[156:171]
  v_mfma_f32_32x32x16_bf16 v[172:187], v[112:115], v[92:95], v[172:187]
  s_lshl_b32 s42, s58, 7
  s_add_u32 s42, s42, s54
  s_add_u32 m0, s56, 36864
  s_mul_i32 s43, s58, s45
  buffer_load_dwordx4 v2, s[20:23], s42 offen lds
  ds_read_b128 v[32:35], v17 offset:0
  ds_read_b64_tr_b16 v[52:53], v22 offset:4096
  ds_read_b64_tr_b16 v[54:55], v22 offset:5120
  ds_read_b64_tr_b16 v[56:57], v23 offset:4096
  ds_read_b64_tr_b16 v[58:59], v23 offset:5120
  v_mfma_f32_32x32x16_bf16 v[156:171], v[116:119], v[96:99], v[156:171]
  v_mfma_f32_32x32x16_bf16 v[172:187], v[120:123], v[96:99], v[172:187]
  s_add_u32 m0, s56, 37888
  s_add_u32 s43, s43, s55
  buffer_load_dwordx4 v3, s[20:23], s42 offen lds
  ds_read_b128 v[36:39], v18 offset:0
  ds_read_b64_tr_b16 v[60:61], v22 offset:8192
  ds_read_b64_tr_b16 v[62:63], v22 offset:9216
  ds_read_b64_tr_b16 v[64:65], v23 offset:8192
  ds_read_b64_tr_b16 v[66:67], v23 offset:9216
  v_mfma_f32_32x32x16_bf16 v[156:171], v[124:127], v[100:103], v[156:171]
  v_mfma_f32_32x32x16_bf16 v[172:187], v[128:131], v[100:103], v[172:187]
  s_add_u32 m0, s56, 53248
  s_add_u32 s42, s43, s44
  buffer_load_dwordx4 v4, s[24:27], s43 offen lds
  ds_read_b128 v[40:43], v19 offset:0
  ds_read_b64_tr_b16 v[68:69], v22 offset:12288
  ds_read_b64_tr_b16 v[70:71], v22 offset:13312
  ds_read_b64_tr_b16 v[72:73], v23 offset:12288
  ds_read_b64_tr_b16 v[74:75], v23 offset:13312
  v_mfma_f32_32x32x16_bf16 v[156:171], v[132:135], v[104:107], v[156:171]
  v_mfma_f32_32x32x16_bf16 v[172:187], v[136:139], v[104:107], v[172:187]
  s_add_u32 m0, s56, 54272
  s_lshl_b32 s43, s58, 11
  buffer_load_dwordx4 v4, s[24:27], s42 offen lds
  s_add_u32 m0, s60, 69632
  s_add_u32 s43, s43, s59
  s_mov_b64 exec, s[36:37]
  buffer_load_dwordx4 v6, s[32:35], s43 offen lds
  s_mov_b64 exec, -1
  s_add_u32 s58, s58, 1
  s_and_b32 s58, s58, 7
  s_waitcnt vmcnt(10) lgkmcnt(0)
  s_barrier
  ds_read_b128 v[92:95], v16 offset:36864
  ds_read_b64_tr_b16 v[108:109], v22 offset:36864
  ds_read_b64_tr_b16 v[110:111], v22 offset:37888
  ds_read_b64_tr_b16 v[112:113], v23 offset:36864
  ds_read_b64_tr_b16 v[114:115], v23 offset:37888
  v_mfma_f32_32x32x16_bf16 v[156:171], v[44:47], v[28:31], v[156:171]
  v_mfma_f32_32x32x16_bf16 v[172:187], v[48:51], v[28:31], v[172:187]
  s_lshl_b32 s42, s58, 7
  s_add_u32 s42, s42, s54
  s_add_u32 m0, s56, 73728
  s_mul_i32 s43, s58, s45
  buffer_load_dwordx4 v2, s[20:23], s42 offen lds
  ds_read_b128 v[96:99], v17 offset:36864
  ds_read_b64_tr_b16 v[116:117], v22 offset:40960
  ds_read_b64_tr_b16 v[118:119], v22 offset:41984
  ds_read_b64_tr_b16 v[120:121], v23 offset:40960
  ds_read_b64_tr_b16 v[122:123], v23 offset:41984
  v_mfma_f32_32x32x16_bf16 v[156:171], v[52:55], v[32:35], v[156:171]
  v_mfma_f32_32x32x16_bf16 v[172:187], v[56:59], v[32:35], v[172:187]
  s_add_u32 m0, s56, 74752
  s_add_u32 s43, s43, s55
  buffer_load_dwordx4 v3, s[20:23], s42 offen lds
  ds_read_b128 v[100:103], v18 offset:36864
  ds_read_b64_tr_b16 v[124:125], v22 offset:45056
  ds_read_b64_tr_b16 v[126:127], v22 offset:46080
  ds_read_b64_tr_b16 v[128:129], v23 offset:45056
  ds_read_b64_tr_b16 v[130:131], v23 offset:46080
  v_mfma_f32_32x32x16_bf16 v[156:171], v[60:63], v[36:39], v[156:171]
  v_mfma_f32_32x32x16_bf16 v[172:187], v[64:67], v[36:39], v[172:187]
  s_add_u32 m0, s56, 90112
  s_add_u32 s42, s43, s44
  buffer_load_dwordx4 v4, s[24:27], s43 offen lds
  ds_read_b128 v[104:107], v19 offset:36864
  ds_read_b64_tr_b16 v[132:133], v22 offset:49152
  ds_read_b64_tr_b16 v[134:135], v22 offset:50176
  ds_read_b64_tr_b16 v[136:137], v23 offset:49152
  ds_read_b64_tr_b16 v[138:139], v23 offset:50176
  v_mfma_f32_32x32x16_bf16 v[156:171], v[68:71], v[40:43], v[156:171]
  v_mfma_f32_32x32x16_bf16 v[172:187], v[72:75], v[40:43], v[172:187]
  s_add_u32 m0, s56, 91136
  s_lshl_b32 s43, s58, 11
  buffer_load_dwordx4 v4, s[24:27], s42 offen lds
  s_add_u32 m0, s60, 106496
  s_add_u32 s43, s43, s59
  s_mov_b64 exec, s[36:37]
  buffer_load_dwordx4 v6, s[32:35], s43 offen lds
  s_mov_b64 exec, -1
  s_add_u32 s58, s58, 1
  s_and_b32 s58, s58, 7
  s_waitcnt vmcnt(10) lgkmcnt(0)
  s_barrier
  ds_read_b128 v[28:31], v12 offset:0
  ds_read_b64_tr_b16 v[44:45], v20 offset:0
  ds_read_b64_tr_b16 v[46:47], v20 offset:1024
  ds_read_b64_tr_b16 v[48:49], v21 offset:0
  ds_read_b64_tr_b16 v[50:51], v21 offset:1024
  v_mfma_f32_32x32x16_bf16 v[156:171], v[108:111], v[92:95], v[156:171]
  v_mfma_f32_32x32x16_bf16 v[172:187], v[112:115], v[92:95], v[172:187]
  s_lshl_b32 s42, s58, 7
  s_add_u32 s42, s42, s54
  s_add_u32 m0, s56, 110592
  s_mul_i32 s43, s58, s45
  buffer_load_dwordx4 v2, s[20:23], s42 offen lds
  ds_read_b128 v[32:35], v13 offset:0
  ds_read_b64_tr_b16 v[52:53], v20 offset:4096
  ds_read_b64_tr_b16 v[54:55], v20 offset:5120
  ds_read_b64_tr_b16 v[56:57], v21 offset:4096
  ds_read_b64_tr_b16 v[58:59], v21 offset:5120
  v_mfma_f32_32x32x16_bf16 v[156:171], v[116:119], v[96:99], v[156:171]
  v_mfma_f32_32x32x16_bf16 v[172:187], v[120:123], v[96:99], v[172:187]
  s_add_u32 m0, s56, 111616
  s_add_u32 s43, s43, s55
  buffer_load_dwordx4 v3, s[20:23], s42 offen lds
  ds_read_b128 v[36:39], v14 offset:0
  ds_read_b64_tr_b16 v[60:61], v20 offset:8192
  ds_read_b64_tr_b16 v[62:63], v20 offset:9216
  ds_read_b64_tr_b16 v[64:65], v21 offset:8192
  ds_read_b64_tr_b16 v[66:67], v21 offset:9216
  v_mfma_f32_32x32x16_bf16 v[156:171], v[124:127], v[100:103], v[156:171]
  v_mfma_f32_32x32x16_bf16 v[172:187], v[128:131], v[100:103], v[172:187]
  s_add_u32 m0, s56, 126976
  s_add_u32 s42, s43, s44
  buffer_load_dwordx4 v4, s[24:27], s43 offen lds
  ds_read_b128 v[40:43], v15 offset:0
  ds_read_b64_tr_b16 v[68:69], v20 offset:12288
  ds_read_b64_tr_b16 v[70:71], v20 offset:13312
  ds_read_b64_tr_b16 v[72:73], v21 offset:12288
  ds_read_b64_tr_b16 v[74:75], v21 offset:13312
  v_mfma_f32_32x32x16_bf16 v[156:171], v[132:135], v[104:107], v[156:171]
  v_mfma_f32_32x32x16_bf16 v[172:187], v[136:139], v[104:107], v[172:187]
  s_add_u32 m0, s56, 128000
  s_lshl_b32 s43, s58, 11
  buffer_load_dwordx4 v4, s[24:27], s42 offen lds
  s_add_u32 m0, s60, 143360
  s_add_u32 s43, s43, s59
  s_mov_b64 exec, s[36:37]
  buffer_load_dwordx4 v6, s[32:35], s43 offen lds
  s_mov_b64 exec, -1
  s_add_u32 s58, s58, 1
  s_and_b32 s58, s58, 7
  s_waitcnt vmcnt(10) lgkmcnt(0)
  s_barrier
  ds_read_b128 v[92:95], v12 offset:36864
  ds_read_b64_tr_b16 v[108:109], v20 offset:36864
  ds_read_b64_tr_b16 v[110:111], v20 offset:37888
  ds_read_b64_tr_b16 v[112:113], v21 offset:36864
  ds_read_b64_tr_b16 v[114:115], v21 offset:37888
  v_mfma_f32_32x32x16_bf16 v[156:171], v[44:47], v[28:31], v[156:171]
  v_mfma_f32_32x32x16_bf16 v[172:187], v[48:51], v[28:31], v[172:187]
  ds_read_b128 v[96:99], v13 offset:36864
  ds_read_b64_tr_b16 v[116:117], v20 offset:40960
  ds_read_b64_tr_b16 v[118:119], v20 offset:41984
  ds_read_b64_tr_b16 v[120:121], v21 offset:40960
  ds_read_b64_tr_b16 v[122:123], v21 offset:41984
  v_mfma_f32_32x32x16_bf16 v[156:171], v[52:55], v[32:35], v[156:171]
  v_mfma_f32_32x32x16_bf16 v[172:187], v[56:59], v[32:35], v[172:187]
  ds_read_b128 v[100:103], v14 offset:36864
  ds_read_b64_tr_b16 v[124:125], v20 offset:45056
  ds_read_b64_tr_b16 v[126:127], v20 offset:46080
  ds_read_b64_tr_b16 v[128:129], v21 offset:45056
  ds_read_b64_tr_b16 v[130:131], v21 offset:46080
  v_mfma_f32_32x32x16_bf16 v[156:171], v[60:63], v[36:39], v[156:171]
  v_mfma_f32_32x32x16_bf16 v[172:187], v[64:67], v[36:39], v[172:187]
  ds_read_b128 v[104:107], v15 offset:36864
  ds_read_b64_tr_b16 v[132:133], v20 offset:49152
  ds_read_b64_tr_b16 v[134:135], v20 offset:50176
  ds_read_b64_tr_b16 v[136:137], v21 offset:49152
  ds_read_b64_tr_b16 v[138:139], v21 offset:50176
  v_mfma_f32_32x32x16_bf16 v[156:171], v[68:71], v[40:43], v[156:171]
  v_mfma_f32_32x32x16_bf16 v[172:187], v[72:75], v[40:43], v[172:187]
  s_waitcnt vmcnt(5) lgkmcnt(0)
  s_barrier
  ds_read_b128 v[28:31], v16 offset:0
  ds_read_b64_tr_b16 v[44:45], v22 offset:0
  ds_read_b64_tr_b16 v[46:47], v22 offset:1024
  ds_read_b64_tr_b16 v[48:49], v23 offset:0
  ds_read_b64_tr_b16 v[50:51], v23 offset:1024
  v_mfma_f32_32x32x16_bf16 v[156:171], v[108:111], v[92:95], v[156:171]
  v_mfma_f32_32x32x16_bf16 v[172:187], v[112:115], v[92:95], v[172:187]
  ds_read_b128 v[32:35], v17 offset:0
  ds_read_b64_tr_b16 v[52:53], v22 offset:4096
  ds_read_b64_tr_b16 v[54:55], v22 offset:5120
  ds_read_b64_tr_b16 v[56:57], v23 offset:4096
  ds_read_b64_tr_b16 v[58:59], v23 offset:5120
  v_mfma_f32_32x32x16_bf16 v[156:171], v[116:119], v[96:99], v[156:171]
  v_mfma_f32_32x32x16_bf16 v[172:187], v[120:123], v[96:99], v[172:187]
  ds_read_b128 v[36:39], v18 offset:0
  ds_read_b64_tr_b16 v[60:61], v22 offset:8192
  ds_read_b64_tr_b16 v[62:63], v22 offset:9216
  ds_read_b64_tr_b16 v[64:65], v23 offset:8192
  ds_read_b64_tr_b16 v[66:67], v23 offset:9216
  v_mfma_f32_32x32x16_bf16 v[156:171], v[124:127], v[100:103], v[156:171]
  v_mfma_f32_32x32x16_bf16 v[172:187], v[128:131], v[100:103], v[172:187]
  ds_read_b128 v[40:43], v19 offset:0
  ds_read_b64_tr_b16 v[68:69], v22 offset:12288
  ds_read_b64_tr_b16 v[70:71], v22 offset:13312
  ds_read_b64_tr_b16 v[72:73], v23 offset:12288
  ds_read_b64_tr_b16 v[74:75], v23 offset:13312
  v_mfma_f32_32x32x16_bf16 v[156:171], v[132:135], v[104:107], v[156:171]
  v_mfma_f32_32x32x16_bf16 v[172:187], v[136:139], v[104:107], v[172:187]
  s_waitcnt vmcnt(0) lgkmcnt(0)
  s_barrier
  ds_read_b128 v[92:95], v16 offset:36864
  ds_read_b64_tr_b16 v[108:109], v22 offset:36864
  ds_read_b64_tr_b16 v[110:111], v22 offset:37888
  ds_read_b64_tr_b16 v[112:113], v23 offset:36864
  ds_read_b64_tr_b16 v[114:115], v23 offset:37888
  v_mfma_f32_32x32x16_bf16 v[156:171], v[44:47], v[28:31], v[156:171]
  v_mfma_f32_32x32x16_bf16 v[172:187], v[48:51], v[28:31], v[172:187]
  ds_read_b128 v[96:99], v17 offset:36864
  ds_read_b64_tr_b16 v[116:117], v22 offset:40960
  ds_read_b64_tr_b16 v[118:119], v22 offset:41984
  ds_read_b64_tr_b16 v[120:121], v23 offset:40960
  ds_read_b64_tr_b16 v[122:123], v23 offset:41984
  v_mfma_f32_32x32x16_bf16 v[156:171], v[52:55], v[32:35], v[156:171]
  v_mfma_f32_32x32x16_bf16 v[172:187], v[56:59], v[32:35], v[172:187]
  ds_read_b128 v[100:103], v18 offset:36864
  ds_read_b64_tr_b16 v[124:125], v22 offset:45056
  ds_read_b64_tr_b16 v[126:127], v22 offset:46080
  ds_read_b64_tr_b16 v[128:129], v23 offset:45056
  ds_read_b64_tr_b16 v[130:131], v23 offset:46080
  v_mfma_f32_32x32x16_bf16 v[156:171], v[60:63], v[36:39], v[156:171]
  v_mfma_f32_32x32x16_bf16 v[172:187], v[64:67], v[36:39], v[172:187]
  ds_read_b128 v[104:107], v19 offset:36864
  ds_read_b64_tr_b16 v[132:133], v22 offset:49152
  ds_read_b64_tr_b16 v[134:135], v22 offset:50176
  ds_read_b64_tr_b16 v[136:137], v23 offset:49152
  ds_read_b64_tr_b16 v[138:139], v23 offset:50176
  v_mfma_f32_32x32x16_bf16 v[156:171], v[68:71], v[40:43], v[156:171]
  v_mfma_f32_32x32x16_bf16 v[172:187], v[72:75], v[40:43], v[172:187]
  s_waitcnt lgkmcnt(0)
  v_mfma_f32_32x32x16_bf16 v[156:171], v[108:111], v[92:95], v[156:171]
  v_mfma_f32_32x32x16_bf16 v[172:187], v[112:115], v[92:95], v[172:187]
  v_mfma_f32_32x32x16_bf16 v[156:171], v[116:119], v[96:99], v[156:171]
  v_mfma_f32_32x32x16_bf16 v[172:187], v[120:123], v[96:99], v[172:187]
  v_mfma_f32_32x32x16_bf16 v[156:171], v[124:127], v[100:103], v[156:171]
  v_mfma_f32_32x32x16_bf16 v[172:187], v[128:131], v[100:103], v[172:187]
  v_mfma_f32_32x32x16_bf16 v[156:171], v[132:135], v[104:107], v[156:171]
  v_mfma_f32_32x32x16_bf16 v[172:187], v[136:139], v[104:107], v[172:187]
  s_nop 15
  s_branch proj_T_epi
proj_T_plain:
  s_lshl_b32 s42, s58, 7
  s_add_u32 s42, s42, s54
  s_add_u32 m0, s56, 0
  s_mul_i32 s43, s58, s45
  buffer_load_dwordx4 v2, s[20:23], s42 offen lds
  s_add_u32 m0, s56, 1024
  s_add_u32 s43, s43, s55
  buffer_load_dwordx4 v3, s[20:23], s42 offen lds
  s_add_u32 m0, s56, 16384
  s_add_u32 s42, s43, s44
  buffer_load_dwordx4 v4, s[24:27], s43 offen lds
  s_add_u32 m0, s56, 17408
  s_lshl_b32 s43, s58, 11
  buffer_load_dwordx4 v4, s[24:27], s42 offen lds
  s_add_u32 s58, s58, 1
  s_and_b32 s58, s58, 7
  s_lshl_b32 s42, s58, 7
  s_add_u32 s42, s42, s54
  s_add_u32 m0, s56, 36864
  s_mul_i32 s43, s58, s45
  buffer_load_dwordx4 v2, s[20:23], s42 offen lds
  s_add_u32 m0, s56, 37888
  s_add_u32 s43, s43, s55
  buffer_load_dwordx4 v3, s[20:23], s42 offen lds
  s_add_u32 m0, s56, 53248
  s_add_u32 s42, s43, s44
  buffer_load_dwordx4 v4, s[24:27], s43 offen lds
  s_add_u32 m0, s56, 54272
  s_lshl_b32 s43, s58, 11
  buffer_load_dwordx4 v4, s[24:27], s42 offen lds
  s_add_u32 s58, s58, 1
  s_and_b32 s58, s58, 7
  v_and_b32 v8, 31, v1
  v_lshrrev_b32 v9, 5, v1
  v_bfe_u32 v10, v1, 1, 3
  v_xor_b32 v9, v9, v10
  v_lshlrev_b32 v9, 4, v9
  v_lshl_add_u32 v8, v8, 7, v9
  s_lshl_b32 s50, s51, 12
  v_add_u32 v8, s50, v8
  v_xor_b32 v12, 0, v8
  v_add_u32 v16, 73728, v12
  v_xor_b32 v13, 32, v8
  v_add_u32 v17, 73728, v13
  v_xor_b32 v14, 64, v8
  v_add_u32 v18, 73728, v14
  v_xor_b32 v15, 96, v8
  v_add_u32 v19, 73728, v15
  v_lshrrev_b32 v8, 5, v1
  v_bfe_u32 v9, v1, 2, 2
  v_lshl_add_u32 v8, v8, 3, v9
  v_bfe_u32 v10, v1, 4, 1
  v_and_b32 v11, 3, v1
  v_lshl_add_u32 v10, v10, 2, v11
  v_lshlrev_b32 v10, 3, v10
  v_lshl_add_u32 v24, v8, 6, v10
  v_add_u32 v24, 32768, v24
  v_add_u32 v25, 73728, v24
  v_lshl_add_u32 v8, v8, 8, v10
  s_lshl_b32 s50, s52, 1
  v_xor_b32 v9, s50, v9
  v_lshl_add_u32 v8, v9, 6, v8
  v_add_u32 v20, 16384, v8
  v_xor_b32 v21, 64, v20
  v_add_u32 v22, 73728, v20
  v_add_u32 v23, 73728, v21
  s_waitcnt vmcnt(4)
  s_barrier
  ds_read_b128 v[28:31], v12 offset:0
  ds_read_b64_tr_b16 v[44:45], v20 offset:0
  ds_read_b64_tr_b16 v[46:47], v20 offset:1024
  ds_read_b64_tr_b16 v[48:49], v21 offset:0
  ds_read_b64_tr_b16 v[50:51], v21 offset:1024
  ds_read_b128 v[32:35], v13 offset:0
  ds_read_b64_tr_b16 v[52:53], v20 offset:4096
  ds_read_b64_tr_b16 v[54:55], v20 offset:5120
  ds_read_b64_tr_b16 v[56:57], v21 offset:4096
  ds_read_b64_tr_b16 v[58:59], v21 offset:5120
  ds_read_b128 v[36:39], v14 offset:0
  ds_read_b64_tr_b16 v[60:61], v20 offset:8192
  ds_read_b64_tr_b16 v[62:63], v20 offset:9216
  ds_read_b64_tr_b16 v[64:65], v21 offset:8192
  ds_read_b64_tr_b16 v[66:67], v21 offset:9216
  ds_read_b128 v[40:43], v15 offset:0
  ds_read_b64_tr_b16 v[68:69], v20 offset:12288
  ds_read_b64_tr_b16 v[70:71], v20 offset:13312
  ds_read_b64_tr_b16 v[72:73], v21 offset:12288
  ds_read_b64_tr_b16 v[74:75], v21 offset:13312
  s_lshl_b32 s42, s58, 7
  s_add_u32 s42, s42, s54
  s_add_u32 m0, s56, 73728
  s_mul_i32 s43, s58, s45
  buffer_load_dwordx4 v2, s[20:23], s42 offen lds
  s_add_u32 m0, s56, 74752
  s_add_u32 s43, s43, s55
  buffer_load_dwordx4 v3, s[20:23], s42 offen lds
  s_add_u32 m0, s56, 90112
  s_add_u32 s42, s43, s44
  buffer_load_dwordx4 v4, s[24:27], s43 offen lds
  s_add_u32 m0, s56, 91136
  s_lshl_b32 s43, s58, 11
  buffer_load_dwordx4 v4, s[24:27], s42 offen lds
  s_add_u32 s58, s58, 1
  s_and_b32 s58, s58, 7
  s_lshl_b32 s42, s58, 7
  s_add_u32 s42, s42, s54
  s_add_u32 m0, s56, 110592
  s_mul_i32 s43, s58, s45
  buffer_load_dwordx4 v2, s[20:23], s42 offen lds
  s_add_u32 m0, s56, 111616
  s_add_u32 s43, s43, s55
  buffer_load_dwordx4 v3, s[20:23], s42 offen lds
  s_add_u32 m0, s56, 126976
  s_add_u32 s42, s43, s44
  buffer_load_dwordx4 v4, s[24:27], s43 offen lds
  s_add_u32 m0, s56, 128000
  s_lshl_b32 s43, s58, 11
  buffer_load_dwordx4 v4, s[24:27], s42 offen lds
  s_add_u32 s58, s58, 1
  s_and_b32 s58, s58, 7
  s_waitcnt vmcnt(8) lgkmcnt(0)
  s_barrier
  ds_read_b128 v[92:95], v12 offset:36864
  ds_read_b64_tr_b16 v[108:109], v20 offset:36864
  ds_read_b64_tr_b16 v[110:111], v20 offset:37888
  ds_read_b64_tr_b16 v[112:113], v21 offset:36864
  ds_read_b64_tr_b16 v[114:115], v21 offset:37888
  v_mfma_f32_32x32x16_bf16 v[156:171], v[44:47], v[28:31], 0
  v_mfma_f32_32x32x16_bf16 v[172:187], v[48:51], v[28:31], 0
  s_lshl_b32 s42, s58, 7
  s_add_u32 s42, s42, s54
  s_add_u32 m0, s56, 0
  s_mul_i32 s43, s58, s45
  buffer_load_dwordx4 v2, s[20:23], s42 offen lds
  ds_read_b128 v[96:99], v13 offset:36864
  ds_read_b64_tr_b16 v[116:117], v20 offset:40960
  ds_read_b64_tr_b16 v[118:119], v20 offset:41984
  ds_read_b64_tr_b16 v[120:121], v21 offset:40960
  ds_read_b64_tr_b16 v[122:123], v21 offset:41984
  v_mfma_f32_32x32x16_bf16 v[156:171], v[52:55], v[32:35], v[156:171]
  v_mfma_f32_32x32x16_bf16 v[172:187], v[56:59], v[32:35], v[172:187]
  s_add_u32 m0, s56, 1024
  s_add_u32 s43, s43, s55
  buffer_load_dwordx4 v3, s[20:23], s42 offen lds
  ds_read_b128 v[100:103], v14 offset:36864
  ds_read_b64_tr_b16 v[124:125], v20 offset:45056
  ds_read_b64_tr_b16 v[126:127], v20 offset:46080
  ds_read_b64_tr_b16 v[128:129], v21 offset:45056
  ds_read_b64_tr_b16 v[130:131], v21 offset:46080
  v_mfma_f32_32x32x16_bf16 v[156:171], v[60:63], v[36:39], v[156:171]
  v_mfma_f32_32x32x16_bf16 v[172:187], v[64:67], v[36:39], v[172:187]
  s_add_u32 m0, s56, 16384
  s_add_u32 s42, s43, s44
  buffer_load_dwordx4 v4, s[24:27], s43 offen lds
  ds_read_b128 v[104:107], v15 offset:36864
  ds_read_b64_tr_b16 v[132:133], v20 offset:49152
  ds_read_b64_tr_b16 v[134:135], v20 offset:50176
  ds_read_b64_tr_b16 v[136:137], v21 offset:49152
  ds_read_b64_tr_b16 v[138:139], v21 offset:50176
  v_mfma_f32_32x32x16_bf16 v[156:171], v[68:71], v[40:43], v[156:171]
  v_mfma_f32_32x32x16_bf16 v[172:187], v[72:75], v[40:43], v[172:187]
  s_add_u32 m0, s56, 17408
  s_lshl_b32 s43, s58, 11
  buffer_load_dwordx4 v4, s[24:27], s42 offen lds
  s_add_u32 s58, s58, 1
  s_and_b32 s58, s58, 7
  s_waitcnt vmcnt(8) lgkmcnt(0)
  s_barrier
  ds_read_b128 v[28:31], v16 offset:0
  ds_read_b64_tr_b16 v[44:45], v22 offset:0
  ds_read_b64_tr_b16 v[46:47], v22 offset:1024
  ds_read_b64_tr_b16 v[48:49], v23 offset:0
  ds_read_b64_tr_b16 v[50:51], v23 offset:1024
  v_mfma_f32_32x32x16_bf16 v[156:171], v[108:111], v[92:95], v[156:171]
  v_mfma_f32_32x32x16_bf16 v[172:187], v[112:115], v[92:95], v[172:187]
  s_lshl_b32 s42, s58, 7
  s_add_u32 s42, s42, s54
  s_add_u32 m0, s56, 36864
  s_mul_i32 s43, s58, s45
  buffer_load_dwordx4 v2, s[20:23], s42 offen lds
  ds_read_b128 v[32:35], v17 offset:0
  ds_read_b64_tr_b16 v[52:53], v22 offset:4096
  ds_read_b64_tr_b16 v[54:55], v22 offset:5120
  ds_read_b64_tr_b16 v[56:57], v23 offset:4096
  ds_read_b64_tr_b16 v[58:59], v23 offset:5120
  v_mfma_f32_32x32x16_bf16 v[156:171], v[116:119], v[96:99], v[156:171]
  v_mfma_f32_32x32x16_bf16 v[172:187], v[120:123], v[96:99], v[172:187]
  s_add_u32 m0, s56, 37888
  s_add_u32 s43, s43, s55
  buffer_load_dwordx4 v3, s[20:23], s42 offen lds
  ds_read_b128 v[36:39], v18 offset:0
  ds_read_b64_tr_b16 v[60:61], v22 offset:8192
  ds_read_b64_tr_b16 v[62:63], v22 offset:9216
  ds_read_b64_tr_b16 v[64:65], v23 offset:8192
  ds_read_b64_tr_b16 v[66:67], v23 offset:9216
  v_mfma_f32_32x32x16_bf16 v[156:171], v[124:127], v[100:103], v[156:171]
  v_mfma_f32_32x32x16_bf16 v[172:187], v[128:131], v[100:103], v[172:187]
  s_add_u32 m0, s56, 53248
  s_add_u32 s42, s43, s44
  buffer_load_dwordx4 v4, s[24:27], s43 offen lds
  ds_read_b128 v[40:43], v19 offset:0
  ds_read_b64_tr_b16 v[68:69], v22 offset:12288
  ds_read_b64_tr_b16 v[70:71], v22 offset:13312
  ds_read_b64_tr_b16 v[72:73], v23 offset:12288
  ds_read_b64_tr_b16 v[74:75], v23 offset:13312
  v_mfma_f32_32x32x16_bf16 v[156:171], v[132:135], v[104:107], v[156:171]
  v_mfma_f32_32x32x16_bf16 v[172:187], v[136:139], v[104:107], v[172:187]
  s_add_u32 m0, s56, 54272
  s_lshl_b32 s43, s58, 11
  buffer_load_dwordx4 v4, s[24:27], s42 offen lds
  s_add_u32 s58, s58, 1
  s_and_b32 s58, s58, 7
  s_waitcnt vmcnt(8) lgkmcnt(0)
  s_barrier
  ds_read_b128 v[92:95], v16 offset:36864
  ds_read_b64_tr_b16 v[108:109], v22 offset:36864
  ds_read_b64_tr_b16 v[110:111], v22 offset:37888
  ds_read_b64_tr_b16 v[112:113], v23 offset:36864
  ds_read_b64_tr_b16 v[114:115], v23 offset:37888
  v_mfma_f32_32x32x16_bf16 v[156:171], v[44:47], v[28:31], v[156:171]
  v_mfma_f32_32x32x16_bf16 v[172:187], v[48:51], v[28:31], v[172:187]
  s_lshl_b32 s42, s58, 7
  s_add_u32 s42, s42, s54
  s_add_u32 m0, s56, 73728
  s_mul_i32 s43, s58, s45
  buffer_load_dwordx4 v2, s[20:23], s42 offen lds
  ds_read_b128 v[96:99], v17 offset:36864
  ds_read_b64_tr_b16 v[116:117], v22 offset:40960
  ds_read_b64_tr_b16 v[118:119], v22 offset:41984
  ds_read_b64_tr_b16 v[120:121], v23 offset:40960
  ds_read_b64_tr_b16 v[122:123], v23 offset:41984
  v_mfma_f32_32x32x16_bf16 v[156:171], v[52:55], v[32:35], v[156:171]
  v_mfma_f32_32x32x16_bf16 v[172:187], v[56:59], v[32:35], v[172:187]
  s_add_u32 m0, s56, 74752
  s_add_u32 s43, s43, s55
  buffer_load_dwordx4 v3, s[20:23], s42 offen lds
  ds_read_b128 v[100:103], v18 offset:36864
  ds_read_b64_tr_b16 v[124:125], v22 offset:45056
  ds_read_b64_tr_b16 v[126:127], v22 offset:46080
  ds_read_b64_tr_b16 v[128:129], v23 offset:45056
  ds_read_b64_tr_b16 v[130:131], v23 offset:46080
  v_mfma_f32_32x32x16_bf16 v[156:171], v[60:63], v[36:39], v[156:171]
  v_mfma_f32_32x32x16_bf16 v[172:187], v[64:67], v[36:39], v[172:187]
  s_add_u32 m0, s56, 90112
  s_add_u32 s42, s43, s44
  buffer_load_dwordx4 v4, s[24:27], s43 offen lds
  ds_read_b128 v[104:107], v19 offset:36864
  ds_read_b64_tr_b16 v[132:133], v22 offset:49152
  ds_read_b64_tr_b16 v[134:135], v22 offset:50176
  ds_read_b64_tr_b16 v[136:137], v23 offset:49152
  ds_read_b64_tr_b16 v[138:139], v23 offset:50176
  v_mfma_f32_32x32x16_bf16 v[156:171], v[68:71], v[40:43], v[156:171]
  v_mfma_f32_32x32x16_bf16 v[172:187], v[72:75], v[40:43], v[172:187]
  s_add_u32 m0, s56, 91136
  s_lshl_b32 s43, s58, 11
  buffer_load_dwordx4 v4, s[24:27], s42 offen lds
  s_add_u32 s58, s58, 1
  s_and_b32 s58, s58, 7
  s_waitcnt vmcnt(8) lgkmcnt(0)
  s_barrier
  ds_read_b128 v[28:31], v12 offset:0
  ds_read_b64_tr_b16 v[44:45], v20 offset:0
  ds_read_b64_tr_b16 v[46:47], v20 offset:1024
  ds_read_b64_tr_b16 v[48:49], v21 offset:0
  ds_read_b64_tr_b16 v[50:51], v21 offset:1024
  v_mfma_f32_32x32x16_bf16 v[156:171], v[108:111], v[92:95], v[156:171]
  v_mfma_f32_32x32x16_bf16 v[172:187], v[112:115], v[92:95], v[172:187]
  s_lshl_b32 s42, s58, 7
  s_add_u32 s42, s42, s54
  s_add_u32 m0, s56, 110592
  s_mul_i32 s43, s58, s45
  buffer_load_dwordx4 v2, s[20:23], s42 offen lds
  ds_read_b128 v[32:35], v13 offset:0
  ds_read_b64_tr_b16 v[52:53], v20 offset:4096
  ds_read_b64_tr_b16 v[54:55], v20 offset:5120
  ds_read_b64_tr_b16 v[56:57], v21 offset:4096
  ds_read_b64_tr_b16 v[58:59], v21 offset:5120
  v_mfma_f32_32x32x16_bf16 v[156:171], v[116:119], v[96:99], v[156:171]
  v_mfma_f32_32x32x16_bf16 v[172:187], v[120:123], v[96:99], v[172:187]
  s_add_u32 m0, s56, 111616
  s_add_u32 s43, s43, s55
  buffer_load_dwordx4 v3, s[20:23], s42 offen lds
  ds_read_b128 v[36:39], v14 offset:0
  ds_read_b64_tr_b16 v[60:61], v20 offset:8192
  ds_read_b64_tr_b16 v[62:63], v20 offset:9216
  ds_read_b64_tr_b16 v[64:65], v21 offset:8192
  ds_read_b64_tr_b16 v[66:67], v21 offset:9216
  v_mfma_f32_32x32x16_bf16 v[156:171], v[124:127], v[100:103], v[156:171]
  v_mfma_f32_32x32x16_bf16 v[172:187], v[128:131], v[100:103], v[172:187]
  s_add_u32 m0, s56, 126976
  s_add_u32 s42, s43, s44
  buffer_load_dwordx4 v4, s[24:27], s43 offen lds
  ds_read_b128 v[40:43], v15 offset:0
  ds_read_b64_tr_b16 v[68:69], v20 offset:12288
  ds_read_b64_tr_b16 v[70:71], v20 offset:13312
  ds_read_b64_tr_b16 v[72:73], v21 offset:12288
  ds_read_b64_tr_b16 v[74:75], v21 offset:13312
  v_mfma_f32_32x32x16_bf16 v[156:171], v[132:135], v[104:107], v[156:171]
  v_mfma_f32_32x32x16_bf16 v[172:187], v[136:139], v[104:107], v[172:187]
  s_add_u32 m0, s56, 128000
  s_lshl_b32 s43, s58, 11
  buffer_load_dwordx4 v4, s[24:27], s42 offen lds
  s_add_u32 s58, s58, 1
  s_and_b32 s58, s58, 7
  s_waitcnt vmcnt(8) lgkmcnt(0)
  s_barrier
  ds_read_b128 v[92:95], v12 offset:36864
  ds_read_b64_tr_b16 v[108:109], v20 offset:36864
  ds_read_b64_tr_b16 v[110:111], v20 offset:37888
  ds_read_b64_tr_b16 v[112:113], v21 offset:36864
  ds_read_b64_tr_b16 v[114:115], v21 offset:37888
  v_mfma_f32_32x32x16_bf16 v[156:171], v[44:47], v[28:31], v[156:171]
  v_mfma_f32_32x32x16_bf16 v[172:187], v[48:51], v[28:31], v[172:187]
  ds_read_b128 v[96:99], v13 offset:36864
  ds_read_b64_tr_b16 v[116:117], v20 offset:40960
  ds_read_b64_tr_b16 v[118:119], v20 offset:41984
  ds_read_b64_tr_b16 v[120:121], v21 offset:40960
  ds_read_b64_tr_b16 v[122:123], v21 offset:41984
  v_mfma_f32_32x32x16_bf16 v[156:171], v[52:55], v[32:35], v[156:171]
  v_mfma_f32_32x32x16_bf16 v[172:187], v[56:59], v[32:35], v[172:187]
  ds_read_b128 v[100:103], v14 offset:36864
  ds_read_b64_tr_b16 v[124:125], v20 offset:45056
  ds_read_b64_tr_b16 v[126:127], v20 offset:46080
  ds_read_b64_tr_b16 v[128:129], v21 offset:45056
  ds_read_b64_tr_b16 v[130:131], v21 offset:46080
  v_mfma_f32_32x32x16_bf16 v[156:171], v[60:63], v[36:39], v[156:171]
  v_mfma_f32_32x32x16_bf16 v[172:187], v[64:67], v[36:39], v[172:187]
  ds_read_b128 v[104:107], v15 offset:36864
  ds_read_b64_tr_b16 v[132:133], v20 offset:49152
  ds_read_b64_tr_b16 v[134:135], v20 offset:50176
  ds_read_b64_tr_b16 v[136:137], v21 offset:49152
  ds_read_b64_tr_b16 v[138:139], v21 offset:50176
  v_mfma_f32_32x32x16_bf16 v[156:171], v[68:71], v[40:43], v[156:171]
  v_mfma_f32_32x32x16_bf16 v[172:187], v[72:75], v[40:43], v[172:187]
  s_waitcnt vmcnt(4) lgkmcnt(0)
  s_barrier
  ds_read_b128 v[28:31], v16 offset:0
  ds_read_b64_tr_b16 v[44:45], v22 offset:0
  ds_read_b64_tr_b16 v[46:47], v22 offset:1024
  ds_read_b64_tr_b16 v[48:49], v23 offset:0
  ds_read_b64_tr_b16 v[50:51], v23 offset:1024
  v_mfma_f32_32x32x16_bf16 v[156:171], v[108:111], v[92:95], v[156:171]
  v_mfma_f32_32x32x16_bf16 v[172:187], v[112:115], v[92:95], v[172:187]
  ds_read_b128 v[32:35], v17 offset:0
  ds_read_b64_tr_b16 v[52:53], v22 offset:4096
  ds_read_b64_tr_b16 v[54:55], v22 offset:5120
  ds_read_b64_tr_b16 v[56:57], v23 offset:4096
  ds_read_b64_tr_b16 v[58:59], v23 offset:5120
  v_mfma_f32_32x32x16_bf16 v[156:171], v[116:119], v[96:99], v[156:171]
  v_mfma_f32_32x32x16_bf16 v[172:187], v[120:123], v[96:99], v[172:187]
  ds_read_b128 v[36:39], v18 offset:0
  ds_read_b64_tr_b16 v[60:61], v22 offset:8192
  ds_read_b64_tr_b16 v[62:63], v22 offset:9216
  ds_read_b64_tr_b16 v[64:65], v23 offset:8192
  ds_read_b64_tr_b16 v[66:67], v23 offset:9216
  v_mfma_f32_32x32x16_bf16 v[156:171], v[124:127], v[100:103], v[156:171]
  v_mfma_f32_32x32x16_bf16 v[172:187], v[128:131], v[100:103], v[172:187]
  ds_read_b128 v[40:43], v19 offset:0
  ds_read_b64_tr_b16 v[68:69], v22 offset:12288
  ds_read_b64_tr_b16 v[70:71], v22 offset:13312
  ds_read_b64_tr_b16 v[72:73], v23 offset:12288
  ds_read_b64_tr_b16 v[74:75], v23 offset:13312
  v_mfma_f32_32x32x16_bf16 v[156:171], v[132:135], v[104:107], v[156:171]
  v_mfma_f32_32x32x16_bf16 v[172:187], v[136:139], v[104:107], v[172:187]
  s_waitcnt vmcnt(0) lgkmcnt(0)
  s_barrier
  ds_read_b128 v[92:95], v16 offset:36864
  ds_read_b64_tr_b16 v[108:109], v22 offset:36864
  ds_read_b64_tr_b16 v[110:111], v22 offset:37888
  ds_read_b64_tr_b16 v[112:113], v23 offset:36864
  ds_read_b64_tr_b16 v[114:115], v23 offset:37888
  v_mfma_f32_32x32x16_bf16 v[156:171], v[44:47], v[28:31], v[156:171]
  v_mfma_f32_32x32x16_bf16 v[172:187], v[48:51], v[28:31], v[172:187]
  ds_read_b128 v[96:99], v17 offset:36864
  ds_read_b64_tr_b16 v[116:117], v22 offset:40960
  ds_read_b64_tr_b16 v[118:119], v22 offset:41984
  ds_read_b64_tr_b16 v[120:121], v23 offset:40960
  ds_read_b64_tr_b16 v[122:123], v23 offset:41984
  v_mfma_f32_32x32x16_bf16 v[156:171], v[52:55], v[32:35], v[156:171]
  v_mfma_f32_32x32x16_bf16 v[172:187], v[56:59], v[32:35], v[172:187]
  ds_read_b128 v[100:103], v18 offset:36864
  ds_read_b64_tr_b16 v[124:125], v22 offset:45056
  ds_read_b64_tr_b16 v[126:127], v22 offset:46080
  ds_read_b64_tr_b16 v[128:129], v23 offset:45056
  ds_read_b64_tr_b16 v[130:131], v23 offset:46080
  v_mfma_f32_32x32x16_bf16 v[156:171], v[60:63], v[36:39], v[156:171]
  v_mfma_f32_32x32x16_bf16 v[172:187], v[64:67], v[36:39], v[172:187]
  ds_read_b128 v[104:107], v19 offset:36864
  ds_read_b64_tr_b16 v[132:133], v22 offset:49152
  ds_read_b64_tr_b16 v[134:135], v22 offset:50176
  ds_read_b64_tr_b16 v[136:137], v23 offset:49152
  ds_read_b64_tr_b16 v[138:139], v23 offset:50176
  v_mfma_f32_32x32x16_bf16 v[156:171], v[68:71], v[40:43], v[156:171]
  v_mfma_f32_32x32x16_bf16 v[172:187], v[72:75], v[40:43], v[172:187]
  s_waitcnt lgkmcnt(0)
  v_mfma_f32_32x32x16_bf16 v[156:171], v[108:111], v[92:95], v[156:171]
  v_mfma_f32_32x32x16_bf16 v[172:187], v[112:115], v[92:95], v[172:187]
  v_mfma_f32_32x32x16_bf16 v[156:171], v[116:119], v[96:99], v[156:171]
  v_mfma_f32_32x32x16_bf16 v[172:187], v[120:123], v[96:99], v[172:187]
  v_mfma_f32_32x32x16_bf16 v[156:171], v[124:127], v[100:103], v[156:171]
  v_mfma_f32_32x32x16_bf16 v[172:187], v[128:131], v[100:103], v[172:187]
  v_mfma_f32_32x32x16_bf16 v[156:171], v[132:135], v[104:107], v[156:171]
  v_mfma_f32_32x32x16_bf16 v[172:187], v[136:139], v[104:107], v[172:187]
  s_nop 15
proj_T_epi:
  s_mov_b32 s43, 1052289595
  s_cmp_lt_u32 s40, 8
  s_cselect_b32 s43, s43, 1.0
  s_lshl_b32 s44, s40, 3
  s_lshl_b32 s42, s52, 2
  s_add_u32 s44, s44, s42
  s_lshl_b32 s44, s44, 6
  s_add_u32 s44, s44, s57
  s_lshl_b32 s50, s44, 10
  s_mov_b32 s46, 65536
  s_cmp_lt_u32 s40, 8
  s_cbranch_scc1 proj_qk_store
  s_sub_u32 s44, s44, 4096
  s_lshl_b32 s50, s44, 11
  s_add_u32 s50, s50, 4194304
  s_mov_b32 s46, 131072
proj_qk_store:
  v_lshlrev_b32 v5, 4, v1
  v_mul_f32 v156, s43, v156
  v_mul_f32 v157, s43, v157
  v_mul_f32 v158, s43, v158
  v_mul_f32 v159, s43, v159
  v_mul_f32 v160, s43, v160
  v_mul_f32 v161, s43, v161
  v_mul_f32 v162, s43, v162
  v_mul_f32 v163, s43, v163
  v_cvt_pk_bf16_f32 v28, v156, v157
  v_cvt_pk_bf16_f32 v29, v158, v159
  v_cvt_pk_bf16_f32 v30, v160, v161
  v_cvt_pk_bf16_f32 v31, v162, v163
  buffer_store_dwordx4 v[28:31], v5, s[28:31], s50 offen sc0 sc1
  s_add_u32 s50, s50, s46
  v_mul_f32 v164, s43, v164
  v_mul_f32 v165, s43, v165
  v_mul_f32 v166, s43, v166
  v_mul_f32 v167, s43, v167
  v_mul_f32 v168, s43, v168
  v_mul_f32 v169, s43, v169
  v_mul_f32 v170, s43, v170
  v_mul_f32 v171, s43, v171
  v_cvt_pk_bf16_f32 v32, v164, v165
  v_cvt_pk_bf16_f32 v33, v166, v167
  v_cvt_pk_bf16_f32 v34, v168, v169
  v_cvt_pk_bf16_f32 v35, v170, v171
  buffer_store_dwordx4 v[32:35], v5, s[28:31], s50 offen sc0 sc1
  s_add_u32 s50, s50, s46
  v_mul_f32 v172, s43, v172
  v_mul_f32 v173, s43, v173
  v_mul_f32 v174, s43, v174
  v_mul_f32 v175, s43, v175
  v_mul_f32 v176, s43, v176
  v_mul_f32 v177, s43, v177
  v_mul_f32 v178, s43, v178
  v_mul_f32 v179, s43, v179
  v_cvt_pk_bf16_f32 v36, v172, v173
  v_cvt_pk_bf16_f32 v37, v174, v175
  v_cvt_pk_bf16_f32 v38, v176, v177
  v_cvt_pk_bf16_f32 v39, v178, v179
  buffer_store_dwordx4 v[36:39], v5, s[28:31], s50 offen sc0 sc1
  s_add_u32 s50, s50, s46
  v_mul_f32 v180, s43, v180
  v_mul_f32 v181, s43, v181
  v_mul_f32 v182, s43, v182
  v_mul_f32 v183, s43, v183
  v_mul_f32 v184, s43, v184
  v_mul_f32 v185, s43, v185
  v_mul_f32 v186, s43, v186
  v_mul_f32 v187, s43, v187
  v_cvt_pk_bf16_f32 v40, v180, v181
  v_cvt_pk_bf16_f32 v41, v182, v183
  v_cvt_pk_bf16_f32 v42, v184, v185
  v_cvt_pk_bf16_f32 v43, v186, v187
  buffer_store_dwordx4 v[40:43], v5, s[28:31], s50 offen sc0 sc1
  s_endpgm
proj_v_sel:
  s_cmp_ge_u32 s53, 8
  s_cbranch_scc1 proj_N_plain
  s_cmp_lg_u32 s53, s47
  s_cbranch_scc1 proj_N_none
  s_cmp_eq_u32 s52, 0
  s_cbranch_scc1 proj_N_T
proj_N_N:
  s_lshl_b32 s42, s58, 7
  s_add_u32 s42, s42, s54
  s_add_u32 m0, s56, 0
  s_mul_i32 s43, s58, s45
  buffer_load_dwordx4 v2, s[20:23], s42 offen lds
  s_add_u32 m0, s56, 1024
  s_add_u32 s43, s43, s55
  buffer_load_dwordx4 v3, s[20:23], s42 offen lds
  s_add_u32 m0, s56, 16384
  s_add_u32 s42, s43, s44
  buffer_load_dwordx4 v4, s[24:27], s43 offen lds
  s_add_u32 m0, s56, 17408
  s_lshl_b32 s43, s58, 11
  buffer_load_dwordx4 v4, s[24:27], s42 offen lds
  s_add_u32 m0, s60, 32768
  s_add_u32 s43, s43, s59
  s_mov_b64 exec, s[36:37]
  buffer_load_dwordx4 v6, s[32:35], s43 offen lds
  s_mov_b64 exec, -1
  s_add_u32 s58, s58, 1
  s_and_b32 s58, s58, 7
  s_lshl_b32 s42, s58, 7
  s_add_u32 s42, s42, s54
  s_add_u32 m0, s56, 36864
  s_mul_i32 s43, s58, s45
  buffer_load_dwordx4 v2, s[20:23], s42 offen lds
  s_add_u32 m0, s56, 37888
  s_add_u32 s43, s43, s55
  buffer_load_dwordx4 v3, s[20:23], s42 offen lds
  s_add_u32 m0, s56, 53248
  s_add_u32 s42, s43, s44
  buffer_load_dwordx4 v4, s[24:27], s43 offen lds
  s_add_u32 m0, s56, 54272
  s_lshl_b32 s43, s58, 11
  buffer_load_dwordx4 v4, s[24:27], s42 offen lds
  s_add_u32 m0, s60, 69632
  s_add_u32 s43, s43, s59
  s_mov_b64 exec, s[36:37]
  buffer_load_dwordx4 v6, s[32:35], s43 offen lds
  s_mov_b64 exec, -1
  s_add_u32 s58, s58, 1
  s_and_b32 s58, s58, 7
  v_and_b32 v8, 31, v1
  v_lshrrev_b32 v9, 5, v1
  v_bfe_u32 v10, v1, 1, 3
  v_xor_b32 v9, v9, v10
  v_lshlrev_b32 v9, 4, v9
  v_lshl_add_u32 v8, v8, 7, v9
  s_lshl_b32 s50, s51, 12
  v_add_u32 v8, s50, v8
  v_xor_b32 v12, 0, v8
  v_add_u32 v16, 73728, v12
  v_xor_b32 v13, 32, v8
  v_add_u32 v17, 73728, v13
  v_xor_b32 v14, 64, v8
  v_add_u32 v18, 73728, v14
  v_xor_b32 v15, 96, v8
  v_add_u32 v19, 73728, v15
  v_lshrrev_b32 v8, 5, v1
  v_bfe_u32 v9, v1, 2, 2
  v_lshl_add_u32 v8, v8, 3, v9
  v_bfe_u32 v10, v1, 4, 1
  v_and_b32 v11, 3, v1
  v_lshl_add_u32 v10, v10, 2, v11
  v_lshlrev_b32 v10, 3, v10
  v_lshl_add_u32 v24, v8, 6, v10
  v_add_u32 v24, 32768, v24
  v_add_u32 v25, 73728, v24
  v_lshl_add_u32 v8, v8, 8, v10
  s_lshl_b32 s50, s52, 1
  v_xor_b32 v9, s50, v9
  v_lshl_add_u32 v8, v9, 6, v8
  v_add_u32 v20, 16384, v8
  v_xor_b32 v21, 64, v20
  v_add_u32 v22, 73728, v20
  v_add_u32 v23, 73728, v21
  s_waitcnt vmcnt(5)
  s_barrier
  ds_read_b128 v[28:31], v12 offset:0
  ds_read_b64_tr_b16 v[44:45], v20 offset:0
  ds_read_b64_tr_b16 v[46:47], v20 offset:1024
  ds_read_b64_tr_b16 v[48:49], v21 offset:0
  ds_read_b64_tr_b16 v[50:51], v21 offset:1024
  ds_read_b64_tr_b16 v[76:77], v24 offset:0
  ds_read_b64_tr_b16 v[78:79], v24 offset:256
  ds_read_b128 v[32:35], v13 offset:0
  ds_read_b64_tr_b16 v[52:53], v20 offset:4096
  ds_read_b64_tr_b16 v[54:55], v20 offset:5120
  ds_read_b64_tr_b16 v[56:57], v21 offset:4096
  ds_read_b64_tr_b16 v[58:59], v21 offset:5120
  ds_read_b64_tr_b16 v[80:81], v24 offset:1024
  ds_read_b64_tr_b16 v[82:83], v24 offset:1280
  ds_read_b128 v[36:39], v14 offset:0
  ds_read_b64_tr_b16 v[60:61], v20 offset:8192
  ds_read_b64_tr_b16 v[62:63], v20 offset:9216
  ds_read_b64_tr_b16 v[64:65], v21 offset:8192
  ds_read_b64_tr_b16 v[66:67], v21 offset:9216
  ds_read_b64_tr_b16 v[84:85], v24 offset:2048
  ds_read_b64_tr_b16 v[86:87], v24 offset:2304
  ds_read_b128 v[40:43], v15 offset:0
  ds_read_b64_tr_b16 v[68:69], v20 offset:12288
  ds_read_b64_tr_b16 v[70:71], v20 offset:13312
  ds_read_b64_tr_b16 v[72:73], v21 offset:12288
  ds_read_b64_tr_b16 v[74:75], v21 offset:13312
  ds_read_b64_tr_b16 v[88:89], v24 offset:3072
  ds_read_b64_tr_b16 v[90:91], v24 offset:3328
  s_lshl_b32 s42, s58, 7
  s_add_u32 s42, s42, s54
  s_add_u32 m0, s56, 73728
  s_mul_i32 s43, s58, s45
  buffer_load_dwordx4 v2, s[20:23], s42 offen lds
  s_add_u32 m0, s56, 74752
  s_add_u32 s43, s43, s55
  buffer_load_dwordx4 v3, s[20:23], s42 offen lds
  s_add_u32 m0, s56, 90112
  s_add_u32 s42, s43, s44
  buffer_load_dwordx4 v4, s[24:27], s43 offen lds
  s_add_u32 m0, s56, 91136
  s_lshl_b32 s43, s58, 11
  buffer_load_dwordx4 v4, s[24:27], s42 offen lds
  s_add_u32 m0, s60, 106496
  s_add_u32 s43, s43, s59
  s_mov_b64 exec, s[36:37]
  buffer_load_dwordx4 v6, s[32:35], s43 offen lds
  s_mov_b64 exec, -1
  s_add_u32 s58, s58, 1
  s_and_b32 s58, s58, 7
  s_lshl_b32 s42, s58, 7
  s_add_u32 s42, s42, s54
  s_add_u32 m0, s56, 110592
  s_mul_i32 s43, s58, s45
  buffer_load_dwordx4 v2, s[20:23], s42 offen lds
  s_add_u32 m0, s56, 111616
  s_add_u32 s43, s43, s55
  buffer_load_dwordx4 v3, s[20:23], s42 offen lds
  s_add_u32 m0, s56, 126976
  s_add_u32 s42, s43, s44
  buffer_load_dwordx4 v4, s[24:27], s43 offen lds
  s_add_u32 m0, s56, 128000
  s_lshl_b32 s43, s58, 11
  buffer_load_dwordx4 v4, s[24:27], s42 offen lds
  s_add_u32 m0, s60, 143360
  s_add_u32 s43, s43, s59
  s_mov_b64 exec, s[36:37]
  buffer_load_dwordx4 v6, s[32:35], s43 offen lds
  s_mov_b64 exec, -1
  s_add_u32 s58, s58, 1
  s_and_b32 s58, s58, 7
  s_waitcnt vmcnt(10) lgkmcnt(0)
  s_barrier
  ds_read_b128 v[92:95], v12 offset:36864
  ds_read_b64_tr_b16 v[108:109], v20 offset:36864
  ds_read_b64_tr_b16 v[110:111], v20 offset:37888
  ds_read_b64_tr_b16 v[112:113], v21 offset:36864
  ds_read_b64_tr_b16 v[114:115], v21 offset:37888
  ds_read_b64_tr_b16 v[140:141], v24 offset:36864
  ds_read_b64_tr_b16 v[142:143], v24 offset:37120
  v_mfma_f32_32x32x16_bf16 v[156:171], v[28:31], v[44:47], 0
  v_mfma_f32_32x32x16_bf16 v[172:187], v[28:31], v[48:51], 0
  v_mfma_f32_32x32x16_bf16 v[188:203], v[28:31], v[76:79], 0
  s_lshl_b32 s42, s58, 7
  s_add_u32 s42, s42, s54
  s_add_u32 m0, s56, 0
  s_mul_i32 s43, s58, s45
  buffer_load_dwordx4 v2, s[20:23], s42 offen lds
  ds_read_b128 v[96:99], v13 offset:36864
  ds_read_b64_tr_b16 v[116:117], v20 offset:40960
  ds_read_b64_tr_b16 v[118:119], v20 offset:41984
  ds_read_b64_tr_b16 v[120:121], v21 offset:40960
  ds_read_b64_tr_b16 v[122:123], v21 offset:41984
  ds_read_b64_tr_b16 v[144:145], v24 offset:37888
  ds_read_b64_tr_b16 v[146:147], v24 offset:38144
  v_mfma_f32_32x32x16_bf16 v[156:171], v[32:35], v[52:55], v[156:171]
  v_mfma_f32_32x32x16_bf16 v[172:187], v[32:35], v[56:59], v[172:187]
  v_mfma_f32_32x32x16_bf16 v[188:203], v[32:35], v[80:83], v[188:203]
  s_add_u32 m0, s56, 1024
  s_add_u32 s43, s43, s55
  buffer_load_dwordx4 v3, s[20:23], s42 offen lds
  ds_read_b128 v[100:103], v14 offset:36864
  ds_read_b64_tr_b16 v[124:125], v20 offset:45056
  ds_read_b64_tr_b16 v[126:127], v20 offset:46080
  ds_read_b64_tr_b16 v[128:129], v21 offset:45056
  ds_read_b64_tr_b16 v[130:131], v21 offset:46080
  ds_read_b64_tr_b16 v[148:149], v24 offset:38912
  ds_read_b64_tr_b16 v[150:151], v24 offset:39168
  v_mfma_f32_32x32x16_bf16 v[156:171], v[36:39], v[60:63], v[156:171]
  v_mfma_f32_32x32x16_bf16 v[172:187], v[36:39], v[64:67], v[172:187]
  v_mfma_f32_32x32x16_bf16 v[188:203], v[36:39], v[84:87], v[188:203]
  s_add_u32 m0, s56, 16384
  s_add_u32 s42, s43, s44
  buffer_load_dwordx4 v4, s[24:27], s43 offen lds
  ds_read_b128 v[104:107], v15 offset:36864
  ds_read_b64_tr_b16 v[132:133], v20 offset:49152
  ds_read_b64_tr_b16 v[134:135], v20 offset:50176
  ds_read_b64_tr_b16 v[136:137], v21 offset:49152
  ds_read_b64_tr_b16 v[138:139], v21 offset:50176
  ds_read_b64_tr_b16 v[152:153], v24 offset:39936
  ds_read_b64_tr_b16 v[154:155], v24 offset:40192
  v_mfma_f32_32x32x16_bf16 v[156:171], v[40:43], v[68:71], v[156:171]
  v_mfma_f32_32x32x16_bf16 v[172:187], v[40:43], v[72:75], v[172:187]
  v_mfma_f32_32x32x16_bf16 v[188:203], v[40:43], v[88:91], v[188:203]
  s_add_u32 m0, s56, 17408
  s_lshl_b32 s43, s58, 11
  buffer_load_dwordx4 v4, s[24:27], s42 offen lds
  s_add_u32 m0, s60, 32768
  s_add_u32 s43, s43, s59
  s_mov_b64 exec, s[36:37]
  buffer_load_dwordx4 v6, s[32:35], s43 offen lds
  s_mov_b64 exec, -1
  s_add_u32 s58, s58, 1
  s_and_b32 s58, s58, 7
  s_waitcnt vmcnt(10) lgkmcnt(0)
  s_barrier
  ds_read_b128 v[28:31], v16 offset:0
  ds_read_b64_tr_b16 v[44:45], v22 offset:0
  ds_read_b64_tr_b16 v[46:47], v22 offset:1024
  ds_read_b64_tr_b16 v[48:49], v23 offset:0
  ds_read_b64_tr_b16 v[50:51], v23 offset:1024
  ds_read_b64_tr_b16 v[76:77], v25 offset:0
  ds_read_b64_tr_b16 v[78:79], v25 offset:256
  v_mfma_f32_32x32x16_bf16 v[156:171], v[92:95], v[108:111], v[156:171]
  v_mfma_f32_32x32x16_bf16 v[172:187], v[92:95], v[112:115], v[172:187]
  v_mfma_f32_32x32x16_bf16 v[188:203], v[92:95], v[140:143], v[188:203]
  s_lshl_b32 s42, s58, 7
  s_add_u32 s42, s42, s54
  s_add_u32 m0, s56, 36864
  s_mul_i32 s43, s58, s45
  buffer_load_dwordx4 v2, s[20:23], s42 offen lds
  ds_read_b128 v[32:35], v17 offset:0
  ds_read_b64_tr_b16 v[52:53], v22 offset:4096
  ds_read_b64_tr_b16 v[54:55], v22 offset:5120
  ds_read_b64_tr_b16 v[56:57], v23 offset:4096
  ds_read_b64_tr_b16 v[58:59], v23 offset:5120
  ds_read_b64_tr_b16 v[80:81], v25 offset:1024
  ds_read_b64_tr_b16 v[82:83], v25 offset:1280
  v_mfma_f32_32x32x16_bf16 v[156:171], v[96:99], v[116:119], v[156:171]
  v_mfma_f32_32x32x16_bf16 v[172:187], v[96:99], v[120:123], v[172:187]
  v_mfma_f32_32x32x16_bf16 v[188:203], v[96:99], v[144:147], v[188:203]
  s_add_u32 m0, s56, 37888
  s_add_u32 s43, s43, s55
  buffer_load_dwordx4 v3, s[20:23], s42 offen lds
  ds_read_b128 v[36:39], v18 offset:0
  ds_read_b64_tr_b16 v[60:61], v22 offset:8192
  ds_read_b64_tr_b16 v[62:63], v22 offset:9216
  ds_read_b64_tr_b16 v[64:65], v23 offset:8192
  ds_read_b64_tr_b16 v[66:67], v23 offset:9216
  ds_read_b64_tr_b16 v[84:85], v25 offset:2048
  ds_read_b64_tr_b16 v[86:87], v25 offset:2304
  v_mfma_f32_32x32x16_bf16 v[156:171], v[100:103], v[124:127], v[156:171]
  v_mfma_f32_32x32x16_bf16 v[172:187], v[100:103], v[128:131], v[172:187]
  v_mfma_f32_32x32x16_bf16 v[188:203], v[100:103], v[148:151], v[188:203]
  s_add_u32 m0, s56, 53248
  s_add_u32 s42, s43, s44
  buffer_load_dwordx4 v4, s[24:27], s43 offen lds
  ds_read_b128 v[40:43], v19 offset:0
  ds_read_b64_tr_b16 v[68:69], v22 offset:12288
  ds_read_b64_tr_b16 v[70:71], v22 offset:13312
  ds_read_b64_tr_b16 v[72:73], v23 offset:12288
  ds_read_b64_tr_b16 v[74:75], v23 offset:13312
  ds_read_b64_tr_b16 v[88:89], v25 offset:3072
  ds_read_b64_tr_b16 v[90:91], v25 offset:3328
  v_mfma_f32_32x32x16_bf16 v[156:171], v[104:107], v[132:135], v[156:171]
  v_mfma_f32_32x32x16_bf16 v[172:187], v[104:107], v[136:139], v[172:187]
  v_mfma_f32_32x32x16_bf16 v[188:203], v[104:107], v[152:155], v[188:203]
  s_add_u32 m0, s56, 54272
  s_lshl_b32 s43, s58, 11
  buffer_load_dwordx4 v4, s[24:27], s42 offen lds
  s_add_u32 m0, s60, 69632
  s_add_u32 s43, s43, s59
  s_mov_b64 exec, s[36:37]
  buffer_load_dwordx4 v6, s[32:35], s43 offen lds
  s_mov_b64 exec, -1
  s_add_u32 s58, s58, 1
  s_and_b32 s58, s58, 7
  s_waitcnt vmcnt(10) lgkmcnt(0)
  s_barrier
  ds_read_b128 v[92:95], v16 offset:36864
  ds_read_b64_tr_b16 v[108:109], v22 offset:36864
  ds_read_b64_tr_b16 v[110:111], v22 offset:37888
  ds_read_b64_tr_b16 v[112:113], v23 offset:36864
  ds_read_b64_tr_b16 v[114:115], v23 offset:37888
  ds_read_b64_tr_b16 v[140:141], v25 offset:36864
  ds_read_b64_tr_b16 v[142:143], v25 offset:37120
  v_mfma_f32_32x32x16_bf16 v[156:171], v[28:31], v[44:47], v[156:171]
  v_mfma_f32_32x32x16_bf16 v[172:187], v[28:31], v[48:51], v[172:187]
  v_mfma_f32_32x32x16_bf16 v[188:203], v[28:31], v[76:79], v[188:203]
  s_lshl_b32 s42, s58, 7
  s_add_u32 s42, s42, s54
  s_add_u32 m0, s56, 73728
  s_mul_i32 s43, s58, s45
  buffer_load_dwordx4 v2, s[20:23], s42 offen lds
  ds_read_b128 v[96:99], v17 offset:36864
  ds_read_b64_tr_b16 v[116:117], v22 offset:40960
  ds_read_b64_tr_b16 v[118:119], v22 offset:41984
  ds_read_b64_tr_b16 v[120:121], v23 offset:40960
  ds_read_b64_tr_b16 v[122:123], v23 offset:41984
  ds_read_b64_tr_b16 v[144:145], v25 offset:37888
  ds_read_b64_tr_b16 v[146:147], v25 offset:38144
  v_mfma_f32_32x32x16_bf16 v[156:171], v[32:35], v[52:55], v[156:171]
  v_mfma_f32_32x32x16_bf16 v[172:187], v[32:35], v[56:59], v[172:187]
  v_mfma_f32_32x32x16_bf16 v[188:203], v[32:35], v[80:83], v[188:203]
  s_add_u32 m0, s56, 74752
  s_add_u32 s43, s43, s55
  buffer_load_dwordx4 v3, s[20:23], s42 offen lds
  ds_read_b128 v[100:103], v18 offset:36864
  ds_read_b64_tr_b16 v[124:125], v22 offset:45056
  ds_read_b64_tr_b16 v[126:127], v22 offset:46080
  ds_read_b64_tr_b16 v[128:129], v23 offset:45056
  ds_read_b64_tr_b16 v[130:131], v23 offset:46080
  ds_read_b64_tr_b16 v[148:149], v25 offset:38912
  ds_read_b64_tr_b16 v[150:151], v25 offset:39168
  v_mfma_f32_32x32x16_bf16 v[156:171], v[36:39], v[60:63], v[156:171]
  v_mfma_f32_32x32x16_bf16 v[172:187], v[36:39], v[64:67], v[172:187]
  v_mfma_f32_32x32x16_bf16 v[188:203], v[36:39], v[84:87], v[188:203]
  s_add_u32 m0, s56, 90112
  s_add_u32 s42, s43, s44
  buffer_load_dwordx4 v4, s[24:27], s43 offen lds
  ds_read_b128 v[104:107], v19 offset:36864
  ds_read_b64_tr_b16 v[132:133], v22 offset:49152
  ds_read_b64_tr_b16 v[134:135], v22 offset:50176
  ds_read_b64_tr_b16 v[136:137], v23 offset:49152
  ds_read_b64_tr_b16 v[138:139], v23 offset:50176
  ds_read_b64_tr_b16 v[152:153], v25 offset:39936
  ds_read_b64_tr_b16 v[154:155], v25 offset:40192
  v_mfma_f32_32x32x16_bf16 v[156:171], v[40:43], v[68:71], v[156:171]
  v_mfma_f32_32x32x16_bf16 v[172:187], v[40:43], v[72:75], v[172:187]
  v_mfma_f32_32x32x16_bf16 v[188:203], v[40:43], v[88:91], v[188:203]
  s_add_u32 m0, s56, 91136
  s_lshl_b32 s43, s58, 11
  buffer_load_dwordx4 v4, s[24:27], s42 offen lds
  s_add_u32 m0, s60, 106496
  s_add_u32 s43, s43, s59
  s_mov_b64 exec, s[36:37]
  buffer_load_dwordx4 v6, s[32:35], s43 offen lds
  s_mov_b64 exec, -1
  s_add_u32 s58, s58, 1
  s_and_b32 s58, s58, 7
  s_waitcnt vmcnt(10) lgkmcnt(0)
  s_barrier
  ds_read_b128 v[28:31], v12 offset:0
  ds_read_b64_tr_b16 v[44:45], v20 offset:0
  ds_read_b64_tr_b16 v[46:47], v20 offset:1024
  ds_read_b64_tr_b16 v[48:49], v21 offset:0
  ds_read_b64_tr_b16 v[50:51], v21 offset:1024
  ds_read_b64_tr_b16 v[76:77], v24 offset:0
  ds_read_b64_tr_b16 v[78:79], v24 offset:256
  v_mfma_f32_32x32x16_bf16 v[156:171], v[92:95], v[108:111], v[156:171]
  v_mfma_f32_32x32x16_bf16 v[172:187], v[92:95], v[112:115], v[172:187]
  v_mfma_f32_32x32x16_bf16 v[188:203], v[92:95], v[140:143], v[188:203]
  s_lshl_b32 s42, s58, 7
  s_add_u32 s42, s42, s54
  s_add_u32 m0, s56, 110592
  s_mul_i32 s43, s58, s45
  buffer_load_dwordx4 v2, s[20:23], s42 offen lds
  ds_read_b128 v[32:35], v13 offset:0
  ds_read_b64_tr_b16 v[52:53], v20 offset:4096
  ds_read_b64_tr_b16 v[54:55], v20 offset:5120
  ds_read_b64_tr_b16 v[56:57], v21 offset:4096
  ds_read_b64_tr_b16 v[58:59], v21 offset:5120
  ds_read_b64_tr_b16 v[80:81], v24 offset:1024
  ds_read_b64_tr_b16 v[82:83], v24 offset:1280
  v_mfma_f32_32x32x16_bf16 v[156:171], v[96:99], v[116:119], v[156:171]
  v_mfma_f32_32x32x16_bf16 v[172:187], v[96:99], v[120:123], v[172:187]
  v_mfma_f32_32x32x16_bf16 v[188:203], v[96:99], v[144:147], v[188:203]
  s_add_u32 m0, s56, 111616
  s_add_u32 s43, s43, s55
  buffer_load_dwordx4 v3, s[20:23], s42 offen lds
  ds_read_b128 v[36:39], v14 offset:0
  ds_read_b64_tr_b16 v[60:61], v20 offset:8192
  ds_read_b64_tr_b16 v[62:63], v20 offset:9216
  ds_read_b64_tr_b16 v[64:65], v21 offset:8192
  ds_read_b64_tr_b16 v[66:67], v21 offset:9216
  ds_read_b64_tr_b16 v[84:85], v24 offset:2048
  ds_read_b64_tr_b16 v[86:87], v24 offset:2304
  v_mfma_f32_32x32x16_bf16 v[156:171], v[100:103], v[124:127], v[156:171]
  v_mfma_f32_32x32x16_bf16 v[172:187], v[100:103], v[128:131], v[172:187]
  v_mfma_f32_32x32x16_bf16 v[188:203], v[100:103], v[148:151], v[188:203]
  s_add_u32 m0, s56, 126976
  s_add_u32 s42, s43, s44
  buffer_load_dwordx4 v4, s[24:27], s43 offen lds
  ds_read_b128 v[40:43], v15 offset:0
  ds_read_b64_tr_b16 v[68:69], v20 offset:12288
  ds_read_b64_tr_b16 v[70:71], v20 offset:13312
  ds_read_b64_tr_b16 v[72:73], v21 offset:12288
  ds_read_b64_tr_b16 v[74:75], v21 offset:13312
  ds_read_b64_tr_b16 v[88:89], v24 offset:3072
  ds_read_b64_tr_b16 v[90:91], v24 offset:3328
  v_mfma_f32_32x32x16_bf16 v[156:171], v[104:107], v[132:135], v[156:171]
  v_mfma_f32_32x32x16_bf16 v[172:187], v[104:107], v[136:139], v[172:187]
  v_mfma_f32_32x32x16_bf16 v[188:203], v[104:107], v[152:155], v[188:203]
  s_add_u32 m0, s56, 128000
  s_lshl_b32 s43, s58, 11
  buffer_load_dwordx4 v4, s[24:27], s42 offen lds
  s_add_u32 m0, s60, 143360
  s_add_u32 s43, s43, s59
  s_mov_b64 exec, s[36:37]
  buffer_load_dwordx4 v6, s[32:35], s43 offen lds
  s_mov_b64 exec, -1
  s_add_u32 s58, s58, 1
  s_and_b32 s58, s58, 7
  s_waitcnt vmcnt(10) lgkmcnt(0)
  s_barrier
  ds_read_b128 v[92:95], v12 offset:36864
  ds_read_b64_tr_b16 v[108:109], v20 offset:36864
  ds_read_b64_tr_b16 v[110:111], v20 offset:37888
  ds_read_b64_tr_b16 v[112:113], v21 offset:36864
  ds_read_b64_tr_b16 v[114:115], v21 offset:37888
  ds_read_b64_tr_b16 v[140:141], v24 offset:36864
  ds_read_b64_tr_b16 v[142:143], v24 offset:37120
  v_mfma_f32_32x32x16_bf16 v[156:171], v[28:31], v[44:47], v[156:171]
  v_mfma_f32_32x32x16_bf16 v[172:187], v[28:31], v[48:51], v[172:187]
  v_mfma_f32_32x32x16_bf16 v[188:203], v[28:31], v[76:79], v[188:203]
  ds_read_b128 v[96:99], v13 offset:36864
  ds_read_b64_tr_b16 v[116:117], v20 offset:40960
  ds_read_b64_tr_b16 v[118:119], v20 offset:41984
  ds_read_b64_tr_b16 v[120:121], v21 offset:40960
  ds_read_b64_tr_b16 v[122:123], v21 offset:41984
  ds_read_b64_tr_b16 v[144:145], v24 offset:37888
  ds_read_b64_tr_b16 v[146:147], v24 offset:38144
  v_mfma_f32_32x32x16_bf16 v[156:171], v[32:35], v[52:55], v[156:171]
  v_mfma_f32_32x32x16_bf16 v[172:187], v[32:35], v[56:59], v[172:187]
  v_mfma_f32_32x32x16_bf16 v[188:203], v[32:35], v[80:83], v[188:203]
  ds_read_b128 v[100:103], v14 offset:36864
  ds_read_b64_tr_b16 v[124:125], v20 offset:45056
  ds_read_b64_tr_b16 v[126:127], v20 offset:46080
  ds_read_b64_tr_b16 v[128:129], v21 offset:45056
  ds_read_b64_tr_b16 v[130:131], v21 offset:46080
  ds_read_b64_tr_b16 v[148:149], v24 offset:38912
  ds_read_b64_tr_b16 v[150:151], v24 offset:39168
  v_mfma_f32_32x32x16_bf16 v[156:171], v[36:39], v[60:63], v[156:171]
  v_mfma_f32_32x32x16_bf16 v[172:187], v[36:39], v[64:67], v[172:187]
  v_mfma_f32_32x32x16_bf16 v[188:203], v[36:39], v[84:87], v[188:203]
  ds_read_b128 v[104:107], v15 offset:36864
  ds_read_b64_tr_b16 v[132:133], v20 offset:49152
  ds_read_b64_tr_b16 v[134:135], v20 offset:50176
  ds_read_b64_tr_b16 v[136:137], v21 offset:49152
  ds_read_b64_tr_b16 v[138:139], v21 offset:50176
  ds_read_b64_tr_b16 v[152:153], v24 offset:39936
  ds_read_b64_tr_b16 v[154:155], v24 offset:40192
  v_mfma_f32_32x32x16_bf16 v[156:171], v[40:43], v[68:71], v[156:171]
  v_mfma_f32_32x32x16_bf16 v[172:187], v[40:43], v[72:75], v[172:187]
  v_mfma_f32_32x32x16_bf16 v[188:203], v[40:43], v[88:91], v[188:203]
  s_waitcnt vmcnt(5) lgkmcnt(0)
  s_barrier
  ds_read_b128 v[28:31], v16 offset:0
  ds_read_b64_tr_b16 v[44:45], v22 offset:0
  ds_read_b64_tr_b16 v[46:47], v22 offset:1024
  ds_read_b64_tr_b16 v[48:49], v23 offset:0
  ds_read_b64_tr_b16 v[50:51], v23 offset:1024
  ds_read_b64_tr_b16 v[76:77], v25 offset:0
  ds_read_b64_tr_b16 v[78:79], v25 offset:256
  v_mfma_f32_32x32x16_bf16 v[156:171], v[92:95], v[108:111], v[156:171]
  v_mfma_f32_32x32x16_bf16 v[172:187], v[92:95], v[112:115], v[172:187]
  v_mfma_f32_32x32x16_bf16 v[188:203], v[92:95], v[140:143], v[188:203]
  ds_read_b128 v[32:35], v17 offset:0
  ds_read_b64_tr_b16 v[52:53], v22 offset:4096
  ds_read_b64_tr_b16 v[54:55], v22 offset:5120
  ds_read_b64_tr_b16 v[56:57], v23 offset:4096
  ds_read_b64_tr_b16 v[58:59], v23 offset:5120
  ds_read_b64_tr_b16 v[80:81], v25 offset:1024
  ds_read_b64_tr_b16 v[82:83], v25 offset:1280
  v_mfma_f32_32x32x16_bf16 v[156:171], v[96:99], v[116:119], v[156:171]
  v_mfma_f32_32x32x16_bf16 v[172:187], v[96:99], v[120:123], v[172:187]
  v_mfma_f32_32x32x16_bf16 v[188:203], v[96:99], v[144:147], v[188:203]
  ds_read_b128 v[36:39], v18 offset:0
  ds_read_b64_tr_b16 v[60:61], v22 offset:8192
  ds_read_b64_tr_b16 v[62:63], v22 offset:9216
  ds_read_b64_tr_b16 v[64:65], v23 offset:8192
  ds_read_b64_tr_b16 v[66:67], v23 offset:9216
  ds_read_b64_tr_b16 v[84:85], v25 offset:2048
  ds_read_b64_tr_b16 v[86:87], v25 offset:2304
  v_mfma_f32_32x32x16_bf16 v[156:171], v[100:103], v[124:127], v[156:171]
  v_mfma_f32_32x32x16_bf16 v[172:187], v[100:103], v[128:131], v[172:187]
  v_mfma_f32_32x32x16_bf16 v[188:203], v[100:103], v[148:151], v[188:203]
  ds_read_b128 v[40:43], v19 offset:0
  ds_read_b64_tr_b16 v[68:69], v22 offset:12288
  ds_read_b64_tr_b16 v[70:71], v22 offset:13312
  ds_read_b64_tr_b16 v[72:73], v23 offset:12288
  ds_read_b64_tr_b16 v[74:75], v23 offset:13312
  ds_read_b64_tr_b16 v[88:89], v25 offset:3072
  ds_read_b64_tr_b16 v[90:91], v25 offset:3328
  v_mfma_f32_32x32x16_bf16 v[156:171], v[104:107], v[132:135], v[156:171]
  v_mfma_f32_32x32x16_bf16 v[172:187], v[104:107], v[136:139], v[172:187]
  v_mfma_f32_32x32x16_bf16 v[188:203], v[104:107], v[152:155], v[188:203]
  s_waitcnt vmcnt(0) lgkmcnt(0)
  s_barrier
  ds_read_b128 v[92:95], v16 offset:36864
  ds_read_b64_tr_b16 v[108:109], v22 offset:36864
  ds_read_b64_tr_b16 v[110:111], v22 offset:37888
  ds_read_b64_tr_b16 v[112:113], v23 offset:36864
  ds_read_b64_tr_b16 v[114:115], v23 offset:37888
  ds_read_b64_tr_b16 v[140:141], v25 offset:36864
  ds_read_b64_tr_b16 v[142:143], v25 offset:37120
  v_mfma_f32_32x32x16_bf16 v[156:171], v[28:31], v[44:47], v[156:171]
  v_mfma_f32_32x32x16_bf16 v[172:187], v[28:31], v[48:51], v[172:187]
  v_mfma_f32_32x32x16_bf16 v[188:203], v[28:31], v[76:79], v[188:203]
  ds_read_b128 v[96:99], v17 offset:36864
  ds_read_b64_tr_b16 v[116:117], v22 offset:40960
  ds_read_b64_tr_b16 v[118:119], v22 offset:41984
  ds_read_b64_tr_b16 v[120:121], v23 offset:40960
  ds_read_b64_tr_b16 v[122:123], v23 offset:41984
  ds_read_b64_tr_b16 v[144:145], v25 offset:37888
  ds_read_b64_tr_b16 v[146:147], v25 offset:38144
  v_mfma_f32_32x32x16_bf16 v[156:171], v[32:35], v[52:55], v[156:171]
  v_mfma_f32_32x32x16_bf16 v[172:187], v[32:35], v[56:59], v[172:187]
  v_mfma_f32_32x32x16_bf16 v[188:203], v[32:35], v[80:83], v[188:203]
  ds_read_b128 v[100:103], v18 offset:36864
  ds_read_b64_tr_b16 v[124:125], v22 offset:45056
  ds_read_b64_tr_b16 v[126:127], v22 offset:46080
  ds_read_b64_tr_b16 v[128:129], v23 offset:45056
  ds_read_b64_tr_b16 v[130:131], v23 offset:46080
  ds_read_b64_tr_b16 v[148:149], v25 offset:38912
  ds_read_b64_tr_b16 v[150:151], v25 offset:39168
  v_mfma_f32_32x32x16_bf16 v[156:171], v[36:39], v[60:63], v[156:171]
  v_mfma_f32_32x32x16_bf16 v[172:187], v[36:39], v[64:67], v[172:187]
  v_mfma_f32_32x32x16_bf16 v[188:203], v[36:39], v[84:87], v[188:203]
  ds_read_b128 v[104:107], v19 offset:36864
  ds_read_b64_tr_b16 v[132:133], v22 offset:49152
  ds_read_b64_tr_b16 v[134:135], v22 offset:50176
  ds_read_b64_tr_b16 v[136:137], v23 offset:49152
  ds_read_b64_tr_b16 v[138:139], v23 offset:50176
  ds_read_b64_tr_b16 v[152:153], v25 offset:39936
  ds_read_b64_tr_b16 v[154:155], v25 offset:40192
  v_mfma_f32_32x32x16_bf16 v[156:171], v[40:43], v[68:71], v[156:171]
  v_mfma_f32_32x32x16_bf16 v[172:187], v[40:43], v[72:75], v[172:187]
  v_mfma_f32_32x32x16_bf16 v[188:203], v[40:43], v[88:91], v[188:203]
  s_waitcnt lgkmcnt(0)
  v_mfma_f32_32x32x16_bf16 v[156:171], v[92:95], v[108:111], v[156:171]
  v_mfma_f32_32x32x16_bf16 v[172:187], v[92:95], v[112:115], v[172:187]
  v_mfma_f32_32x32x16_bf16 v[188:203], v[92:95], v[140:143], v[188:203]
  v_mfma_f32_32x32x16_bf16 v[156:171], v[96:99], v[116:119], v[156:171]
  v_mfma_f32_32x32x16_bf16 v[172:187], v[96:99], v[120:123], v[172:187]
  v_mfma_f32_32x32x16_bf16 v[188:203], v[96:99], v[144:147], v[188:203]
  v_mfma_f32_32x32x16_bf16 v[156:171], v[100:103], v[124:127], v[156:171]
  v_mfma_f32_32x32x16_bf16 v[172:187], v[100:103], v[128:131], v[172:187]
  v_mfma_f32_32x32x16_bf16 v[188:203], v[100:103], v[148:151], v[188:203]
  v_mfma_f32_32x32x16_bf16 v[156:171], v[104:107], v[132:135], v[156:171]
  v_mfma_f32_32x32x16_bf16 v[172:187], v[104:107], v[136:139], v[172:187]
  v_mfma_f32_32x32x16_bf16 v[188:203], v[104:107], v[152:155], v[188:203]
  s_nop 15
  s_lshl_b32 s50, s57, 11
  s_add_u32 s50, s50, 8257536
  v_and_b32 v8, 3, v1
  v_and_b32 v9, 4, v1
  v_lshl_or_b32 v8, v9, 1, v8
  v_and_b32 v9, 8, v1
  v_lshrrev_b32 v9, 1, v9
  v_or_b32 v8, v8, v9
  v_lshlrev_b32 v8, 4, v8
  v_lshrrev_b32 v9, 5, v1
  v_lshl_add_u32 v8, v9, 9, v8
  v_bfe_u32 v9, v1, 4, 1
  v_lshl_add_u32 v5, v9, 17, v8
  v_cvt_pk_bf16_f32 v44, v188, v189
  v_cvt_pk_bf16_f32 v45, v190, v191
  v_cvt_pk_bf16_f32 v46, v192, v193
  v_cvt_pk_bf16_f32 v47, v194, v195
  v_cvt_pk_bf16_f32 v48, v196, v197
  v_cvt_pk_bf16_f32 v49, v198, v199
  v_cvt_pk_bf16_f32 v50, v200, v201
  v_cvt_pk_bf16_f32 v51, v202, v203
  v_and_b32 v8, 16, v1
  v_cmp_ne_u32 vcc, 0, v8
  s_and_saveexec_b64 s[48:49], vcc
  buffer_store_dwordx4 v[44:47], v5, s[28:31], s50 offen offset:1024 sc0 sc1
  buffer_store_dwordx4 v[48:51], v5, s[28:31], s50 offen offset:1280 sc0 sc1
  s_mov_b64 exec, s[48:49]
  s_branch proj_N_epi
proj_N_T:
  s_lshl_b32 s42, s58, 7
  s_add_u32 s42, s42, s54
  s_add_u32 m0, s56, 0
  s_mul_i32 s43, s58, s45
  buffer_load_dwordx4 v2, s[20:23], s42 offen lds
  s_add_u32 m0, s56, 1024
  s_add_u32 s43, s43, s55
  buffer_load_dwordx4 v3, s[20:23], s42 offen lds
  s_add_u32 m0, s56, 16384
  s_add_u32 s42, s43, s44
  buffer_load_dwordx4 v4, s[24:27], s43 offen lds
  s_add_u32 m0, s56, 17408
  s_lshl_b32 s43, s58, 11
  buffer_load_dwordx4 v4, s[24:27], s42 offen lds
  s_add_u32 m0, s60, 32768
  s_add_u32 s43, s43, s59
  s_mov_b64 exec, s[36:37]
  buffer_load_dwordx4 v6, s[32:35], s43 offen lds
  s_mov_b64 exec, -1
  s_add_u32 s58, s58, 1
  s_and_b32 s58, s58, 7
  s_lshl_b32 s42, s58, 7
  s_add_u32 s42, s42, s54
  s_add_u32 m0, s56, 36864
  s_mul_i32 s43, s58, s45
  buffer_load_dwordx4 v2, s[20:23], s42 offen lds
  s_add_u32 m0, s56, 37888
  s_add_u32 s43, s43, s55
  buffer_load_dwordx4 v3, s[20:23], s42 offen lds
  s_add_u32 m0, s56, 53248
  s_add_u32 s42, s43, s44
  buffer_load_dwordx4 v4, s[24:27], s43 offen lds
  s_add_u32 m0, s56, 54272
  s_lshl_b32 s43, s58, 11
  buffer_load_dwordx4 v4, s[24:27], s42 offen lds
  s_add_u32 m0, s60, 69632
  s_add_u32 s43, s43, s59
  s_mov_b64 exec, s[36:37]
  buffer_load_dwordx4 v6, s[32:35], s43 offen lds
  s_mov_b64 exec, -1
  s_add_u32 s58, s58, 1
  s_and_b32 s58, s58, 7
  v_and_b32 v8, 31, v1
  v_lshrrev_b32 v9, 5, v1
  v_bfe_u32 v10, v1, 1, 3
  v_xor_b32 v9, v9, v10
  v_lshlrev_b32 v9, 4, v9
  v_lshl_add_u32 v8, v8, 7, v9
  s_lshl_b32 s50, s51, 12
  v_add_u32 v8, s50, v8
  v_xor_b32 v12, 0, v8
  v_add_u32 v16, 73728, v12
  v_xor_b32 v13, 32, v8
  v_add_u32 v17, 73728, v13
  v_xor_b32 v14, 64, v8
  v_add_u32 v18, 73728, v14
  v_xor_b32 v15, 96, v8
  v_add_u32 v19, 73728, v15
  v_lshrrev_b32 v8, 5, v1
  v_bfe_u32 v9, v1, 2, 2
  v_lshl_add_u32 v8, v8, 3, v9
  v_bfe_u32 v10, v1, 4, 1
  v_and_b32 v11, 3, v1
  v_lshl_add_u32 v10, v10, 2, v11
  v_lshlrev_b32 v10, 3, v10
  v_lshl_add_u32 v24, v8, 6, v10
  v_add_u32 v24, 32768, v24
  v_add_u32 v25, 73728, v24
  v_lshl_add_u32 v8, v8, 8, v10
  s_lshl_b32 s50, s52, 1
  v_xor_b32 v9, s50, v9
  v_lshl_add_u32 v8, v9, 6, v8
  v_add_u32 v20, 16384, v8
  v_xor_b32 v21, 64, v20
  v_add_u32 v22, 73728, v20
  v_add_u32 v23, 73728, v21
  s_waitcnt vmcnt(5)
  s_barrier
  ds_read_b128 v[28:31], v12 offset:0
  ds_read_b64_tr_b16 v[44:45], v20 offset:0
  ds_read_b64_tr_b16 v[46:47], v20 offset:1024
  ds_read_b64_tr_b16 v[48:49], v21 offset:0
  ds_read_b64_tr_b16 v[50:51], v21 offset:1024
  ds_read_b64_tr_b16 v[76:77], v24 offset:0
  ds_read_b64_tr_b16 v[78:79], v24 offset:256
  ds_read_b128 v[32:35], v13 offset:0
  ds_read_b64_tr_b16 v[52:53], v20 offset:4096
  ds_read_b64_tr_b16 v[54:55], v20 offset:5120
  ds_read_b64_tr_b16 v[56:57], v21 offset:4096
  ds_read_b64_tr_b16 v[58:59], v21 offset:5120
  ds_read_b64_tr_b16 v[80:81], v24 offset:1024
  ds_read_b64_tr_b16 v[82:83], v24 offset:1280
  ds_read_b128 v[36:39], v14 offset:0
  ds_read_b64_tr_b16 v[60:61], v20 offset:8192
  ds_read_b64_tr_b16 v[62:63], v20 offset:9216
  ds_read_b64_tr_b16 v[64:65], v21 offset:8192
  ds_read_b64_tr_b16 v[66:67], v21 offset:9216
  ds_read_b64_tr_b16 v[84:85], v24 offset:2048
  ds_read_b64_tr_b16 v[86:87], v24 offset:2304
  ds_read_b128 v[40:43], v15 offset:0
  ds_read_b64_tr_b16 v[68:69], v20 offset:12288
  ds_read_b64_tr_b16 v[70:71], v20 offset:13312
  ds_read_b64_tr_b16 v[72:73], v21 offset:12288
  ds_read_b64_tr_b16 v[74:75], v21 offset:13312
  ds_read_b64_tr_b16 v[88:89], v24 offset:3072
  ds_read_b64_tr_b16 v[90:91], v24 offset:3328
  s_lshl_b32 s42, s58, 7
  s_add_u32 s42, s42, s54
  s_add_u32 m0, s56, 73728
  s_mul_i32 s43, s58, s45
  buffer_load_dwordx4 v2, s[20:23], s42 offen lds
  s_add_u32 m0, s56, 74752
  s_add_u32 s43, s43, s55
  buffer_load_dwordx4 v3, s[20:23], s42 offen lds
  s_add_u32 m0, s56, 90112
  s_add_u32 s42, s43, s44
  buffer_load_dwordx4 v4, s[24:27], s43 offen lds
  s_add_u32 m0, s56, 91136
  s_lshl_b32 s43, s58, 11
  buffer_load_dwordx4 v4, s[24:27], s42 offen lds
  s_add_u32 m0, s60, 106496
  s_add_u32 s43, s43, s59
  s_mov_b64 exec, s[36:37]
  buffer_load_dwordx4 v6, s[32:35], s43 offen lds
  s_mov_b64 exec, -1
  s_add_u32 s58, s58, 1
  s_and_b32 s58, s58, 7
  s_lshl_b32 s42, s58, 7
  s_add_u32 s42, s42, s54
  s_add_u32 m0, s56, 110592
  s_mul_i32 s43, s58, s45
  buffer_load_dwordx4 v2, s[20:23], s42 offen lds
  s_add_u32 m0, s56, 111616
  s_add_u32 s43, s43, s55
  buffer_load_dwordx4 v3, s[20:23], s42 offen lds
  s_add_u32 m0, s56, 126976
  s_add_u32 s42, s43, s44
  buffer_load_dwordx4 v4, s[24:27], s43 offen lds
  s_add_u32 m0, s56, 128000
  s_lshl_b32 s43, s58, 11
  buffer_load_dwordx4 v4, s[24:27], s42 offen lds
  s_add_u32 m0, s60, 143360
  s_add_u32 s43, s43, s59
  s_mov_b64 exec, s[36:37]
  buffer_load_dwordx4 v6, s[32:35], s43 offen lds
  s_mov_b64 exec, -1
  s_add_u32 s58, s58, 1
  s_and_b32 s58, s58, 7
  s_waitcnt vmcnt(10) lgkmcnt(0)
  s_barrier
  ds_read_b128 v[92:95], v12 offset:36864
  ds_read_b64_tr_b16 v[108:109], v20 offset:36864
  ds_read_b64_tr_b16 v[110:111], v20 offset:37888
  ds_read_b64_tr_b16 v[112:113], v21 offset:36864
  ds_read_b64_tr_b16 v[114:115], v21 offset:37888
  ds_read_b64_tr_b16 v[140:141], v24 offset:36864
  ds_read_b64_tr_b16 v[142:143], v24 offset:37120
  v_mfma_f32_32x32x16_bf16 v[156:171], v[28:31], v[44:47], 0
  v_mfma_f32_32x32x16_bf16 v[172:187], v[28:31], v[48:51], 0
  v_mfma_f32_32x32x16_bf16 v[188:203], v[76:79], v[28:31], 0
  s_lshl_b32 s42, s58, 7
  s_add_u32 s42, s42, s54
  s_add_u32 m0, s56, 0
  s_mul_i32 s43, s58, s45
  buffer_load_dwordx4 v2, s[20:23], s42 offen lds
  ds_read_b128 v[96:99], v13 offset:36864
  ds_read_b64_tr_b16 v[116:117], v20 offset:40960
  ds_read_b64_tr_b16 v[118:119], v20 offset:41984
  ds_read_b64_tr_b16 v[120:121], v21 offset:40960
  ds_read_b64_tr_b16 v[122:123], v21 offset:41984
  ds_read_b64_tr_b16 v[144:145], v24 offset:37888
  ds_read_b64_tr_b16 v[146:147], v24 offset:38144
  v_mfma_f32_32x32x16_bf16 v[156:171], v[32:35], v[52:55], v[156:171]
  v_mfma_f32_32x32x16_bf16 v[172:187], v[32:35], v[56:59], v[172:187]
  v_mfma_f32_32x32x16_bf16 v[188:203], v[80:83], v[32:35], v[188:203]
  s_add_u32 m0, s56, 1024
  s_add_u32 s43, s43, s55
  buffer_load_dwordx4 v3, s[20:23], s42 offen lds
  ds_read_b128 v[100:103], v14 offset:36864
  ds_read_b64_tr_b16 v[124:125], v20 offset:45056
  ds_read_b64_tr_b16 v[126:127], v20 offset:46080
  ds_read_b64_tr_b16 v[128:129], v21 offset:45056
  ds_read_b64_tr_b16 v[130:131], v21 offset:46080
  ds_read_b64_tr_b16 v[148:149], v24 offset:38912
  ds_read_b64_tr_b16 v[150:151], v24 offset:39168
  v_mfma_f32_32x32x16_bf16 v[156:171], v[36:39], v[60:63], v[156:171]
  v_mfma_f32_32x32x16_bf16 v[172:187], v[36:39], v[64:67], v[172:187]
  v_mfma_f32_32x32x16_bf16 v[188:203], v[84:87], v[36:39], v[188:203]
  s_add_u32 m0, s56, 16384
  s_add_u32 s42, s43, s44
  buffer_load_dwordx4 v4, s[24:27], s43 offen lds
  ds_read_b128 v[104:107], v15 offset:36864
  ds_read_b64_tr_b16 v[132:133], v20 offset:49152
  ds_read_b64_tr_b16 v[134:135], v20 offset:50176
  ds_read_b64_tr_b16 v[136:137], v21 offset:49152
  ds_read_b64_tr_b16 v[138:139], v21 offset:50176
  ds_read_b64_tr_b16 v[152:153], v24 offset:39936
  ds_read_b64_tr_b16 v[154:155], v24 offset:40192
  v_mfma_f32_32x32x16_bf16 v[156:171], v[40:43], v[68:71], v[156:171]
  v_mfma_f32_32x32x16_bf16 v[172:187], v[40:43], v[72:75], v[172:187]
  v_mfma_f32_32x32x16_bf16 v[188:203], v[88:91], v[40:43], v[188:203]
  s_add_u32 m0, s56, 17408
  s_lshl_b32 s43, s58, 11
  buffer_load_dwordx4 v4, s[24:27], s42 offen lds
  s_add_u32 m0, s60, 32768
  s_add_u32 s43, s43, s59
  s_mov_b64 exec, s[36:37]
  buffer_load_dwordx4 v6, s[32:35], s43 offen lds
  s_mov_b64 exec, -1
  s_add_u32 s58, s58, 1
  s_and_b32 s58, s58, 7
  s_waitcnt vmcnt(10) lgkmcnt(0)
  s_barrier
  ds_read_b128 v[28:31], v16 offset:0
  ds_read_b64_tr_b16 v[44:45], v22 offset:0
  ds_read_b64_tr_b16 v[46:47], v22 offset:1024
  ds_read_b64_tr_b16 v[48:49], v23 offset:0
  ds_read_b64_tr_b16 v[50:51], v23 offset:1024
  ds_read_b64_tr_b16 v[76:77], v25 offset:0
  ds_read_b64_tr_b16 v[78:79], v25 offset:256
  v_mfma_f32_32x32x16_bf16 v[156:171], v[92:95], v[108:111], v[156:171]
  v_mfma_f32_32x32x16_bf16 v[172:187], v[92:95], v[112:115], v[172:187]
  v_mfma_f32_32x32x16_bf16 v[188:203], v[140:143], v[92:95], v[188:203]
  s_lshl_b32 s42, s58, 7
  s_add_u32 s42, s42, s54
  s_add_u32 m0, s56, 36864
  s_mul_i32 s43, s58, s45
  buffer_load_dwordx4 v2, s[20:23], s42 offen lds
  ds_read_b128 v[32:35], v17 offset:0
  ds_read_b64_tr_b16 v[52:53], v22 offset:4096
  ds_read_b64_tr_b16 v[54:55], v22 offset:5120
  ds_read_b64_tr_b16 v[56:57], v23 offset:4096
  ds_read_b64_tr_b16 v[58:59], v23 offset:5120
  ds_read_b64_tr_b16 v[80:81], v25 offset:1024
  ds_read_b64_tr_b16 v[82:83], v25 offset:1280
  v_mfma_f32_32x32x16_bf16 v[156:171], v[96:99], v[116:119], v[156:171]
  v_mfma_f32_32x32x16_bf16 v[172:187], v[96:99], v[120:123], v[172:187]
  v_mfma_f32_32x32x16_bf16 v[188:203], v[144:147], v[96:99], v[188:203]
  s_add_u32 m0, s56, 37888
  s_add_u32 s43, s43, s55
  buffer_load_dwordx4 v3, s[20:23], s42 offen lds
  ds_read_b128 v[36:39], v18 offset:0
  ds_read_b64_tr_b16 v[60:61], v22 offset:8192
  ds_read_b64_tr_b16 v[62:63], v22 offset:9216
  ds_read_b64_tr_b16 v[64:65], v23 offset:8192
  ds_read_b64_tr_b16 v[66:67], v23 offset:9216
  ds_read_b64_tr_b16 v[84:85], v25 offset:2048
  ds_read_b64_tr_b16 v[86:87], v25 offset:2304
  v_mfma_f32_32x32x16_bf16 v[156:171], v[100:103], v[124:127], v[156:171]
  v_mfma_f32_32x32x16_bf16 v[172:187], v[100:103], v[128:131], v[172:187]
  v_mfma_f32_32x32x16_bf16 v[188:203], v[148:151], v[100:103], v[188:203]
  s_add_u32 m0, s56, 53248
  s_add_u32 s42, s43, s44
  buffer_load_dwordx4 v4, s[24:27], s43 offen lds
  ds_read_b128 v[40:43], v19 offset:0
  ds_read_b64_tr_b16 v[68:69], v22 offset:12288
  ds_read_b64_tr_b16 v[70:71], v22 offset:13312
  ds_read_b64_tr_b16 v[72:73], v23 offset:12288
  ds_read_b64_tr_b16 v[74:75], v23 offset:13312
  ds_read_b64_tr_b16 v[88:89], v25 offset:3072
  ds_read_b64_tr_b16 v[90:91], v25 offset:3328
  v_mfma_f32_32x32x16_bf16 v[156:171], v[104:107], v[132:135], v[156:171]
  v_mfma_f32_32x32x16_bf16 v[172:187], v[104:107], v[136:139], v[172:187]
  v_mfma_f32_32x32x16_bf16 v[188:203], v[152:155], v[104:107], v[188:203]
  s_add_u32 m0, s56, 54272
  s_lshl_b32 s43, s58, 11
  buffer_load_dwordx4 v4, s[24:27], s42 offen lds
  s_add_u32 m0, s60, 69632
  s_add_u32 s43, s43, s59
  s_mov_b64 exec, s[36:37]
  buffer_load_dwordx4 v6, s[32:35], s43 offen lds
  s_mov_b64 exec, -1
  s_add_u32 s58, s58, 1
  s_and_b32 s58, s58, 7
  s_waitcnt vmcnt(10) lgkmcnt(0)
  s_barrier
  ds_read_b128 v[92:95], v16 offset:36864
  ds_read_b64_tr_b16 v[108:109], v22 offset:36864
  ds_read_b64_tr_b16 v[110:111], v22 offset:37888
  ds_read_b64_tr_b16 v[112:113], v23 offset:36864
  ds_read_b64_tr_b16 v[114:115], v23 offset:37888
  ds_read_b64_tr_b16 v[140:141], v25 offset:36864
  ds_read_b64_tr_b16 v[142:143], v25 offset:37120
  v_mfma_f32_32x32x16_bf16 v[156:171], v[28:31], v[44:47], v[156:171]
  v_mfma_f32_32x32x16_bf16 v[172:187], v[28:31], v[48:51], v[172:187]
  v_mfma_f32_32x32x16_bf16 v[188:203], v[76:79], v[28:31], v[188:203]
  s_lshl_b32 s42, s58, 7
  s_add_u32 s42, s42, s54
  s_add_u32 m0, s56, 73728
  s_mul_i32 s43, s58, s45
  buffer_load_dwordx4 v2, s[20:23], s42 offen lds
  ds_read_b128 v[96:99], v17 offset:36864
  ds_read_b64_tr_b16 v[116:117], v22 offset:40960
  ds_read_b64_tr_b16 v[118:119], v22 offset:41984
  ds_read_b64_tr_b16 v[120:121], v23 offset:40960
  ds_read_b64_tr_b16 v[122:123], v23 offset:41984
  ds_read_b64_tr_b16 v[144:145], v25 offset:37888
  ds_read_b64_tr_b16 v[146:147], v25 offset:38144
  v_mfma_f32_32x32x16_bf16 v[156:171], v[32:35], v[52:55], v[156:171]
  v_mfma_f32_32x32x16_bf16 v[172:187], v[32:35], v[56:59], v[172:187]
  v_mfma_f32_32x32x16_bf16 v[188:203], v[80:83], v[32:35], v[188:203]
  s_add_u32 m0, s56, 74752
  s_add_u32 s43, s43, s55
  buffer_load_dwordx4 v3, s[20:23], s42 offen lds
  ds_read_b128 v[100:103], v18 offset:36864
  ds_read_b64_tr_b16 v[124:125], v22 offset:45056
  ds_read_b64_tr_b16 v[126:127], v22 offset:46080
  ds_read_b64_tr_b16 v[128:129], v23 offset:45056
  ds_read_b64_tr_b16 v[130:131], v23 offset:46080
  ds_read_b64_tr_b16 v[148:149], v25 offset:38912
  ds_read_b64_tr_b16 v[150:151], v25 offset:39168
  v_mfma_f32_32x32x16_bf16 v[156:171], v[36:39], v[60:63], v[156:171]
  v_mfma_f32_32x32x16_bf16 v[172:187], v[36:39], v[64:67], v[172:187]
  v_mfma_f32_32x32x16_bf16 v[188:203], v[84:87], v[36:39], v[188:203]
  s_add_u32 m0, s56, 90112
  s_add_u32 s42, s43, s44
  buffer_load_dwordx4 v4, s[24:27], s43 offen lds
  ds_read_b128 v[104:107], v19 offset:36864
  ds_read_b64_tr_b16 v[132:133], v22 offset:49152
  ds_read_b64_tr_b16 v[134:135], v22 offset:50176
  ds_read_b64_tr_b16 v[136:137], v23 offset:49152
  ds_read_b64_tr_b16 v[138:139], v23 offset:50176
  ds_read_b64_tr_b16 v[152:153], v25 offset:39936
  ds_read_b64_tr_b16 v[154:155], v25 offset:40192
  v_mfma_f32_32x32x16_bf16 v[156:171], v[40:43], v[68:71], v[156:171]
  v_mfma_f32_32x32x16_bf16 v[172:187], v[40:43], v[72:75], v[172:187]
  v_mfma_f32_32x32x16_bf16 v[188:203], v[88:91], v[40:43], v[188:203]
  s_add_u32 m0, s56, 91136
  s_lshl_b32 s43, s58, 11
  buffer_load_dwordx4 v4, s[24:27], s42 offen lds
  s_add_u32 m0, s60, 106496
  s_add_u32 s43, s43, s59
  s_mov_b64 exec, s[36:37]
  buffer_load_dwordx4 v6, s[32:35], s43 offen lds
  s_mov_b64 exec, -1
  s_add_u32 s58, s58, 1
  s_and_b32 s58, s58, 7
  s_waitcnt vmcnt(10) lgkmcnt(0)
  s_barrier
  ds_read_b128 v[28:31], v12 offset:0
  ds_read_b64_tr_b16 v[44:45], v20 offset:0
  ds_read_b64_tr_b16 v[46:47], v20 offset:1024
  ds_read_b64_tr_b16 v[48:49], v21 offset:0
  ds_read_b64_tr_b16 v[50:51], v21 offset:1024
  ds_read_b64_tr_b16 v[76:77], v24 offset:0
  ds_read_b64_tr_b16 v[78:79], v24 offset:256
  v_mfma_f32_32x32x16_bf16 v[156:171], v[92:95], v[108:111], v[156:171]
  v_mfma_f32_32x32x16_bf16 v[172:187], v[92:95], v[112:115], v[172:187]
  v_mfma_f32_32x32x16_bf16 v[188:203], v[140:143], v[92:95], v[188:203]
  s_lshl_b32 s42, s58, 7
  s_add_u32 s42, s42, s54
  s_add_u32 m0, s56, 110592
  s_mul_i32 s43, s58, s45
  buffer_load_dwordx4 v2, s[20:23], s42 offen lds
  ds_read_b128 v[32:35], v13 offset:0
  ds_read_b64_tr_b16 v[52:53], v20 offset:4096
  ds_read_b64_tr_b16 v[54:55], v20 offset:5120
  ds_read_b64_tr_b16 v[56:57], v21 offset:4096
  ds_read_b64_tr_b16 v[58:59], v21 offset:5120
  ds_read_b64_tr_b16 v[80:81], v24 offset:1024
  ds_read_b64_tr_b16 v[82:83], v24 offset:1280
  v_mfma_f32_32x32x16_bf16 v[156:171], v[96:99], v[116:119], v[156:171]
  v_mfma_f32_32x32x16_bf16 v[172:187], v[96:99], v[120:123], v[172:187]
  v_mfma_f32_32x32x16_bf16 v[188:203], v[144:147], v[96:99], v[188:203]
  s_add_u32 m0, s56, 111616
  s_add_u32 s43, s43, s55
  buffer_load_dwordx4 v3, s[20:23], s42 offen lds
  ds_read_b128 v[36:39], v14 offset:0
  ds_read_b64_tr_b16 v[60:61], v20 offset:8192
  ds_read_b64_tr_b16 v[62:63], v20 offset:9216
  ds_read_b64_tr_b16 v[64:65], v21 offset:8192
  ds_read_b64_tr_b16 v[66:67], v21 offset:9216
  ds_read_b64_tr_b16 v[84:85], v24 offset:2048
  ds_read_b64_tr_b16 v[86:87], v24 offset:2304
  v_mfma_f32_32x32x16_bf16 v[156:171], v[100:103], v[124:127], v[156:171]
  v_mfma_f32_32x32x16_bf16 v[172:187], v[100:103], v[128:131], v[172:187]
  v_mfma_f32_32x32x16_bf16 v[188:203], v[148:151], v[100:103], v[188:203]
  s_add_u32 m0, s56, 126976
  s_add_u32 s42, s43, s44
  buffer_load_dwordx4 v4, s[24:27], s43 offen lds
  ds_read_b128 v[40:43], v15 offset:0
  ds_read_b64_tr_b16 v[68:69], v20 offset:12288
  ds_read_b64_tr_b16 v[70:71], v20 offset:13312
  ds_read_b64_tr_b16 v[72:73], v21 offset:12288
  ds_read_b64_tr_b16 v[74:75], v21 offset:13312
  ds_read_b64_tr_b16 v[88:89], v24 offset:3072
  ds_read_b64_tr_b16 v[90:91], v24 offset:3328
  v_mfma_f32_32x32x16_bf16 v[156:171], v[104:107], v[132:135], v[156:171]
  v_mfma_f32_32x32x16_bf16 v[172:187], v[104:107], v[136:139], v[172:187]
  v_mfma_f32_32x32x16_bf16 v[188:203], v[152:155], v[104:107], v[188:203]
  s_add_u32 m0, s56, 128000
  s_lshl_b32 s43, s58, 11
  buffer_load_dwordx4 v4, s[24:27], s42 offen lds
  s_add_u32 m0, s60, 143360
  s_add_u32 s43, s43, s59
  s_mov_b64 exec, s[36:37]
  buffer_load_dwordx4 v6, s[32:35], s43 offen lds
  s_mov_b64 exec, -1
  s_add_u32 s58, s58, 1
  s_and_b32 s58, s58, 7
  s_waitcnt vmcnt(10) lgkmcnt(0)
  s_barrier
  ds_read_b128 v[92:95], v12 offset:36864
  ds_read_b64_tr_b16 v[108:109], v20 offset:36864
  ds_read_b64_tr_b16 v[110:111], v20 offset:37888
  ds_read_b64_tr_b16 v[112:113], v21 offset:36864
  ds_read_b64_tr_b16 v[114:115], v21 offset:37888
  ds_read_b64_tr_b16 v[140:141], v24 offset:36864
  ds_read_b64_tr_b16 v[142:143], v24 offset:37120
  v_mfma_f32_32x32x16_bf16 v[156:171], v[28:31], v[44:47], v[156:171]
  v_mfma_f32_32x32x16_bf16 v[172:187], v[28:31], v[48:51], v[172:187]
  v_mfma_f32_32x32x16_bf16 v[188:203], v[76:79], v[28:31], v[188:203]
  ds_read_b128 v[96:99], v13 offset:36864
  ds_read_b64_tr_b16 v[116:117], v20 offset:40960
  ds_read_b64_tr_b16 v[118:119], v20 offset:41984
  ds_read_b64_tr_b16 v[120:121], v21 offset:40960
  ds_read_b64_tr_b16 v[122:123], v21 offset:41984
  ds_read_b64_tr_b16 v[144:145], v24 offset:37888
  ds_read_b64_tr_b16 v[146:147], v24 offset:38144
  v_mfma_f32_32x32x16_bf16 v[156:171], v[32:35], v[52:55], v[156:171]
  v_mfma_f32_32x32x16_bf16 v[172:187], v[32:35], v[56:59], v[172:187]
  v_mfma_f32_32x32x16_bf16 v[188:203], v[80:83], v[32:35], v[188:203]
  ds_read_b128 v[100:103], v14 offset:36864
  ds_read_b64_tr_b16 v[124:125], v20 offset:45056
  ds_read_b64_tr_b16 v[126:127], v20 offset:46080
  ds_read_b64_tr_b16 v[128:129], v21 offset:45056
  ds_read_b64_tr_b16 v[130:131], v21 offset:46080
  ds_read_b64_tr_b16 v[148:149], v24 offset:38912
  ds_read_b64_tr_b16 v[150:151], v24 offset:39168
  v_mfma_f32_32x32x16_bf16 v[156:171], v[36:39], v[60:63], v[156:171]
  v_mfma_f32_32x32x16_bf16 v[172:187], v[36:39], v[64:67], v[172:187]
  v_mfma_f32_32x32x16_bf16 v[188:203], v[84:87], v[36:39], v[188:203]
  ds_read_b128 v[104:107], v15 offset:36864
  ds_read_b64_tr_b16 v[132:133], v20 offset:49152
  ds_read_b64_tr_b16 v[134:135], v20 offset:50176
  ds_read_b64_tr_b16 v[136:137], v21 offset:49152
  ds_read_b64_tr_b16 v[138:139], v21 offset:50176
  ds_read_b64_tr_b16 v[152:153], v24 offset:39936
  ds_read_b64_tr_b16 v[154:155], v24 offset:40192
  v_mfma_f32_32x32x16_bf16 v[156:171], v[40:43], v[68:71], v[156:171]
  v_mfma_f32_32x32x16_bf16 v[172:187], v[40:43], v[72:75], v[172:187]
  v_mfma_f32_32x32x16_bf16 v[188:203], v[88:91], v[40:43], v[188:203]
  s_waitcnt vmcnt(5) lgkmcnt(0)
  s_barrier
  ds_read_b128 v[28:31], v16 offset:0
  ds_read_b64_tr_b16 v[44:45], v22 offset:0
  ds_read_b64_tr_b16 v[46:47], v22 offset:1024
  ds_read_b64_tr_b16 v[48:49], v23 offset:0
  ds_read_b64_tr_b16 v[50:51], v23 offset:1024
  ds_read_b64_tr_b16 v[76:77], v25 offset:0
  ds_read_b64_tr_b16 v[78:79], v25 offset:256
  v_mfma_f32_32x32x16_bf16 v[156:171], v[92:95], v[108:111], v[156:171]
  v_mfma_f32_32x32x16_bf16 v[172:187], v[92:95], v[112:115], v[172:187]
  v_mfma_f32_32x32x16_bf16 v[188:203], v[140:143], v[92:95], v[188:203]
  ds_read_b128 v[32:35], v17 offset:0
  ds_read_b64_tr_b16 v[52:53], v22 offset:4096
  ds_read_b64_tr_b16 v[54:55], v22 offset:5120
  ds_read_b64_tr_b16 v[56:57], v23 offset:4096
  ds_read_b64_tr_b16 v[58:59], v23 offset:5120
  ds_read_b64_tr_b16 v[80:81], v25 offset:1024
  ds_read_b64_tr_b16 v[82:83], v25 offset:1280
  v_mfma_f32_32x32x16_bf16 v[156:171], v[96:99], v[116:119], v[156:171]
  v_mfma_f32_32x32x16_bf16 v[172:187], v[96:99], v[120:123], v[172:187]
  v_mfma_f32_32x32x16_bf16 v[188:203], v[144:147], v[96:99], v[188:203]
  ds_read_b128 v[36:39], v18 offset:0
  ds_read_b64_tr_b16 v[60:61], v22 offset:8192
  ds_read_b64_tr_b16 v[62:63], v22 offset:9216
  ds_read_b64_tr_b16 v[64:65], v23 offset:8192
  ds_read_b64_tr_b16 v[66:67], v23 offset:9216
  ds_read_b64_tr_b16 v[84:85], v25 offset:2048
  ds_read_b64_tr_b16 v[86:87], v25 offset:2304
  v_mfma_f32_32x32x16_bf16 v[156:171], v[100:103], v[124:127], v[156:171]
  v_mfma_f32_32x32x16_bf16 v[172:187], v[100:103], v[128:131], v[172:187]
  v_mfma_f32_32x32x16_bf16 v[188:203], v[148:151], v[100:103], v[188:203]
  ds_read_b128 v[40:43], v19 offset:0
  ds_read_b64_tr_b16 v[68:69], v22 offset:12288
  ds_read_b64_tr_b16 v[70:71], v22 offset:13312
  ds_read_b64_tr_b16 v[72:73], v23 offset:12288
  ds_read_b64_tr_b16 v[74:75], v23 offset:13312
  ds_read_b64_tr_b16 v[88:89], v25 offset:3072
  ds_read_b64_tr_b16 v[90:91], v25 offset:3328
  v_mfma_f32_32x32x16_bf16 v[156:171], v[104:107], v[132:135], v[156:171]
  v_mfma_f32_32x32x16_bf16 v[172:187], v[104:107], v[136:139], v[172:187]
  v_mfma_f32_32x32x16_bf16 v[188:203], v[152:155], v[104:107], v[188:203]
  s_waitcnt vmcnt(0) lgkmcnt(0)
  s_barrier
  ds_read_b128 v[92:95], v16 offset:36864
  ds_read_b64_tr_b16 v[108:109], v22 offset:36864
  ds_read_b64_tr_b16 v[110:111], v22 offset:37888
  ds_read_b64_tr_b16 v[112:113], v23 offset:36864
  ds_read_b64_tr_b16 v[114:115], v23 offset:37888
  ds_read_b64_tr_b16 v[140:141], v25 offset:36864
  ds_read_b64_tr_b16 v[142:143], v25 offset:37120
  v_mfma_f32_32x32x16_bf16 v[156:171], v[28:31], v[44:47], v[156:171]
  v_mfma_f32_32x32x16_bf16 v[172:187], v[28:31], v[48:51], v[172:187]
  v_mfma_f32_32x32x16_bf16 v[188:203], v[76:79], v[28:31], v[188:203]
  ds_read_b128 v[96:99], v17 offset:36864
  ds_read_b64_tr_b16 v[116:117], v22 offset:40960
  ds_read_b64_tr_b16 v[118:119], v22 offset:41984
  ds_read_b64_tr_b16 v[120:121], v23 offset:40960
  ds_read_b64_tr_b16 v[122:123], v23 offset:41984
  ds_read_b64_tr_b16 v[144:145], v25 offset:37888
  ds_read_b64_tr_b16 v[146:147], v25 offset:38144
  v_mfma_f32_32x32x16_bf16 v[156:171], v[32:35], v[52:55], v[156:171]
  v_mfma_f32_32x32x16_bf16 v[172:187], v[32:35], v[56:59], v[172:187]
  v_mfma_f32_32x32x16_bf16 v[188:203], v[80:83], v[32:35], v[188:203]
  ds_read_b128 v[100:103], v18 offset:36864
  ds_read_b64_tr_b16 v[124:125], v22 offset:45056
  ds_read_b64_tr_b16 v[126:127], v22 offset:46080
  ds_read_b64_tr_b16 v[128:129], v23 offset:45056
  ds_read_b64_tr_b16 v[130:131], v23 offset:46080
  ds_read_b64_tr_b16 v[148:149], v25 offset:38912
  ds_read_b64_tr_b16 v[150:151], v25 offset:39168
  v_mfma_f32_32x32x16_bf16 v[156:171], v[36:39], v[60:63], v[156:171]
  v_mfma_f32_32x32x16_bf16 v[172:187], v[36:39], v[64:67], v[172:187]
  v_mfma_f32_32x32x16_bf16 v[188:203], v[84:87], v[36:39], v[188:203]
  ds_read_b128 v[104:107], v19 offset:36864
  ds_read_b64_tr_b16 v[132:133], v22 offset:49152
  ds_read_b64_tr_b16 v[134:135], v22 offset:50176
  ds_read_b64_tr_b16 v[136:137], v23 offset:49152
  ds_read_b64_tr_b16 v[138:139], v23 offset:50176
  ds_read_b64_tr_b16 v[152:153], v25 offset:39936
  ds_read_b64_tr_b16 v[154:155], v25 offset:40192
  v_mfma_f32_32x32x16_bf16 v[156:171], v[40:43], v[68:71], v[156:171]
  v_mfma_f32_32x32x16_bf16 v[172:187], v[40:43], v[72:75], v[172:187]
  v_mfma_f32_32x32x16_bf16 v[188:203], v[88:91], v[40:43], v[188:203]
  s_waitcnt lgkmcnt(0)
  v_mfma_f32_32x32x16_bf16 v[156:171], v[92:95], v[108:111], v[156:171]
  v_mfma_f32_32x32x16_bf16 v[172:187], v[92:95], v[112:115], v[172:187]
  v_mfma_f32_32x32x16_bf16 v[188:203], v[140:143], v[92:95], v[188:203]
  v_mfma_f32_32x32x16_bf16 v[156:171], v[96:99], v[116:119], v[156:171]
  v_mfma_f32_32x32x16_bf16 v[172:187], v[96:99], v[120:123], v[172:187]
  v_mfma_f32_32x32x16_bf16 v[188:203], v[144:147], v[96:99], v[188:203]
  v_mfma_f32_32x32x16_bf16 v[156:171], v[100:103], v[124:127], v[156:171]
  v_mfma_f32_32x32x16_bf16 v[172:187], v[100:103], v[128:131], v[172:187]
  v_mfma_f32_32x32x16_bf16 v[188:203], v[148:151], v[100:103], v[188:203]
  v_mfma_f32_32x32x16_bf16 v[156:171], v[104:107], v[132:135], v[156:171]
  v_mfma_f32_32x32x16_bf16 v[172:187], v[104:107], v[136:139], v[172:187]
  v_mfma_f32_32x32x16_bf16 v[188:203], v[152:155], v[104:107], v[188:203]
  s_nop 15
  s_lshl_b32 s50, s57, 11
  s_add_u32 s50, s50, 8388608
  v_lshlrev_b32 v10, 4, v1
  v_cvt_pk_bf16_f32 v44, v188, v189
  v_cvt_pk_bf16_f32 v45, v190, v191
  v_cvt_pk_bf16_f32 v46, v192, v193
  v_cvt_pk_bf16_f32 v47, v194, v195
  buffer_store_dwordx4 v[44:47], v10, s[28:31], s50 offen sc0 sc1
  s_branch proj_N_epi
proj_N_none:
  s_lshl_b32 s42, s58, 7
  s_add_u32 s42, s42, s54
  s_add_u32 m0, s56, 0
  s_mul_i32 s43, s58, s45
  buffer_load_dwordx4 v2, s[20:23], s42 offen lds
  s_add_u32 m0, s56, 1024
  s_add_u32 s43, s43, s55
  buffer_load_dwordx4 v3, s[20:23], s42 offen lds
  s_add_u32 m0, s56, 16384
  s_add_u32 s42, s43, s44
  buffer_load_dwordx4 v4, s[24:27], s43 offen lds
  s_add_u32 m0, s56, 17408
  s_lshl_b32 s43, s58, 11
  buffer_load_dwordx4 v4, s[24:27], s42 offen lds
  s_add_u32 m0, s60, 32768
  s_add_u32 s43, s43, s59
  s_mov_b64 exec, s[36:37]
  buffer_load_dwordx4 v6, s[32:35], s43 offen lds
  s_mov_b64 exec, -1
  s_add_u32 s58, s58, 1
  s_and_b32 s58, s58, 7
  s_lshl_b32 s42, s58, 7
  s_add_u32 s42, s42, s54
  s_add_u32 m0, s56, 36864
  s_mul_i32 s43, s58, s45
  buffer_load_dwordx4 v2, s[20:23], s42 offen lds
  s_add_u32 m0, s56, 37888
  s_add_u32 s43, s43, s55
  buffer_load_dwordx4 v3, s[20:23], s42 offen lds
  s_add_u32 m0, s56, 53248
  s_add_u32 s42, s43, s44
  buffer_load_dwordx4 v4, s[24:27], s43 offen lds
  s_add_u32 m0, s56, 54272
  s_lshl_b32 s43, s58, 11
  buffer_load_dwordx4 v4, s[24:27], s42 offen lds
  s_add_u32 m0, s60, 69632
  s_add_u32 s43, s43, s59
  s_mov_b64 exec, s[36:37]
  buffer_load_dwordx4 v6, s[32:35], s43 offen lds
  s_mov_b64 exec, -1
  s_add_u32 s58, s58, 1
  s_and_b32 s58, s58, 7
  v_and_b32 v8, 31, v1
  v_lshrrev_b32 v9, 5, v1
  v_bfe_u32 v10, v1, 1, 3
  v_xor_b32 v9, v9, v10
  v_lshlrev_b32 v9, 4, v9
  v_lshl_add_u32 v8, v8, 7, v9
  s_lshl_b32 s50, s51, 12
  v_add_u32 v8, s50, v8
  v_xor_b32 v12, 0, v8
  v_add_u32 v16, 73728, v12
  v_xor_b32 v13, 32, v8
  v_add_u32 v17, 73728, v13
  v_xor_b32 v14, 64, v8
  v_add_u32 v18, 73728, v14
  v_xor_b32 v15, 96, v8
  v_add_u32 v19, 73728, v15
  v_lshrrev_b32 v8, 5, v1
  v_bfe_u32 v9, v1, 2, 2
  v_lshl_add_u32 v8, v8, 3, v9
  v_bfe_u32 v10, v1, 4, 1
  v_and_b32 v11, 3, v1
  v_lshl_add_u32 v10, v10, 2, v11
  v_lshlrev_b32 v10, 3, v10
  v_lshl_add_u32 v24, v8, 6, v10
  v_add_u32 v24, 32768, v24
  v_add_u32 v25, 73728, v24
  v_lshl_add_u32 v8, v8, 8, v10
  s_lshl_b32 s50, s52, 1
  v_xor_b32 v9, s50, v9
  v_lshl_add_u32 v8, v9, 6, v8
  v_add_u32 v20, 16384, v8
  v_xor_b32 v21, 64, v20
  v_add_u32 v22, 73728, v20
  v_add_u32 v23, 73728, v21
  s_waitcnt vmcnt(5)
  s_barrier
  ds_read_b128 v[28:31], v12 offset:0
  ds_read_b64_tr_b16 v[44:45], v20 offset:0
  ds_read_b64_tr_b16 v[46:47], v20 offset:1024
  ds_read_b64_tr_b16 v[48:49], v21 offset:0
  ds_read_b64_tr_b16 v[50:51], v21 offset:1024
  ds_read_b128 v[32:35], v13 offset:0
  ds_read_b64_tr_b16 v[52:53], v20 offset:4096
  ds_read_b64_tr_b16 v[54:55], v20 offset:5120
  ds_read_b64_tr_b16 v[56:57], v21 offset:4096
  ds_read_b64_tr_b16 v[58:59], v21 offset:5120
  ds_read_b128 v[36:39], v14 offset:0
  ds_read_b64_tr_b16 v[60:61], v20 offset:8192
  ds_read_b64_tr_b16 v[62:63], v20 offset:9216
  ds_read_b64_tr_b16 v[64:65], v21 offset:8192
  ds_read_b64_tr_b16 v[66:67], v21 offset:9216
  ds_read_b128 v[40:43], v15 offset:0
  ds_read_b64_tr_b16 v[68:69], v20 offset:12288
  ds_read_b64_tr_b16 v[70:71], v20 offset:13312
  ds_read_b64_tr_b16 v[72:73], v21 offset:12288
  ds_read_b64_tr_b16 v[74:75], v21 offset:13312
  s_lshl_b32 s42, s58, 7
  s_add_u32 s42, s42, s54
  s_add_u32 m0, s56, 73728
  s_mul_i32 s43, s58, s45
  buffer_load_dwordx4 v2, s[20:23], s42 offen lds
  s_add_u32 m0, s56, 74752
  s_add_u32 s43, s43, s55
  buffer_load_dwordx4 v3, s[20:23], s42 offen lds
  s_add_u32 m0, s56, 90112
  s_add_u32 s42, s43, s44
  buffer_load_dwordx4 v4, s[24:27], s43 offen lds
  s_add_u32 m0, s56, 91136
  s_lshl_b32 s43, s58, 11
  buffer_load_dwordx4 v4, s[24:27], s42 offen lds
  s_add_u32 m0, s60, 106496
  s_add_u32 s43, s43, s59
  s_mov_b64 exec, s[36:37]
  buffer_load_dwordx4 v6, s[32:35], s43 offen lds
  s_mov_b64 exec, -1
  s_add_u32 s58, s58, 1
  s_and_b32 s58, s58, 7
  s_lshl_b32 s42, s58, 7
  s_add_u32 s42, s42, s54
  s_add_u32 m0, s56, 110592
  s_mul_i32 s43, s58, s45
  buffer_load_dwordx4 v2, s[20:23], s42 offen lds
  s_add_u32 m0, s56, 111616
  s_add_u32 s43, s43, s55
  buffer_load_dwordx4 v3, s[20:23], s42 offen lds
  s_add_u32 m0, s56, 126976
  s_add_u32 s42, s43, s44
  buffer_load_dwordx4 v4, s[24:27], s43 offen lds
  s_add_u32 m0, s56, 128000
  s_lshl_b32 s43, s58, 11
  buffer_load_dwordx4 v4, s[24:27], s42 offen lds
  s_add_u32 m0, s60, 143360
  s_add_u32 s43, s43, s59
  s_mov_b64 exec, s[36:37]
  buffer_load_dwordx4 v6, s[32:35], s43 offen lds
  s_mov_b64 exec, -1
  s_add_u32 s58, s58, 1
  s_and_b32 s58, s58, 7
  s_waitcnt vmcnt(10) lgkmcnt(0)
  s_barrier
  ds_read_b128 v[92:95], v12 offset:36864
  ds_read_b64_tr_b16 v[108:109], v20 offset:36864
  ds_read_b64_tr_b16 v[110:111], v20 offset:37888
  ds_read_b64_tr_b16 v[112:113], v21 offset:36864
  ds_read_b64_tr_b16 v[114:115], v21 offset:37888
  v_mfma_f32_32x32x16_bf16 v[156:171], v[28:31], v[44:47], 0
  v_mfma_f32_32x32x16_bf16 v[172:187], v[28:31], v[48:51], 0
  s_lshl_b32 s42, s58, 7
  s_add_u32 s42, s42, s54
  s_add_u32 m0, s56, 0
  s_mul_i32 s43, s58, s45
  buffer_load_dwordx4 v2, s[20:23], s42 offen lds
  ds_read_b128 v[96:99], v13 offset:36864
  ds_read_b64_tr_b16 v[116:117], v20 offset:40960
  ds_read_b64_tr_b16 v[118:119], v20 offset:41984
  ds_read_b64_tr_b16 v[120:121], v21 offset:40960
  ds_read_b64_tr_b16 v[122:123], v21 offset:41984
  v_mfma_f32_32x32x16_bf16 v[156:171], v[32:35], v[52:55], v[156:171]
  v_mfma_f32_32x32x16_bf16 v[172:187], v[32:35], v[56:59], v[172:187]
  s_add_u32 m0, s56, 1024
  s_add_u32 s43, s43, s55
  buffer_load_dwordx4 v3, s[20:23], s42 offen lds
  ds_read_b128 v[100:103], v14 offset:36864
  ds_read_b64_tr_b16 v[124:125], v20 offset:45056
  ds_read_b64_tr_b16 v[126:127], v20 offset:46080
  ds_read_b64_tr_b16 v[128:129], v21 offset:45056
  ds_read_b64_tr_b16 v[130:131], v21 offset:46080
  v_mfma_f32_32x32x16_bf16 v[156:171], v[36:39], v[60:63], v[156:171]
  v_mfma_f32_32x32x16_bf16 v[172:187], v[36:39], v[64:67], v[172:187]
  s_add_u32 m0, s56, 16384
  s_add_u32 s42, s43, s44
  buffer_load_dwordx4 v4, s[24:27], s43 offen lds
  ds_read_b128 v[104:107], v15 offset:36864
  ds_read_b64_tr_b16 v[132:133], v20 offset:49152
  ds_read_b64_tr_b16 v[134:135], v20 offset:50176
  ds_read_b64_tr_b16 v[136:137], v21 offset:49152
  ds_read_b64_tr_b16 v[138:139], v21 offset:50176
  v_mfma_f32_32x32x16_bf16 v[156:171], v[40:43], v[68:71], v[156:171]
  v_mfma_f32_32x32x16_bf16 v[172:187], v[40:43], v[72:75], v[172:187]
  s_add_u32 m0, s56, 17408
  s_lshl_b32 s43, s58, 11
  buffer_load_dwordx4 v4, s[24:27], s42 offen lds
  s_add_u32 m0, s60, 32768
  s_add_u32 s43, s43, s59
  s_mov_b64 exec, s[36:37]
  buffer_load_dwordx4 v6, s[32:35], s43 offen lds
  s_mov_b64 exec, -1
  s_add_u32 s58, s58, 1
  s_and_b32 s58, s58, 7
  s_waitcnt vmcnt(10) lgkmcnt(0)
  s_barrier
  ds_read_b128 v[28:31], v16 offset:0
  ds_read_b64_tr_b16 v[44:45], v22 offset:0
  ds_read_b64_tr_b16 v[46:47], v22 offset:1024
  ds_read_b64_tr_b16 v[48:49], v23 offset:0
  ds_read_b64_tr_b16 v[50:51], v23 offset:1024
  v_mfma_f32_32x32x16_bf16 v[156:171], v[92:95], v[108:111], v[156:171]
  v_mfma_f32_32x32x16_bf16 v[172:187], v[92:95], v[112:115], v[172:187]
  s_lshl_b32 s42, s58, 7
  s_add_u32 s42, s42, s54
  s_add_u32 m0, s56, 36864
  s_mul_i32 s43, s58, s45
  buffer_load_dwordx4 v2, s[20:23], s42 offen lds
  ds_read_b128 v[32:35], v17 offset:0
  ds_read_b64_tr_b16 v[52:53], v22 offset:4096
  ds_read_b64_tr_b16 v[54:55], v22 offset:5120
  ds_read_b64_tr_b16 v[56:57], v23 offset:4096
  ds_read_b64_tr_b16 v[58:59], v23 offset:5120
  v_mfma_f32_32x32x16_bf16 v[156:171], v[96:99], v[116:119], v[156:171]
  v_mfma_f32_32x32x16_bf16 v[172:187], v[96:99], v[120:123], v[172:187]
  s_add_u32 m0, s56, 37888
  s_add_u32 s43, s43, s55
  buffer_load_dwordx4 v3, s[20:23], s42 offen lds
  ds_read_b128 v[36:39], v18 offset:0
  ds_read_b64_tr_b16 v[60:61], v22 offset:8192
  ds_read_b64_tr_b16 v[62:63], v22 offset:9216
  ds_read_b64_tr_b16 v[64:65], v23 offset:8192
  ds_read_b64_tr_b16 v[66:67], v23 offset:9216
  v_mfma_f32_32x32x16_bf16 v[156:171], v[100:103], v[124:127], v[156:171]
  v_mfma_f32_32x32x16_bf16 v[172:187], v[100:103], v[128:131], v[172:187]
  s_add_u32 m0, s56, 53248
  s_add_u32 s42, s43, s44
  buffer_load_dwordx4 v4, s[24:27], s43 offen lds
  ds_read_b128 v[40:43], v19 offset:0
  ds_read_b64_tr_b16 v[68:69], v22 offset:12288
  ds_read_b64_tr_b16 v[70:71], v22 offset:13312
  ds_read_b64_tr_b16 v[72:73], v23 offset:12288
  ds_read_b64_tr_b16 v[74:75], v23 offset:13312
  v_mfma_f32_32x32x16_bf16 v[156:171], v[104:107], v[132:135], v[156:171]
  v_mfma_f32_32x32x16_bf16 v[172:187], v[104:107], v[136:139], v[172:187]
  s_add_u32 m0, s56, 54272
  s_lshl_b32 s43, s58, 11
  buffer_load_dwordx4 v4, s[24:27], s42 offen lds
  s_add_u32 m0, s60, 69632
  s_add_u32 s43, s43, s59
  s_mov_b64 exec, s[36:37]
  buffer_load_dwordx4 v6, s[32:35], s43 offen lds
  s_mov_b64 exec, -1
  s_add_u32 s58, s58, 1
  s_and_b32 s58, s58, 7
  s_waitcnt vmcnt(10) lgkmcnt(0)
  s_barrier
  ds_read_b128 v[92:95], v16 offset:36864
  ds_read_b64_tr_b16 v[108:109], v22 offset:36864
  ds_read_b64_tr_b16 v[110:111], v22 offset:37888
  ds_read_b64_tr_b16 v[112:113], v23 offset:36864
  ds_read_b64_tr_b16 v[114:115], v23 offset:37888
  v_mfma_f32_32x32x16_bf16 v[156:171], v[28:31], v[44:47], v[156:171]
  v_mfma_f32_32x32x16_bf16 v[172:187], v[28:31], v[48:51], v[172:187]
  s_lshl_b32 s42, s58, 7
  s_add_u32 s42, s42, s54
  s_add_u32 m0, s56, 73728
  s_mul_i32 s43, s58, s45
  buffer_load_dwordx4 v2, s[20:23], s42 offen lds
  ds_read_b128 v[96:99], v17 offset:36864
  ds_read_b64_tr_b16 v[116:117], v22 offset:40960
  ds_read_b64_tr_b16 v[118:119], v22 offset:41984
  ds_read_b64_tr_b16 v[120:121], v23 offset:40960
  ds_read_b64_tr_b16 v[122:123], v23 offset:41984
  v_mfma_f32_32x32x16_bf16 v[156:171], v[32:35], v[52:55], v[156:171]
  v_mfma_f32_32x32x16_bf16 v[172:187], v[32:35], v[56:59], v[172:187]
  s_add_u32 m0, s56, 74752
  s_add_u32 s43, s43, s55
  buffer_load_dwordx4 v3, s[20:23], s42 offen lds
  ds_read_b128 v[100:103], v18 offset:36864
  ds_read_b64_tr_b16 v[124:125], v22 offset:45056
  ds_read_b64_tr_b16 v[126:127], v22 offset:46080
  ds_read_b64_tr_b16 v[128:129], v23 offset:45056
  ds_read_b64_tr_b16 v[130:131], v23 offset:46080
  v_mfma_f32_32x32x16_bf16 v[156:171], v[36:39], v[60:63], v[156:171]
  v_mfma_f32_32x32x16_bf16 v[172:187], v[36:39], v[64:67], v[172:187]
  s_add_u32 m0, s56, 90112
  s_add_u32 s42, s43, s44
  buffer_load_dwordx4 v4, s[24:27], s43 offen lds
  ds_read_b128 v[104:107], v19 offset:36864
  ds_read_b64_tr_b16 v[132:133], v22 offset:49152
  ds_read_b64_tr_b16 v[134:135], v22 offset:50176
  ds_read_b64_tr_b16 v[136:137], v23 offset:49152
  ds_read_b64_tr_b16 v[138:139], v23 offset:50176
  v_mfma_f32_32x32x16_bf16 v[156:171], v[40:43], v[68:71], v[156:171]
  v_mfma_f32_32x32x16_bf16 v[172:187], v[40:43], v[72:75], v[172:187]
  s_add_u32 m0, s56, 91136
  s_lshl_b32 s43, s58, 11
  buffer_load_dwordx4 v4, s[24:27], s42 offen lds
  s_add_u32 m0, s60, 106496
  s_add_u32 s43, s43, s59
  s_mov_b64 exec, s[36:37]
  buffer_load_dwordx4 v6, s[32:35], s43 offen lds
  s_mov_b64 exec, -1
  s_add_u32 s58, s58, 1
  s_and_b32 s58, s58, 7
  s_waitcnt vmcnt(10) lgkmcnt(0)
  s_barrier
  ds_read_b128 v[28:31], v12 offset:0
  ds_read_b64_tr_b16 v[44:45], v20 offset:0
  ds_read_b64_tr_b16 v[46:47], v20 offset:1024
  ds_read_b64_tr_b16 v[48:49], v21 offset:0
  ds_read_b64_tr_b16 v[50:51], v21 offset:1024
  v_mfma_f32_32x32x16_bf16 v[156:171], v[92:95], v[108:111], v[156:171]
  v_mfma_f32_32x32x16_bf16 v[172:187], v[92:95], v[112:115], v[172:187]
  s_lshl_b32 s42, s58, 7
  s_add_u32 s42, s42, s54
  s_add_u32 m0, s56, 110592
  s_mul_i32 s43, s58, s45
  buffer_load_dwordx4 v2, s[20:23], s42 offen lds
  ds_read_b128 v[32:35], v13 offset:0
  ds_read_b64_tr_b16 v[52:53], v20 offset:4096
  ds_read_b64_tr_b16 v[54:55], v20 offset:5120
  ds_read_b64_tr_b16 v[56:57], v21 offset:4096
  ds_read_b64_tr_b16 v[58:59], v21 offset:5120
  v_mfma_f32_32x32x16_bf16 v[156:171], v[96:99], v[116:119], v[156:171]
  v_mfma_f32_32x32x16_bf16 v[172:187], v[96:99], v[120:123], v[172:187]
  s_add_u32 m0, s56, 111616
  s_add_u32 s43, s43, s55
  buffer_load_dwordx4 v3, s[20:23], s42 offen lds
  ds_read_b128 v[36:39], v14 offset:0
  ds_read_b64_tr_b16 v[60:61], v20 offset:8192
  ds_read_b64_tr_b16 v[62:63], v20 offset:9216
  ds_read_b64_tr_b16 v[64:65], v21 offset:8192
  ds_read_b64_tr_b16 v[66:67], v21 offset:9216
  v_mfma_f32_32x32x16_bf16 v[156:171], v[100:103], v[124:127], v[156:171]
  v_mfma_f32_32x32x16_bf16 v[172:187], v[100:103], v[128:131], v[172:187]
  s_add_u32 m0, s56, 126976
  s_add_u32 s42, s43, s44
  buffer_load_dwordx4 v4, s[24:27], s43 offen lds
  ds_read_b128 v[40:43], v15 offset:0
  ds_read_b64_tr_b16 v[68:69], v20 offset:12288
  ds_read_b64_tr_b16 v[70:71], v20 offset:13312
  ds_read_b64_tr_b16 v[72:73], v21 offset:12288
  ds_read_b64_tr_b16 v[74:75], v21 offset:13312
  v_mfma_f32_32x32x16_bf16 v[156:171], v[104:107], v[132:135], v[156:171]
  v_mfma_f32_32x32x16_bf16 v[172:187], v[104:107], v[136:139], v[172:187]
  s_add_u32 m0, s56, 128000
  s_lshl_b32 s43, s58, 11
  buffer_load_dwordx4 v4, s[24:27], s42 offen lds
  s_add_u32 m0, s60, 143360
  s_add_u32 s43, s43, s59
  s_mov_b64 exec, s[36:37]
  buffer_load_dwordx4 v6, s[32:35], s43 offen lds
  s_mov_b64 exec, -1
  s_add_u32 s58, s58, 1
  s_and_b32 s58, s58, 7
  s_waitcnt vmcnt(10) lgkmcnt(0)
  s_barrier
  ds_read_b128 v[92:95], v12 offset:36864
  ds_read_b64_tr_b16 v[108:109], v20 offset:36864
  ds_read_b64_tr_b16 v[110:111], v20 offset:37888
  ds_read_b64_tr_b16 v[112:113], v21 offset:36864
  ds_read_b64_tr_b16 v[114:115], v21 offset:37888
  v_mfma_f32_32x32x16_bf16 v[156:171], v[28:31], v[44:47], v[156:171]
  v_mfma_f32_32x32x16_bf16 v[172:187], v[28:31], v[48:51], v[172:187]
  ds_read_b128 v[96:99], v13 offset:36864
  ds_read_b64_tr_b16 v[116:117], v20 offset:40960
  ds_read_b64_tr_b16 v[118:119], v20 offset:41984
  ds_read_b64_tr_b16 v[120:121], v21 offset:40960
  ds_read_b64_tr_b16 v[122:123], v21 offset:41984
  v_mfma_f32_32x32x16_bf16 v[156:171], v[32:35], v[52:55], v[156:171]
  v_mfma_f32_32x32x16_bf16 v[172:187], v[32:35], v[56:59], v[172:187]
  ds_read_b128 v[100:103], v14 offset:36864
  ds_read_b64_tr_b16 v[124:125], v20 offset:45056
  ds_read_b64_tr_b16 v[126:127], v20 offset:46080
  ds_read_b64_tr_b16 v[128:129], v21 offset:45056
  ds_read_b64_tr_b16 v[130:131], v21 offset:46080
  v_mfma_f32_32x32x16_bf16 v[156:171], v[36:39], v[60:63], v[156:171]
  v_mfma_f32_32x32x16_bf16 v[172:187], v[36:39], v[64:67], v[172:187]
  ds_read_b128 v[104:107], v15 offset:36864
  ds_read_b64_tr_b16 v[132:133], v20 offset:49152
  ds_read_b64_tr_b16 v[134:135], v20 offset:50176
  ds_read_b64_tr_b16 v[136:137], v21 offset:49152
  ds_read_b64_tr_b16 v[138:139], v21 offset:50176
  v_mfma_f32_32x32x16_bf16 v[156:171], v[40:43], v[68:71], v[156:171]
  v_mfma_f32_32x32x16_bf16 v[172:187], v[40:43], v[72:75], v[172:187]
  s_waitcnt vmcnt(5) lgkmcnt(0)
  s_barrier
  ds_read_b128 v[28:31], v16 offset:0
  ds_read_b64_tr_b16 v[44:45], v22 offset:0
  ds_read_b64_tr_b16 v[46:47], v22 offset:1024
  ds_read_b64_tr_b16 v[48:49], v23 offset:0
  ds_read_b64_tr_b16 v[50:51], v23 offset:1024
  v_mfma_f32_32x32x16_bf16 v[156:171], v[92:95], v[108:111], v[156:171]
  v_mfma_f32_32x32x16_bf16 v[172:187], v[92:95], v[112:115], v[172:187]
  ds_read_b128 v[32:35], v17 offset:0
  ds_read_b64_tr_b16 v[52:53], v22 offset:4096
  ds_read_b64_tr_b16 v[54:55], v22 offset:5120
  ds_read_b64_tr_b16 v[56:57], v23 offset:4096
  ds_read_b64_tr_b16 v[58:59], v23 offset:5120
  v_mfma_f32_32x32x16_bf16 v[156:171], v[96:99], v[116:119], v[156:171]
  v_mfma_f32_32x32x16_bf16 v[172:187], v[96:99], v[120:123], v[172:187]
  ds_read_b128 v[36:39], v18 offset:0
  ds_read_b64_tr_b16 v[60:61], v22 offset:8192
  ds_read_b64_tr_b16 v[62:63], v22 offset:9216
  ds_read_b64_tr_b16 v[64:65], v23 offset:8192
  ds_read_b64_tr_b16 v[66:67], v23 offset:9216
  v_mfma_f32_32x32x16_bf16 v[156:171], v[100:103], v[124:127], v[156:171]
  v_mfma_f32_32x32x16_bf16 v[172:187], v[100:103], v[128:131], v[172:187]
  ds_read_b128 v[40:43], v19 offset:0
  ds_read_b64_tr_b16 v[68:69], v22 offset:12288
  ds_read_b64_tr_b16 v[70:71], v22 offset:13312
  ds_read_b64_tr_b16 v[72:73], v23 offset:12288
  ds_read_b64_tr_b16 v[74:75], v23 offset:13312
  v_mfma_f32_32x32x16_bf16 v[156:171], v[104:107], v[132:135], v[156:171]
  v_mfma_f32_32x32x16_bf16 v[172:187], v[104:107], v[136:139], v[172:187]
  s_waitcnt vmcnt(0) lgkmcnt(0)
  s_barrier
  ds_read_b128 v[92:95], v16 offset:36864
  ds_read_b64_tr_b16 v[108:109], v22 offset:36864
  ds_read_b64_tr_b16 v[110:111], v22 offset:37888
  ds_read_b64_tr_b16 v[112:113], v23 offset:36864
  ds_read_b64_tr_b16 v[114:115], v23 offset:37888
  v_mfma_f32_32x32x16_bf16 v[156:171], v[28:31], v[44:47], v[156:171]
  v_mfma_f32_32x32x16_bf16 v[172:187], v[28:31], v[48:51], v[172:187]
  ds_read_b128 v[96:99], v17 offset:36864
  ds_read_b64_tr_b16 v[116:117], v22 offset:40960
  ds_read_b64_tr_b16 v[118:119], v22 offset:41984
  ds_read_b64_tr_b16 v[120:121], v23 offset:40960
  ds_read_b64_tr_b16 v[122:123], v23 offset:41984
  v_mfma_f32_32x32x16_bf16 v[156:171], v[32:35], v[52:55], v[156:171]
  v_mfma_f32_32x32x16_bf16 v[172:187], v[32:35], v[56:59], v[172:187]
  ds_read_b128 v[100:103], v18 offset:36864
  ds_read_b64_tr_b16 v[124:125], v22 offset:45056
  ds_read_b64_tr_b16 v[126:127], v22 offset:46080
  ds_read_b64_tr_b16 v[128:129], v23 offset:45056
  ds_read_b64_tr_b16 v[130:131], v23 offset:46080
  v_mfma_f32_32x32x16_bf16 v[156:171], v[36:39], v[60:63], v[156:171]
  v_mfma_f32_32x32x16_bf16 v[172:187], v[36:39], v[64:67], v[172:187]
  ds_read_b128 v[104:107], v19 offset:36864
  ds_read_b64_tr_b16 v[132:133], v22 offset:49152
  ds_read_b64_tr_b16 v[134:135], v22 offset:50176
  ds_read_b64_tr_b16 v[136:137], v23 offset:49152
  ds_read_b64_tr_b16 v[138:139], v23 offset:50176
  v_mfma_f32_32x32x16_bf16 v[156:171], v[40:43], v[68:71], v[156:171]
  v_mfma_f32_32x32x16_bf16 v[172:187], v[40:43], v[72:75], v[172:187]
  s_waitcnt lgkmcnt(0)
  v_mfma_f32_32x32x16_bf16 v[156:171], v[92:95], v[108:111], v[156:171]
  v_mfma_f32_32x32x16_bf16 v[172:187], v[92:95], v[112:115], v[172:187]
  v_mfma_f32_32x32x16_bf16 v[156:171], v[96:99], v[116:119], v[156:171]
  v_mfma_f32_32x32x16_bf16 v[172:187], v[96:99], v[120:123], v[172:187]
  v_mfma_f32_32x32x16_bf16 v[156:171], v[100:103], v[124:127], v[156:171]
  v_mfma_f32_32x32x16_bf16 v[172:187], v[100:103], v[128:131], v[172:187]
  v_mfma_f32_32x32x16_bf16 v[156:171], v[104:107], v[132:135], v[156:171]
  v_mfma_f32_32x32x16_bf16 v[172:187], v[104:107], v[136:139], v[172:187]
  s_nop 15
  s_branch proj_N_epi
proj_N_plain:
  s_lshl_b32 s42, s58, 7
  s_add_u32 s42, s42, s54
  s_add_u32 m0, s56, 0
  s_mul_i32 s43, s58, s45
  buffer_load_dwordx4 v2, s[20:23], s42 offen lds
  s_add_u32 m0, s56, 1024
  s_add_u32 s43, s43, s55
  buffer_load_dwordx4 v3, s[20:23], s42 offen lds
  s_add_u32 m0, s56, 16384
  s_add_u32 s42, s43, s44
  buffer_load_dwordx4 v4, s[24:27], s43 offen lds
  s_add_u32 m0, s56, 17408
  s_lshl_b32 s43, s58, 11
  buffer_load_dwordx4 v4, s[24:27], s42 offen lds
  s_add_u32 s58, s58, 1
  s_and_b32 s58, s58, 7
  s_lshl_b32 s42, s58, 7
  s_add_u32 s42, s42, s54
  s_add_u32 m0, s56, 36864
  s_mul_i32 s43, s58, s45
  buffer_load_dwordx4 v2, s[20:23], s42 offen lds
  s_add_u32 m0, s56, 37888
  s_add_u32 s43, s43, s55
  buffer_load_dwordx4 v3, s[20:23], s42 offen lds
  s_add_u32 m0, s56, 53248
  s_add_u32 s42, s43, s44
  buffer_load_dwordx4 v4, s[24:27], s43 offen lds
  s_add_u32 m0, s56, 54272
  s_lshl_b32 s43, s58, 11
  buffer_load_dwordx4 v4, s[24:27], s42 offen lds
  s_add_u32 s58, s58, 1
  s_and_b32 s58, s58, 7
  v_and_b32 v8, 31, v1
  v_lshrrev_b32 v9, 5, v1
  v_bfe_u32 v10, v1, 1, 3
  v_xor_b32 v9, v9, v10
  v_lshlrev_b32 v9, 4, v9
  v_lshl_add_u32 v8, v8, 7, v9
  s_lshl_b32 s50, s51, 12
  v_add_u32 v8, s50, v8
  v_xor_b32 v12, 0, v8
  v_add_u32 v16, 73728, v12
  v_xor_b32 v13, 32, v8
  v_add_u32 v17, 73728, v13
  v_xor_b32 v14, 64, v8
  v_add_u32 v18, 73728, v14
  v_xor_b32 v15, 96, v8
  v_add_u32 v19, 73728, v15
  v_lshrrev_b32 v8, 5, v1
  v_bfe_u32 v9, v1, 2, 2
  v_lshl_add_u32 v8, v8, 3, v9
  v_bfe_u32 v10, v1, 4, 1
  v_and_b32 v11, 3, v1
  v_lshl_add_u32 v10, v10, 2, v11
  v_lshlrev_b32 v10, 3, v10
  v_lshl_add_u32 v24, v8, 6, v10
  v_add_u32 v24, 32768, v24
  v_add_u32 v25, 73728, v24
  v_lshl_add_u32 v8, v8, 8, v10
  s_lshl_b32 s50, s52, 1
  v_xor_b32 v9, s50, v9
  v_lshl_add_u32 v8, v9, 6, v8
  v_add_u32 v20, 16384, v8
  v_xor_b32 v21, 64, v20
  v_add_u32 v22, 73728, v20
  v_add_u32 v23, 73728, v21
  s_waitcnt vmcnt(4)
  s_barrier
  ds_read_b128 v[28:31], v12 offset:0
  ds_read_b64_tr_b16 v[44:45], v20 offset:0
  ds_read_b64_tr_b16 v[46:47], v20 offset:1024
  ds_read_b64_tr_b16 v[48:49], v21 offset:0
  ds_read_b64_tr_b16 v[50:51], v21 offset:1024
  ds_read_b128 v[32:35], v13 offset:0
  ds_read_b64_tr_b16 v[52:53], v20 offset:4096
  ds_read_b64_tr_b16 v[54:55], v20 offset:5120
  ds_read_b64_tr_b16 v[56:57], v21 offset:4096
  ds_read_b64_tr_b16 v[58:59], v21 offset:5120
  ds_read_b128 v[36:39], v14 offset:0
  ds_read_b64_tr_b16 v[60:61], v20 offset:8192
  ds_read_b64_tr_b16 v[62:63], v20 offset:9216
  ds_read_b64_tr_b16 v[64:65], v21 offset:8192
  ds_read_b64_tr_b16 v[66:67], v21 offset:9216
  ds_read_b128 v[40:43], v15 offset:0
  ds_read_b64_tr_b16 v[68:69], v20 offset:12288
  ds_read_b64_tr_b16 v[70:71], v20 offset:13312
  ds_read_b64_tr_b16 v[72:73], v21 offset:12288
  ds_read_b64_tr_b16 v[74:75], v21 offset:13312
  s_lshl_b32 s42, s58, 7
  s_add_u32 s42, s42, s54
  s_add_u32 m0, s56, 73728
  s_mul_i32 s43, s58, s45
  buffer_load_dwordx4 v2, s[20:23], s42 offen lds
  s_add_u32 m0, s56, 74752
  s_add_u32 s43, s43, s55
  buffer_load_dwordx4 v3, s[20:23], s42 offen lds
  s_add_u32 m0, s56, 90112
  s_add_u32 s42, s43, s44
  buffer_load_dwordx4 v4, s[24:27], s43 offen lds
  s_add_u32 m0, s56, 91136
  s_lshl_b32 s43, s58, 11
  buffer_load_dwordx4 v4, s[24:27], s42 offen lds
  s_add_u32 s58, s58, 1
  s_and_b32 s58, s58, 7
  s_lshl_b32 s42, s58, 7
  s_add_u32 s42, s42, s54
  s_add_u32 m0, s56, 110592
  s_mul_i32 s43, s58, s45
  buffer_load_dwordx4 v2, s[20:23], s42 offen lds
  s_add_u32 m0, s56, 111616
  s_add_u32 s43, s43, s55
  buffer_load_dwordx4 v3, s[20:23], s42 offen lds
  s_add_u32 m0, s56, 126976
  s_add_u32 s42, s43, s44
  buffer_load_dwordx4 v4, s[24:27], s43 offen lds
  s_add_u32 m0, s56, 128000
  s_lshl_b32 s43, s58, 11
  buffer_load_dwordx4 v4, s[24:27], s42 offen lds
  s_add_u32 s58, s58, 1
  s_and_b32 s58, s58, 7
  s_waitcnt vmcnt(8) lgkmcnt(0)
  s_barrier
  ds_read_b128 v[92:95], v12 offset:36864
  ds_read_b64_tr_b16 v[108:109], v20 offset:36864
  ds_read_b64_tr_b16 v[110:111], v20 offset:37888
  ds_read_b64_tr_b16 v[112:113], v21 offset:36864
  ds_read_b64_tr_b16 v[114:115], v21 offset:37888
  v_mfma_f32_32x32x16_bf16 v[156:171], v[28:31], v[44:47], 0
  v_mfma_f32_32x32x16_bf16 v[172:187], v[28:31], v[48:51], 0
  s_lshl_b32 s42, s58, 7
  s_add_u32 s42, s42, s54
  s_add_u32 m0, s56, 0
  s_mul_i32 s43, s58, s45
  buffer_load_dwordx4 v2, s[20:23], s42 offen lds
  ds_read_b128 v[96:99], v13 offset:36864
  ds_read_b64_tr_b16 v[116:117], v20 offset:40960
  ds_read_b64_tr_b16 v[118:119], v20 offset:41984
  ds_read_b64_tr_b16 v[120:121], v21 offset:40960
  ds_read_b64_tr_b16 v[122:123], v21 offset:41984
  v_mfma_f32_32x32x16_bf16 v[156:171], v[32:35], v[52:55], v[156:171]
  v_mfma_f32_32x32x16_bf16 v[172:187], v[32:35], v[56:59], v[172:187]
  s_add_u32 m0, s56, 1024
  s_add_u32 s43, s43, s55
  buffer_load_dwordx4 v3, s[20:23], s42 offen lds
  ds_read_b128 v[100:103], v14 offset:36864
  ds_read_b64_tr_b16 v[124:125], v20 offset:45056
  ds_read_b64_tr_b16 v[126:127], v20 offset:46080
  ds_read_b64_tr_b16 v[128:129], v21 offset:45056
  ds_read_b64_tr_b16 v[130:131], v21 offset:46080
  v_mfma_f32_32x32x16_bf16 v[156:171], v[36:39], v[60:63], v[156:171]
  v_mfma_f32_32x32x16_bf16 v[172:187], v[36:39], v[64:67], v[172:187]
  s_add_u32 m0, s56, 16384
  s_add_u32 s42, s43, s44
  buffer_load_dwordx4 v4, s[24:27], s43 offen lds
  ds_read_b128 v[104:107], v15 offset:36864
  ds_read_b64_tr_b16 v[132:133], v20 offset:49152
  ds_read_b64_tr_b16 v[134:135], v20 offset:50176
  ds_read_b64_tr_b16 v[136:137], v21 offset:49152
  ds_read_b64_tr_b16 v[138:139], v21 offset:50176
  v_mfma_f32_32x32x16_bf16 v[156:171], v[40:43], v[68:71], v[156:171]
  v_mfma_f32_32x32x16_bf16 v[172:187], v[40:43], v[72:75], v[172:187]
  s_add_u32 m0, s56, 17408
  s_lshl_b32 s43, s58, 11
  buffer_load_dwordx4 v4, s[24:27], s42 offen lds
  s_add_u32 s58, s58, 1
  s_and_b32 s58, s58, 7
  s_waitcnt vmcnt(8) lgkmcnt(0)
  s_barrier
  ds_read_b128 v[28:31], v16 offset:0
  ds_read_b64_tr_b16 v[44:45], v22 offset:0
  ds_read_b64_tr_b16 v[46:47], v22 offset:1024
  ds_read_b64_tr_b16 v[48:49], v23 offset:0
  ds_read_b64_tr_b16 v[50:51], v23 offset:1024
  v_mfma_f32_32x32x16_bf16 v[156:171], v[92:95], v[108:111], v[156:171]
  v_mfma_f32_32x32x16_bf16 v[172:187], v[92:95], v[112:115], v[172:187]
  s_lshl_b32 s42, s58, 7
  s_add_u32 s42, s42, s54
  s_add_u32 m0, s56, 36864
  s_mul_i32 s43, s58, s45
  buffer_load_dwordx4 v2, s[20:23], s42 offen lds
  ds_read_b128 v[32:35], v17 offset:0
  ds_read_b64_tr_b16 v[52:53], v22 offset:4096
  ds_read_b64_tr_b16 v[54:55], v22 offset:5120
  ds_read_b64_tr_b16 v[56:57], v23 offset:4096
  ds_read_b64_tr_b16 v[58:59], v23 offset:5120
  v_mfma_f32_32x32x16_bf16 v[156:171], v[96:99], v[116:119], v[156:171]
  v_mfma_f32_32x32x16_bf16 v[172:187], v[96:99], v[120:123], v[172:187]
  s_add_u32 m0, s56, 37888
  s_add_u32 s43, s43, s55
  buffer_load_dwordx4 v3, s[20:23], s42 offen lds
  ds_read_b128 v[36:39], v18 offset:0
  ds_read_b64_tr_b16 v[60:61], v22 offset:8192
  ds_read_b64_tr_b16 v[62:63], v22 offset:9216
  ds_read_b64_tr_b16 v[64:65], v23 offset:8192
  ds_read_b64_tr_b16 v[66:67], v23 offset:9216
  v_mfma_f32_32x32x16_bf16 v[156:171], v[100:103], v[124:127], v[156:171]
  v_mfma_f32_32x32x16_bf16 v[172:187], v[100:103], v[128:131], v[172:187]
  s_add_u32 m0, s56, 53248
  s_add_u32 s42, s43, s44
  buffer_load_dwordx4 v4, s[24:27], s43 offen lds
  ds_read_b128 v[40:43], v19 offset:0
  ds_read_b64_tr_b16 v[68:69], v22 offset:12288
  ds_read_b64_tr_b16 v[70:71], v22 offset:13312
  ds_read_b64_tr_b16 v[72:73], v23 offset:12288
  ds_read_b64_tr_b16 v[74:75], v23 offset:13312
  v_mfma_f32_32x32x16_bf16 v[156:171], v[104:107], v[132:135], v[156:171]
  v_mfma_f32_32x32x16_bf16 v[172:187], v[104:107], v[136:139], v[172:187]
  s_add_u32 m0, s56, 54272
  s_lshl_b32 s43, s58, 11
  buffer_load_dwordx4 v4, s[24:27], s42 offen lds
  s_add_u32 s58, s58, 1
  s_and_b32 s58, s58, 7
  s_waitcnt vmcnt(8) lgkmcnt(0)
  s_barrier
  ds_read_b128 v[92:95], v16 offset:36864
  ds_read_b64_tr_b16 v[108:109], v22 offset:36864
  ds_read_b64_tr_b16 v[110:111], v22 offset:37888
  ds_read_b64_tr_b16 v[112:113], v23 offset:36864
  ds_read_b64_tr_b16 v[114:115], v23 offset:37888
  v_mfma_f32_32x32x16_bf16 v[156:171], v[28:31], v[44:47], v[156:171]
  v_mfma_f32_32x32x16_bf16 v[172:187], v[28:31], v[48:51], v[172:187]
  s_lshl_b32 s42, s58, 7
  s_add_u32 s42, s42, s54
  s_add_u32 m0, s56, 73728
  s_mul_i32 s43, s58, s45
  buffer_load_dwordx4 v2, s[20:23], s42 offen lds
  ds_read_b128 v[96:99], v17 offset:36864
  ds_read_b64_tr_b16 v[116:117], v22 offset:40960
  ds_read_b64_tr_b16 v[118:119], v22 offset:41984
  ds_read_b64_tr_b16 v[120:121], v23 offset:40960
  ds_read_b64_tr_b16 v[122:123], v23 offset:41984
  v_mfma_f32_32x32x16_bf16 v[156:171], v[32:35], v[52:55], v[156:171]
  v_mfma_f32_32x32x16_bf16 v[172:187], v[32:35], v[56:59], v[172:187]
  s_add_u32 m0, s56, 74752
  s_add_u32 s43, s43, s55
  buffer_load_dwordx4 v3, s[20:23], s42 offen lds
  ds_read_b128 v[100:103], v18 offset:36864
  ds_read_b64_tr_b16 v[124:125], v22 offset:45056
  ds_read_b64_tr_b16 v[126:127], v22 offset:46080
  ds_read_b64_tr_b16 v[128:129], v23 offset:45056
  ds_read_b64_tr_b16 v[130:131], v23 offset:46080
  v_mfma_f32_32x32x16_bf16 v[156:171], v[36:39], v[60:63], v[156:171]
  v_mfma_f32_32x32x16_bf16 v[172:187], v[36:39], v[64:67], v[172:187]
  s_add_u32 m0, s56, 90112
  s_add_u32 s42, s43, s44
  buffer_load_dwordx4 v4, s[24:27], s43 offen lds
  ds_read_b128 v[104:107], v19 offset:36864
  ds_read_b64_tr_b16 v[132:133], v22 offset:49152
  ds_read_b64_tr_b16 v[134:135], v22 offset:50176
  ds_read_b64_tr_b16 v[136:137], v23 offset:49152
  ds_read_b64_tr_b16 v[138:139], v23 offset:50176
  v_mfma_f32_32x32x16_bf16 v[156:171], v[40:43], v[68:71], v[156:171]
  v_mfma_f32_32x32x16_bf16 v[172:187], v[40:43], v[72:75], v[172:187]
  s_add_u32 m0, s56, 91136
  s_lshl_b32 s43, s58, 11
  buffer_load_dwordx4 v4, s[24:27], s42 offen lds
  s_add_u32 s58, s58, 1
  s_and_b32 s58, s58, 7
  s_waitcnt vmcnt(8) lgkmcnt(0)
  s_barrier
  ds_read_b128 v[28:31], v12 offset:0
  ds_read_b64_tr_b16 v[44:45], v20 offset:0
  ds_read_b64_tr_b16 v[46:47], v20 offset:1024
  ds_read_b64_tr_b16 v[48:49], v21 offset:0
  ds_read_b64_tr_b16 v[50:51], v21 offset:1024
  v_mfma_f32_32x32x16_bf16 v[156:171], v[92:95], v[108:111], v[156:171]
  v_mfma_f32_32x32x16_bf16 v[172:187], v[92:95], v[112:115], v[172:187]
  s_lshl_b32 s42, s58, 7
  s_add_u32 s42, s42, s54
  s_add_u32 m0, s56, 110592
  s_mul_i32 s43, s58, s45
  buffer_load_dwordx4 v2, s[20:23], s42 offen lds
  ds_read_b128 v[32:35], v13 offset:0
  ds_read_b64_tr_b16 v[52:53], v20 offset:4096
  ds_read_b64_tr_b16 v[54:55], v20 offset:5120
  ds_read_b64_tr_b16 v[56:57], v21 offset:4096
  ds_read_b64_tr_b16 v[58:59], v21 offset:5120
  v_mfma_f32_32x32x16_bf16 v[156:171], v[96:99], v[116:119], v[156:171]
  v_mfma_f32_32x32x16_bf16 v[172:187], v[96:99], v[120:123], v[172:187]
  s_add_u32 m0, s56, 111616
  s_add_u32 s43, s43, s55
  buffer_load_dwordx4 v3, s[20:23], s42 offen lds
  ds_read_b128 v[36:39], v14 offset:0
  ds_read_b64_tr_b16 v[60:61], v20 offset:8192
  ds_read_b64_tr_b16 v[62:63], v20 offset:9216
  ds_read_b64_tr_b16 v[64:65], v21 offset:8192
  ds_read_b64_tr_b16 v[66:67], v21 offset:9216
  v_mfma_f32_32x32x16_bf16 v[156:171], v[100:103], v[124:127], v[156:171]
  v_mfma_f32_32x32x16_bf16 v[172:187], v[100:103], v[128:131], v[172:187]
  s_add_u32 m0, s56, 126976
  s_add_u32 s42, s43, s44
  buffer_load_dwordx4 v4, s[24:27], s43 offen lds
  ds_read_b128 v[40:43], v15 offset:0
  ds_read_b64_tr_b16 v[68:69], v20 offset:12288
  ds_read_b64_tr_b16 v[70:71], v20 offset:13312
  ds_read_b64_tr_b16 v[72:73], v21 offset:12288
  ds_read_b64_tr_b16 v[74:75], v21 offset:13312
  v_mfma_f32_32x32x16_bf16 v[156:171], v[104:107], v[132:135], v[156:171]
  v_mfma_f32_32x32x16_bf16 v[172:187], v[104:107], v[136:139], v[172:187]
  s_add_u32 m0, s56, 128000
  s_lshl_b32 s43, s58, 11
  buffer_load_dwordx4 v4, s[24:27], s42 offen lds
  s_add_u32 s58, s58, 1
  s_and_b32 s58, s58, 7
  s_waitcnt vmcnt(8) lgkmcnt(0)
  s_barrier
  ds_read_b128 v[92:95], v12 offset:36864
  ds_read_b64_tr_b16 v[108:109], v20 offset:36864
  ds_read_b64_tr_b16 v[110:111], v20 offset:37888
  ds_read_b64_tr_b16 v[112:113], v21 offset:36864
  ds_read_b64_tr_b16 v[114:115], v21 offset:37888
  v_mfma_f32_32x32x16_bf16 v[156:171], v[28:31], v[44:47], v[156:171]
  v_mfma_f32_32x32x16_bf16 v[172:187], v[28:31], v[48:51], v[172:187]
  ds_read_b128 v[96:99], v13 offset:36864
  ds_read_b64_tr_b16 v[116:117], v20 offset:40960
  ds_read_b64_tr_b16 v[118:119], v20 offset:41984
  ds_read_b64_tr_b16 v[120:121], v21 offset:40960
  ds_read_b64_tr_b16 v[122:123], v21 offset:41984
  v_mfma_f32_32x32x16_bf16 v[156:171], v[32:35], v[52:55], v[156:171]
  v_mfma_f32_32x32x16_bf16 v[172:187], v[32:35], v[56:59], v[172:187]
  ds_read_b128 v[100:103], v14 offset:36864
  ds_read_b64_tr_b16 v[124:125], v20 offset:45056
  ds_read_b64_tr_b16 v[126:127], v20 offset:46080
  ds_read_b64_tr_b16 v[128:129], v21 offset:45056
  ds_read_b64_tr_b16 v[130:131], v21 offset:46080
  v_mfma_f32_32x32x16_bf16 v[156:171], v[36:39], v[60:63], v[156:171]
  v_mfma_f32_32x32x16_bf16 v[172:187], v[36:39], v[64:67], v[172:187]
  ds_read_b128 v[104:107], v15 offset:36864
  ds_read_b64_tr_b16 v[132:133], v20 offset:49152
  ds_read_b64_tr_b16 v[134:135], v20 offset:50176
  ds_read_b64_tr_b16 v[136:137], v21 offset:49152
  ds_read_b64_tr_b16 v[138:139], v21 offset:50176
  v_mfma_f32_32x32x16_bf16 v[156:171], v[40:43], v[68:71], v[156:171]
  v_mfma_f32_32x32x16_bf16 v[172:187], v[40:43], v[72:75], v[172:187]
  s_waitcnt vmcnt(4) lgkmcnt(0)
  s_barrier
  ds_read_b128 v[28:31], v16 offset:0
  ds_read_b64_tr_b16 v[44:45], v22 offset:0
  ds_read_b64_tr_b16 v[46:47], v22 offset:1024
  ds_read_b64_tr_b16 v[48:49], v23 offset:0
  ds_read_b64_tr_b16 v[50:51], v23 offset:1024
  v_mfma_f32_32x32x16_bf16 v[156:171], v[92:95], v[108:111], v[156:171]
  v_mfma_f32_32x32x16_bf16 v[172:187], v[92:95], v[112:115], v[172:187]
  ds_read_b128 v[32:35], v17 offset:0
  ds_read_b64_tr_b16 v[52:53], v22 offset:4096
  ds_read_b64_tr_b16 v[54:55], v22 offset:5120
  ds_read_b64_tr_b16 v[56:57], v23 offset:4096
  ds_read_b64_tr_b16 v[58:59], v23 offset:5120
  v_mfma_f32_32x32x16_bf16 v[156:171], v[96:99], v[116:119], v[156:171]
  v_mfma_f32_32x32x16_bf16 v[172:187], v[96:99], v[120:123], v[172:187]
  ds_read_b128 v[36:39], v18 offset:0
  ds_read_b64_tr_b16 v[60:61], v22 offset:8192
  ds_read_b64_tr_b16 v[62:63], v22 offset:9216
  ds_read_b64_tr_b16 v[64:65], v23 offset:8192
  ds_read_b64_tr_b16 v[66:67], v23 offset:9216
  v_mfma_f32_32x32x16_bf16 v[156:171], v[100:103], v[124:127], v[156:171]
  v_mfma_f32_32x32x16_bf16 v[172:187], v[100:103], v[128:131], v[172:187]
  ds_read_b128 v[40:43], v19 offset:0
  ds_read_b64_tr_b16 v[68:69], v22 offset:12288
  ds_read_b64_tr_b16 v[70:71], v22 offset:13312
  ds_read_b64_tr_b16 v[72:73], v23 offset:12288
  ds_read_b64_tr_b16 v[74:75], v23 offset:13312
  v_mfma_f32_32x32x16_bf16 v[156:171], v[104:107], v[132:135], v[156:171]
  v_mfma_f32_32x32x16_bf16 v[172:187], v[104:107], v[136:139], v[172:187]
  s_waitcnt vmcnt(0) lgkmcnt(0)
  s_barrier
  ds_read_b128 v[92:95], v16 offset:36864
  ds_read_b64_tr_b16 v[108:109], v22 offset:36864
  ds_read_b64_tr_b16 v[110:111], v22 offset:37888
  ds_read_b64_tr_b16 v[112:113], v23 offset:36864
  ds_read_b64_tr_b16 v[114:115], v23 offset:37888
  v_mfma_f32_32x32x16_bf16 v[156:171], v[28:31], v[44:47], v[156:171]
  v_mfma_f32_32x32x16_bf16 v[172:187], v[28:31], v[48:51], v[172:187]
  ds_read_b128 v[96:99], v17 offset:36864
  ds_read_b64_tr_b16 v[116:117], v22 offset:40960
  ds_read_b64_tr_b16 v[118:119], v22 offset:41984
  ds_read_b64_tr_b16 v[120:121], v23 offset:40960
  ds_read_b64_tr_b16 v[122:123], v23 offset:41984
  v_mfma_f32_32x32x16_bf16 v[156:171], v[32:35], v[52:55], v[156:171]
  v_mfma_f32_32x32x16_bf16 v[172:187], v[32:35], v[56:59], v[172:187]
  ds_read_b128 v[100:103], v18 offset:36864
  ds_read_b64_tr_b16 v[124:125], v22 offset:45056
  ds_read_b64_tr_b16 v[126:127], v22 offset:46080
  ds_read_b64_tr_b16 v[128:129], v23 offset:45056
  ds_read_b64_tr_b16 v[130:131], v23 offset:46080
  v_mfma_f32_32x32x16_bf16 v[156:171], v[36:39], v[60:63], v[156:171]
  v_mfma_f32_32x32x16_bf16 v[172:187], v[36:39], v[64:67], v[172:187]
  ds_read_b128 v[104:107], v19 offset:36864
  ds_read_b64_tr_b16 v[132:133], v22 offset:49152
  ds_read_b64_tr_b16 v[134:135], v22 offset:50176
  ds_read_b64_tr_b16 v[136:137], v23 offset:49152
  ds_read_b64_tr_b16 v[138:139], v23 offset:50176
  v_mfma_f32_32x32x16_bf16 v[156:171], v[40:43], v[68:71], v[156:171]
  v_mfma_f32_32x32x16_bf16 v[172:187], v[40:43], v[72:75], v[172:187]
  s_waitcnt lgkmcnt(0)
  v_mfma_f32_32x32x16_bf16 v[156:171], v[92:95], v[108:111], v[156:171]
  v_mfma_f32_32x32x16_bf16 v[172:187], v[92:95], v[112:115], v[172:187]
  v_mfma_f32_32x32x16_bf16 v[156:171], v[96:99], v[116:119], v[156:171]
  v_mfma_f32_32x32x16_bf16 v[172:187], v[96:99], v[120:123], v[172:187]
  v_mfma_f32_32x32x16_bf16 v[156:171], v[100:103], v[124:127], v[156:171]
  v_mfma_f32_32x32x16_bf16 v[172:187], v[100:103], v[128:131], v[172:187]
  v_mfma_f32_32x32x16_bf16 v[156:171], v[104:107], v[132:135], v[156:171]
  v_mfma_f32_32x32x16_bf16 v[172:187], v[104:107], v[136:139], v[172:187]
  s_nop 15
proj_N_epi:
  v_and_b32 v8, 3, v1
  v_and_b32 v9, 4, v1
  v_lshl_or_b32 v8, v9, 1, v8
  v_and_b32 v9, 8, v1
  v_lshrrev_b32 v9, 1, v9
  v_or_b32 v8, v8, v9
  v_lshlrev_b32 v8, 4, v8
  v_lshrrev_b32 v9, 5, v1
  v_lshl_add_u32 v8, v9, 9, v8
  v_bfe_u32 v9, v1, 4, 1
  v_lshl_add_u32 v5, v9, 17, v8
  s_sub_u32 s44, s40, 12
  s_lshl_b32 s44, s44, 3
  s_lshl_b32 s42, s52, 2
  s_add_u32 s44, s44, s42
  s_lshl_b32 s44, s44, 6
  s_add_u32 s44, s44, s57
  s_lshl_b32 s50, s44, 11
  s_add_u32 s50, s50, 4195328
  v_cvt_pk_bf16_f32 v28, v156, v157
  v_cvt_pk_bf16_f32 v29, v158, v159
  v_cvt_pk_bf16_f32 v30, v160, v161
  v_cvt_pk_bf16_f32 v31, v162, v163
  v_cvt_pk_bf16_f32 v32, v164, v165
  v_cvt_pk_bf16_f32 v33, v166, v167
  v_cvt_pk_bf16_f32 v34, v168, v169
  v_cvt_pk_bf16_f32 v35, v170, v171
  buffer_store_dwordx4 v[28:31], v5, s[28:31], s50 offen offset:0 sc0 sc1
  buffer_store_dwordx4 v[32:35], v5, s[28:31], s50 offen offset:256 sc0 sc1
  s_add_u32 s50, s50, 262144
  v_cvt_pk_bf16_f32 v36, v172, v173
  v_cvt_pk_bf16_f32 v37, v174, v175
  v_cvt_pk_bf16_f32 v38, v176, v177
  v_cvt_pk_bf16_f32 v39, v178, v179
  v_cvt_pk_bf16_f32 v40, v180, v181
  v_cvt_pk_bf16_f32 v41, v182, v183
  v_cvt_pk_bf16_f32 v42, v184, v185
  v_cvt_pk_bf16_f32 v43, v186, v187
  buffer_store_dwordx4 v[36:39], v5, s[28:31], s50 offen offset:0 sc0 sc1
  buffer_store_dwordx4 v[40:43], v5, s[28:31], s50 offen offset:256 sc0 sc1
proj_done:
  s_endpgm
.globl attn_kernel
.p2align 8
.type attn_kernel,@function
attn_kernel:
  s_cmp_ge_u32 s2, 256
  s_cbranch_scc1 attn_done
  s_load_dwordx2 s[4:5], s[0:1], 88
  s_load_dwordx2 s[6:7], s[0:1], 0
  s_load_dwordx2 s[28:29], s[0:1], 64
  s_load_dwordx2 s[56:57], s[0:1], 32
  s_load_dwordx2 s[58:59], s[0:1], 56
  v_and_b32 v1, 63, v0
  v_lshrrev_b32 v4, 6, v0
  s_nop 0
  v_readfirstlane_b32 s12, v4
  s_and_b32 s17, s2, 7
  s_lshr_b32 s18, s2, 3
  s_lshr_b32 s13, s18, 2
  s_lshl_b32 s13, s13, 3
  s_add_u32 s13, s13, s17
  s_and_b32 s18, s18, 3
  s_lshl_b32 s16, s18, 4
  s_lshl_b32 s17, s12, 1
  s_add_u32 s16, s16, s17
  s_lshr_b32 s14, s13, 5
  s_and_b32 s15, s13, 31
  s_mov_b32 s24, 0x0000ffff
  s_mov_b32 s25, 0x0000ffff
  s_mov_b32 s20, 0x5f800000
  s_mov_b32 s21, 0x7f800000
  s_mov_b32 s22, 0
  v_lshlrev_b32 v2, 4, v1
  s_cmp_eq_u32 s14, 1
  s_cselect_b32 s17, s15, 32
  s_lshl_b32 s17, s17, 17
  s_add_u32 s17, s17, 4194304
  s_lshl_b32 s18, s12, 11
  s_add_u32 s17, s17, s18
  s_lshl_b32 s23, s13, 6
  s_add_u32 s23, s23, s16
  s_lshl_b32 s23, s23, 10
  s_mov_b32 m0, s18
  s_waitcnt lgkmcnt(0)
  s_mov_b32 s8, s4
  s_and_b32 s9, s5, 0xffff
  s_mov_b32 s10, 268435456
  s_mov_b32 s11, 0x00020000
  buffer_load_dwordx4 v2, s[8:11], s17 offen lds
  buffer_load_dwordx4 v2, s[8:11], s17 offen offset:1024 lds
  buffer_load_dwordx4 v[32:35], v2, s[8:11], s23 offen
  buffer_load_dwordx4 v[36:39], v2, s[8:11], s23 offen offset:1024
  s_mov_b32 s48, s6
  s_and_b32 s49, s7, 0xffff
  s_mov_b32 s50, 2097152
  s_mov_b32 s51, 0x00020000
  s_mov_b32 s52, s28
  s_and_b32 s53, s29, 0xffff
  s_mov_b32 s54, 1024
  s_mov_b32 s55, 0x00020000
  s_barrier
  s_add_u32 s17, s17, 16384
  s_add_u32 m0, s18, 16384
  s_nop 0
  buffer_load_dwordx4 v2, s[8:11], s17 offen lds
  buffer_load_dwordx4 v2, s[8:11], s17 offen offset:1024 lds
  v_and_b32 v4, 31, v1
  v_and_b32 v5, 27, v4
  v_mov_b32 v6, 0x3f803f80
  v_cmp_eq_u32 vcc, 16, v5
  s_nop 1
  v_cndmask_b32 v6, 0, v6, vcc
  v_mov_b32 v16, v6
  v_mov_b32 v17, v6
  v_mov_b32 v18, v6
  v_mov_b32 v19, v6
  v_mov_b32 v20, v6
  v_mov_b32 v21, v6
  v_mov_b32 v22, v6
  v_mov_b32 v23, v6
  v_mov_b32 v24, v6
  v_mov_b32 v25, v6
  v_mov_b32 v26, v6
  v_mov_b32 v27, v6
  v_mov_b32 v28, v6
  v_mov_b32 v29, v6
  v_mov_b32 v30, v6
  v_mov_b32 v31, v6
  v_mov_b32 v72, 0
  v_mov_b32 v73, 0
  v_mov_b32 v74, 0
  v_mov_b32 v75, 0
  v_mov_b32 v76, 0
  v_mov_b32 v77, 0
  v_mov_b32 v78, 0
  v_mov_b32 v79, 0
  v_mov_b32 v80, 0
  v_mov_b32 v81, 0
  v_mov_b32 v82, 0
  v_mov_b32 v83, 0
  v_mov_b32 v84, 0
  v_mov_b32 v85, 0
  v_mov_b32 v86, 0
  v_mov_b32 v87, 0
  v_mov_b32 v48, 0
  v_mov_b32 v49, 0
  v_mov_b32 v50, 0
  v_mov_b32 v51, 0
  v_mov_b32 v52, 0
  v_mov_b32 v53, 0
  v_mov_b32 v54, 0
  v_mov_b32 v55, 0
  v_mov_b32 v88, 0
  v_mov_b32 v89, 0
  v_mov_b32 v90, 0
  v_mov_b32 v91, 0
  v_mov_b32 v92, 0
  v_mov_b32 v93, 0
  v_mov_b32 v94, 0
  v_mov_b32 v95, 0
  v_mov_b32 v96, 0
  v_mov_b32 v97, 0
  v_mov_b32 v98, 0
  v_mov_b32 v99, 0
  v_mov_b32 v100, 0
  v_mov_b32 v101, 0
  v_mov_b32 v102, 0
  v_mov_b32 v103, 0
  v_mov_b32 v64, 0
  v_mov_b32 v65, 0
  v_mov_b32 v66, 0
  v_mov_b32 v67, 0
  v_mov_b32 v68, 0
  v_mov_b32 v69, 0
  v_mov_b32 v70, 0
  v_mov_b32 v71, 0
  s_lshl_b32 s46, s12, 2
  s_add_u32 s46, s46, 135168
  v_mov_b32 v216, s46
  v_xor_b32 v217, 16, v216
  v_mov_b32 v218, 0
  ds_write_b32 v216, v218
  s_waitcnt vmcnt(2) lgkmcnt(0)
  s_barrier
  ds_read_b128 v[8:11], v2 offset:0
  ds_read_b128 v[12:15], v2 offset:2048
  s_waitcnt lgkmcnt(0)
  v_mfma_f32_32x32x16_bf16 v[136:151], v[8:11], v[32:35], 0
  v_mfma_f32_32x32x16_bf16 v[168:183], v[8:11], v[36:39], 0
  s_add_u32 s17, s17, 16384
  s_add_u32 m0, s18, 32768
  s_nop 0
  buffer_load_dwordx4 v2, s[8:11], s17 offen lds
  buffer_load_dwordx4 v2, s[8:11], s17 offen offset:1024 lds
  v_max3_f32 v4, v136, v137, v138
  v_max3_f32 v4, v4, v139, v140
  v_max3_f32 v4, v4, v141, v142
  v_max3_f32 v4, v4, v143, v144
  v_max3_f32 v4, v4, v145, v146
  v_max3_f32 v4, v4, v147, v148
  v_max3_f32 v4, v4, v149, v150
  v_max_f32 v4, v4, v151
  v_mov_b32 v5, v4
  s_nop 1
  v_permlane32_swap_b32 v4, v5
  v_max_f32 v4, v4, v5
  v_sub_f32 v4, 0xc2200000, v4
  v_mov_b32 v104, v4
  v_mov_b32 v105, v4
  v_mov_b32 v106, v4
  v_mov_b32 v107, v4
  v_mov_b32 v108, v4
  v_mov_b32 v109, v4
  v_mov_b32 v110, v4
  v_mov_b32 v111, v4
  v_mov_b32 v112, v4
  v_mov_b32 v113, v4
  v_mov_b32 v114, v4
  v_mov_b32 v115, v4
  v_mov_b32 v116, v4
  v_mov_b32 v117, v4
  v_mov_b32 v118, v4
  v_mov_b32 v119, v4
  s_nop 1
  v_mfma_f32_32x32x16_bf16 v[136:151], v[8:11], v[32:35], v[104:119]
  v_max3_f32 v4, v168, v169, v170
  v_max3_f32 v4, v4, v171, v172
  v_max3_f32 v4, v4, v173, v174
  v_max3_f32 v4, v4, v175, v176
  v_max3_f32 v4, v4, v177, v178
  v_max3_f32 v4, v4, v179, v180
  v_max3_f32 v4, v4, v181, v182
  v_max_f32 v4, v4, v183
  v_mov_b32 v5, v4
  s_nop 1
  v_permlane32_swap_b32 v4, v5
  v_max_f32 v4, v4, v5
  v_sub_f32 v4, 0xc2200000, v4
  v_mov_b32 v120, v4
  v_mov_b32 v121, v4
  v_mov_b32 v122, v4
  v_mov_b32 v123, v4
  v_mov_b32 v124, v4
  v_mov_b32 v125, v4
  v_mov_b32 v126, v4
  v_mov_b32 v127, v4
  v_mov_b32 v128, v4
  v_mov_b32 v129, v4
  v_mov_b32 v130, v4
  v_mov_b32 v131, v4
  v_mov_b32 v132, v4
  v_mov_b32 v133, v4
  v_mov_b32 v134, v4
  v_mov_b32 v135, v4
  s_nop 1
  v_mfma_f32_32x32x16_bf16 v[168:183], v[8:11], v[36:39], v[120:135]
  s_mov_b32 s19, 0
  s_cmp_ge_u32 s12, 4
  s_cbranch_scc1 attn_loop1
.p2align 6
attn_loop0:
  s_cmp_lg_u32 s19, 0
  s_cbranch_scc1 attn_nodma0_0
  s_add_u32 s17, s17, 16384
  s_add_u32 m0, s18, 49152
  s_nop 0
  buffer_load_dwordx4 v2, s[8:11], s17 offen lds
  buffer_load_dwordx4 v2, s[8:11], s17 offen offset:1024 lds
attn_nodma0_0:
  s_waitcnt lgkmcnt(2)
  v_readfirstlane_b32 s46, v218
  s_cmp_eq_u32 s19, s46
  s_cbranch_scc1 attn_ptie0
  s_cmp_gt_u32 s19, s46
  s_cbranch_scc1 attn_plow0
  s_setprio 2
  s_branch attn_pdone0
attn_plow0:
  s_setprio 0
  s_branch attn_pdone0
attn_ptie0:
  s_setprio 0
attn_pdone0:
  v_mfma_f32_32x32x16_bf16 v[152:167], v[12:15], v[32:35], v[104:119]
  v_exp_f32 v136, v136
  v_exp_f32 v137, v137
  v_exp_f32 v138, v138
  v_exp_f32 v139, v139
  v_exp_f32 v140, v140
  v_mfma_f32_32x32x16_bf16 v[184:199], v[12:15], v[36:39], v[120:135]
  ds_read_b128 v[8:11], v2 offset:4096
  s_mov_b64 exec, s[24:25]
  ds_read_b128 v[16:19], v2 offset:1024
  ds_read_b128 v[20:23], v2 offset:1280
  s_mov_b64 exec, -1
  v_exp_f32 v141, v141
  v_exp_f32 v142, v142
  v_exp_f32 v143, v143
  v_exp_f32 v144, v144
  v_exp_f32 v145, v145
  v_exp_f32 v146, v146
  s_waitcnt lgkmcnt(3)
  v_mfma_f32_32x32x16_bf16 v[72:87], v[24:27], v[48:51], v[72:87]
  v_exp_f32 v147, v147
  v_exp_f32 v148, v148
  v_exp_f32 v149, v149
  v_exp_f32 v150, v150
  v_exp_f32 v151, v151
  v_cvt_pk_bf16_f32 v40, v136, v137
  v_mfma_f32_32x32x16_bf16 v[72:87], v[28:31], v[52:55], v[72:87]
  v_cvt_pk_bf16_f32 v41, v138, v139
  v_cvt_pk_bf16_f32 v42, v140, v141
  v_cvt_pk_bf16_f32 v43, v142, v143
  v_cvt_pk_bf16_f32 v44, v144, v145
  v_cvt_pk_bf16_f32 v45, v146, v147
  v_cvt_pk_bf16_f32 v46, v148, v149
  v_cvt_pk_bf16_f32 v47, v150, v151
  v_exp_f32 v168, v168
  v_exp_f32 v169, v169
  v_exp_f32 v170, v170
  v_mfma_f32_32x32x16_bf16 v[88:103], v[24:27], v[64:67], v[88:103]
  v_exp_f32 v171, v171
  v_exp_f32 v172, v172
  v_exp_f32 v173, v173
  v_exp_f32 v174, v174
  v_exp_f32 v175, v175
  v_exp_f32 v176, v176
  v_mfma_f32_32x32x16_bf16 v[88:103], v[28:31], v[68:71], v[88:103]
  v_exp_f32 v177, v177
  v_exp_f32 v178, v178
  v_exp_f32 v179, v179
  v_exp_f32 v180, v180
  v_exp_f32 v181, v181
  v_exp_f32 v182, v182
  v_exp_f32 v183, v183
  v_cvt_pk_bf16_f32 v56, v168, v169
  v_cvt_pk_bf16_f32 v57, v170, v171
  v_cvt_pk_bf16_f32 v58, v172, v173
  v_cvt_pk_bf16_f32 v59, v174, v175
  v_cvt_pk_bf16_f32 v60, v176, v177
  v_cvt_pk_bf16_f32 v61, v178, v179
  v_cvt_pk_bf16_f32 v62, v180, v181
  v_cvt_pk_bf16_f32 v63, v182, v183
  s_cmp_lg_u32 s19, 0
  s_cbranch_scc1 attn_nodma0_1
  s_add_u32 s17, s17, 16384
  s_add_u32 m0, s18, 65536
  s_nop 0
  buffer_load_dwordx4 v2, s[8:11], s17 offen lds
  buffer_load_dwordx4 v2, s[8:11], s17 offen offset:1024 lds
attn_nodma0_1:
  s_waitcnt lgkmcnt(2)
  v_mfma_f32_32x32x16_bf16 v[136:151], v[8:11], v[32:35], v[104:119]
  v_exp_f32 v152, v152
  v_exp_f32 v153, v153
  v_exp_f32 v154, v154
  v_exp_f32 v155, v155
  v_exp_f32 v156, v156
  v_mfma_f32_32x32x16_bf16 v[168:183], v[8:11], v[36:39], v[120:135]
  ds_read_b128 v[12:15], v2 offset:6144
  s_mov_b64 exec, s[24:25]
  ds_read_b128 v[24:27], v2 offset:3072
  ds_read_b128 v[28:31], v2 offset:3328
  s_mov_b64 exec, -1
  v_exp_f32 v157, v157
  v_exp_f32 v158, v158
  v_exp_f32 v159, v159
  v_exp_f32 v160, v160
  v_exp_f32 v161, v161
  v_exp_f32 v162, v162
  s_waitcnt lgkmcnt(3)
  v_mfma_f32_32x32x16_bf16 v[72:87], v[16:19], v[40:43], v[72:87]
  v_exp_f32 v163, v163
  v_exp_f32 v164, v164
  v_exp_f32 v165, v165
  v_exp_f32 v166, v166
  v_exp_f32 v167, v167
  v_cvt_pk_bf16_f32 v48, v152, v153
  v_mfma_f32_32x32x16_bf16 v[72:87], v[20:23], v[44:47], v[72:87]
  v_cvt_pk_bf16_f32 v49, v154, v155
  v_cvt_pk_bf16_f32 v50, v156, v157
  v_cvt_pk_bf16_f32 v51, v158, v159
  v_cvt_pk_bf16_f32 v52, v160, v161
  v_cvt_pk_bf16_f32 v53, v162, v163
  v_cvt_pk_bf16_f32 v54, v164, v165
  v_cvt_pk_bf16_f32 v55, v166, v167
  v_exp_f32 v184, v184
  v_exp_f32 v185, v185
  v_exp_f32 v186, v186
  v_mfma_f32_32x32x16_bf16 v[88:103], v[16:19], v[56:59], v[88:103]
  v_exp_f32 v187, v187
  v_exp_f32 v188, v188
  v_exp_f32 v189, v189
  v_exp_f32 v190, v190
  v_exp_f32 v191, v191
  v_exp_f32 v192, v192
  v_mfma_f32_32x32x16_bf16 v[88:103], v[20:23], v[60:63], v[88:103]
  v_exp_f32 v193, v193
  v_exp_f32 v194, v194
  v_exp_f32 v195, v195
  v_exp_f32 v196, v196
  v_exp_f32 v197, v197
  v_exp_f32 v198, v198
  v_exp_f32 v199, v199
  v_cvt_pk_bf16_f32 v64, v184, v185
  v_cvt_pk_bf16_f32 v65, v186, v187
  v_cvt_pk_bf16_f32 v66, v188, v189
  v_cvt_pk_bf16_f32 v67, v190, v191
  v_cvt_pk_bf16_f32 v68, v192, v193
  v_cvt_pk_bf16_f32 v69, v194, v195
  v_cvt_pk_bf16_f32 v70, v196, v197
  v_cvt_pk_bf16_f32 v71, v198, v199
  s_cmp_lg_u32 s19, 0
  s_cbranch_scc1 attn_nodma0_2
  s_add_u32 s17, s17, 16384
  s_add_u32 m0, s18, 81920
  s_nop 0
  buffer_load_dwordx4 v2, s[8:11], s17 offen lds
  buffer_load_dwordx4 v2, s[8:11], s17 offen offset:1024 lds
attn_nodma0_2:
  s_waitcnt lgkmcnt(2)
  v_mfma_f32_32x32x16_bf16 v[152:167], v[12:15], v[32:35], v[104:119]
  v_exp_f32 v136, v136
  v_exp_f32 v137, v137
  v_exp_f32 v138, v138
  v_exp_f32 v139, v139
  v_exp_f32 v140, v140
  v_mfma_f32_32x32x16_bf16 v[184:199], v[12:15], v[36:39], v[120:135]
  ds_read_b128 v[8:11], v2 offset:8192
  s_mov_b64 exec, s[24:25]
  ds_read_b128 v[16:19], v2 offset:5120
  ds_read_b128 v[20:23], v2 offset:5376
  s_mov_b64 exec, -1
  v_exp_f32 v141, v141
  v_exp_f32 v142, v142
  v_exp_f32 v143, v143
  v_exp_f32 v144, v144
  v_exp_f32 v145, v145
  v_exp_f32 v146, v146
  s_waitcnt lgkmcnt(3)
  v_mfma_f32_32x32x16_bf16 v[72:87], v[24:27], v[48:51], v[72:87]
  v_exp_f32 v147, v147
  v_exp_f32 v148, v148
  v_exp_f32 v149, v149
  v_exp_f32 v150, v150
  v_exp_f32 v151, v151
  v_cvt_pk_bf16_f32 v40, v136, v137
  v_mfma_f32_32x32x16_bf16 v[72:87], v[28:31], v[52:55], v[72:87]
  v_cvt_pk_bf16_f32 v41, v138, v139
  v_cvt_pk_bf16_f32 v42, v140, v141
  v_cvt_pk_bf16_f32 v43, v142, v143
  v_cvt_pk_bf16_f32 v44, v144, v145
  v_cvt_pk_bf16_f32 v45, v146, v147
  v_cvt_pk_bf16_f32 v46, v148, v149
  v_cvt_pk_bf16_f32 v47, v150, v151
  v_exp_f32 v168, v168
  v_exp_f32 v169, v169
  v_exp_f32 v170, v170
  v_mfma_f32_32x32x16_bf16 v[88:103], v[24:27], v[64:67], v[88:103]
  v_exp_f32 v171, v171
  v_exp_f32 v172, v172
  v_exp_f32 v173, v173
  v_exp_f32 v174, v174
  v_exp_f32 v175, v175
  v_exp_f32 v176, v176
  v_mfma_f32_32x32x16_bf16 v[88:103], v[28:31], v[68:71], v[88:103]
  v_exp_f32 v177, v177
  v_exp_f32 v178, v178
  v_exp_f32 v179, v179
  v_exp_f32 v180, v180
  v_exp_f32 v181, v181
  v_exp_f32 v182, v182
  v_exp_f32 v183, v183
  v_cvt_pk_bf16_f32 v56, v168, v169
  v_cvt_pk_bf16_f32 v57, v170, v171
  v_cvt_pk_bf16_f32 v58, v172, v173
  v_cvt_pk_bf16_f32 v59, v174, v175
  v_cvt_pk_bf16_f32 v60, v176, v177
  v_cvt_pk_bf16_f32 v61, v178, v179
  v_cvt_pk_bf16_f32 v62, v180, v181
  v_cvt_pk_bf16_f32 v63, v182, v183
  s_cmp_lg_u32 s19, 0
  s_cbranch_scc1 attn_nodma0_3
  s_add_u32 s17, s17, 16384
  s_add_u32 m0, s18, 98304
  s_nop 0
  buffer_load_dwordx4 v2, s[8:11], s17 offen lds
  buffer_load_dwordx4 v2, s[8:11], s17 offen offset:1024 lds
attn_nodma0_3:
  s_waitcnt lgkmcnt(2)
  v_mfma_f32_32x32x16_bf16 v[136:151], v[8:11], v[32:35], v[104:119]
  v_exp_f32 v152, v152
  v_exp_f32 v153, v153
  v_exp_f32 v154, v154
  v_exp_f32 v155, v155
  v_exp_f32 v156, v156
  v_mfma_f32_32x32x16_bf16 v[168:183], v[8:11], v[36:39], v[120:135]
  ds_read_b128 v[12:15], v2 offset:10240
  s_mov_b64 exec, s[24:25]
  ds_read_b128 v[24:27], v2 offset:7168
  ds_read_b128 v[28:31], v2 offset:7424
  s_mov_b64 exec, -1
  v_exp_f32 v157, v157
  v_exp_f32 v158, v158
  v_exp_f32 v159, v159
  v_exp_f32 v160, v160
  v_exp_f32 v161, v161
  v_exp_f32 v162, v162
  s_waitcnt lgkmcnt(3)
  v_mfma_f32_32x32x16_bf16 v[72:87], v[16:19], v[40:43], v[72:87]
  v_exp_f32 v163, v163
  v_exp_f32 v164, v164
  v_exp_f32 v165, v165
  v_exp_f32 v166, v166
  v_exp_f32 v167, v167
  v_cvt_pk_bf16_f32 v48, v152, v153
  v_mfma_f32_32x32x16_bf16 v[72:87], v[20:23], v[44:47], v[72:87]
  v_cvt_pk_bf16_f32 v49, v154, v155
  v_cvt_pk_bf16_f32 v50, v156, v157
  v_cvt_pk_bf16_f32 v51, v158, v159
  v_cvt_pk_bf16_f32 v52, v160, v161
  v_cvt_pk_bf16_f32 v53, v162, v163
  v_cvt_pk_bf16_f32 v54, v164, v165
  v_cvt_pk_bf16_f32 v55, v166, v167
  v_exp_f32 v184, v184
  v_exp_f32 v185, v185
  v_exp_f32 v186, v186
  v_mfma_f32_32x32x16_bf16 v[88:103], v[16:19], v[56:59], v[88:103]
  v_exp_f32 v187, v187
  v_exp_f32 v188, v188
  v_exp_f32 v189, v189
  v_exp_f32 v190, v190
  v_exp_f32 v191, v191
  v_exp_f32 v192, v192
  v_mfma_f32_32x32x16_bf16 v[88:103], v[20:23], v[60:63], v[88:103]
  v_exp_f32 v193, v193
  v_exp_f32 v194, v194
  v_exp_f32 v195, v195
  v_exp_f32 v196, v196
  v_exp_f32 v197, v197
  v_exp_f32 v198, v198
  v_exp_f32 v199, v199
  v_cvt_pk_bf16_f32 v64, v184, v185
  v_cvt_pk_bf16_f32 v65, v186, v187
  v_cvt_pk_bf16_f32 v66, v188, v189
  v_cvt_pk_bf16_f32 v67, v190, v191
  v_cvt_pk_bf16_f32 v68, v192, v193
  v_cvt_pk_bf16_f32 v69, v194, v195
  v_cvt_pk_bf16_f32 v70, v196, v197
  v_cvt_pk_bf16_f32 v71, v198, v199
  s_cmp_lg_u32 s19, 0
  s_cbranch_scc1 attn_nodma0_4
  s_add_u32 s17, s17, 16384
  s_add_u32 m0, s18, 114688
  s_nop 0
  buffer_load_dwordx4 v2, s[8:11], s17 offen lds
  buffer_load_dwordx4 v2, s[8:11], s17 offen offset:1024 lds
attn_nodma0_4:
  s_waitcnt lgkmcnt(2)
  v_mfma_f32_32x32x16_bf16 v[152:167], v[12:15], v[32:35], v[104:119]
  v_exp_f32 v136, v136
  v_exp_f32 v137, v137
  v_exp_f32 v138, v138
  v_exp_f32 v139, v139
  v_exp_f32 v140, v140
  v_mfma_f32_32x32x16_bf16 v[184:199], v[12:15], v[36:39], v[120:135]
  ds_read_b128 v[8:11], v2 offset:12288
  s_mov_b64 exec, s[24:25]
  ds_read_b128 v[16:19], v2 offset:9216
  ds_read_b128 v[20:23], v2 offset:9472
  s_mov_b64 exec, -1
  v_exp_f32 v141, v141
  v_exp_f32 v142, v142
  v_exp_f32 v143, v143
  v_exp_f32 v144, v144
  v_exp_f32 v145, v145
  v_exp_f32 v146, v146
  s_waitcnt lgkmcnt(3)
  v_mfma_f32_32x32x16_bf16 v[72:87], v[24:27], v[48:51], v[72:87]
  v_exp_f32 v147, v147
  v_exp_f32 v148, v148
  v_exp_f32 v149, v149
  v_exp_f32 v150, v150
  v_exp_f32 v151, v151
  v_cvt_pk_bf16_f32 v40, v136, v137
  v_mfma_f32_32x32x16_bf16 v[72:87], v[28:31], v[52:55], v[72:87]
  v_cvt_pk_bf16_f32 v41, v138, v139
  v_cvt_pk_bf16_f32 v42, v140, v141
  v_cvt_pk_bf16_f32 v43, v142, v143
  v_cvt_pk_bf16_f32 v44, v144, v145
  v_cvt_pk_bf16_f32 v45, v146, v147
  v_cvt_pk_bf16_f32 v46, v148, v149
  v_cvt_pk_bf16_f32 v47, v150, v151
  v_exp_f32 v168, v168
  v_exp_f32 v169, v169
  v_exp_f32 v170, v170
  v_mfma_f32_32x32x16_bf16 v[88:103], v[24:27], v[64:67], v[88:103]
  v_exp_f32 v171, v171
  v_exp_f32 v172, v172
  v_exp_f32 v173, v173
  v_exp_f32 v174, v174
  v_exp_f32 v175, v175
  v_exp_f32 v176, v176
  v_mfma_f32_32x32x16_bf16 v[88:103], v[28:31], v[68:71], v[88:103]
  v_exp_f32 v177, v177
  v_exp_f32 v178, v178
  v_exp_f32 v179, v179
  v_exp_f32 v180, v180
  v_exp_f32 v181, v181
  v_exp_f32 v182, v182
  v_exp_f32 v183, v183
  v_cvt_pk_bf16_f32 v56, v168, v169
  v_cvt_pk_bf16_f32 v57, v170, v171
  v_cvt_pk_bf16_f32 v58, v172, v173
  v_cvt_pk_bf16_f32 v59, v174, v175
  v_cvt_pk_bf16_f32 v60, v176, v177
  v_cvt_pk_bf16_f32 v61, v178, v179
  v_cvt_pk_bf16_f32 v62, v180, v181
  v_cvt_pk_bf16_f32 v63, v182, v183
  s_cmp_lg_u32 s19, 0
  s_cbranch_scc1 attn_nobarA0
  s_waitcnt vmcnt(10)
  s_barrier
attn_nobarA0:
  s_waitcnt lgkmcnt(2)
  v_mfma_f32_32x32x16_bf16 v[136:151], v[8:11], v[32:35], v[104:119]
  v_exp_f32 v152, v152
  v_exp_f32 v153, v153
  v_exp_f32 v154, v154
  v_exp_f32 v155, v155
  v_exp_f32 v156, v156
  v_mfma_f32_32x32x16_bf16 v[168:183], v[8:11], v[36:39], v[120:135]
  ds_read_b128 v[12:15], v2 offset:14336
  s_mov_b64 exec, s[24:25]
  ds_read_b128 v[24:27], v2 offset:11264
  ds_read_b128 v[28:31], v2 offset:11520
  s_mov_b64 exec, -1
  v_exp_f32 v157, v157
  v_exp_f32 v158, v158
  v_exp_f32 v159, v159
  v_exp_f32 v160, v160
  v_exp_f32 v161, v161
  v_exp_f32 v162, v162
  s_waitcnt lgkmcnt(3)
  v_mfma_f32_32x32x16_bf16 v[72:87], v[16:19], v[40:43], v[72:87]
  v_exp_f32 v163, v163
  v_exp_f32 v164, v164
  v_exp_f32 v165, v165
  v_exp_f32 v166, v166
  v_exp_f32 v167, v167
  v_cvt_pk_bf16_f32 v48, v152, v153
  v_mfma_f32_32x32x16_bf16 v[72:87], v[20:23], v[44:47], v[72:87]
  v_cvt_pk_bf16_f32 v49, v154, v155
  v_cvt_pk_bf16_f32 v50, v156, v157
  v_cvt_pk_bf16_f32 v51, v158, v159
  v_cvt_pk_bf16_f32 v52, v160, v161
  v_cvt_pk_bf16_f32 v53, v162, v163
  v_cvt_pk_bf16_f32 v54, v164, v165
  v_cvt_pk_bf16_f32 v55, v166, v167
  v_exp_f32 v184, v184
  v_exp_f32 v185, v185
  v_exp_f32 v186, v186
  v_mfma_f32_32x32x16_bf16 v[88:103], v[16:19], v[56:59], v[88:103]
  v_exp_f32 v187, v187
  v_exp_f32 v188, v188
  v_exp_f32 v189, v189
  v_exp_f32 v190, v190
  v_exp_f32 v191, v191
  v_exp_f32 v192, v192
  v_mfma_f32_32x32x16_bf16 v[88:103], v[20:23], v[60:63], v[88:103]
  v_exp_f32 v193, v193
  v_exp_f32 v194, v194
  v_exp_f32 v195, v195
  v_exp_f32 v196, v196
  v_exp_f32 v197, v197
  v_exp_f32 v198, v198
  v_exp_f32 v199, v199
  v_cvt_pk_bf16_f32 v64, v184, v185
  v_cvt_pk_bf16_f32 v65, v186, v187
  v_cvt_pk_bf16_f32 v66, v188, v189
  v_cvt_pk_bf16_f32 v67, v190, v191
  v_cvt_pk_bf16_f32 v68, v192, v193
  v_cvt_pk_bf16_f32 v69, v194, v195
  v_cvt_pk_bf16_f32 v70, v196, v197
  v_cvt_pk_bf16_f32 v71, v198, v199
  s_cmp_lg_u32 s19, 1
  s_cbranch_scc1 attn_nobar0
  s_waitcnt vmcnt(0)
  s_barrier
  v_lshlrev_b32 v4, 4, v1
  s_and_b32 s17, s2, 0xf8
  s_add_u32 s17, s17, s12
  s_cmp_lt_u32 s17, 128
  s_cselect_b32 s30, s56, s58
  s_cselect_b32 s31, s57, s59
  s_mov_b32 s60, s30
  s_and_b32 s61, s31, 0xffff
  s_mov_b32 s62, 524288
  s_mov_b32 s63, 0x00020000
  s_and_b32 s17, s17, 127
  s_lshl_b32 s17, s17, 12
  buffer_load_dwordx4 v[200:203], v4, s[60:63], s17 offen offset:0
  buffer_load_dwordx4 v[200:203], v4, s[60:63], s17 offen offset:1024
  buffer_load_dwordx4 v[200:203], v4, s[60:63], s17 offen offset:2048
  buffer_load_dwordx4 v[200:203], v4, s[60:63], s17 offen offset:3072
  s_lshl_b32 s23, s2, 3
  s_lshl_b32 s17, s12, 1
  s_add_u32 s23, s23, s17
  s_lshl_b32 s17, s23, 10
  buffer_load_dwordx4 v[204:207], v4, s[48:51], s17 offen
  buffer_load_dwordx4 v[208:211], v4, s[48:51], s17 offen offset:1024
  buffer_load_dwordx4 v[212:215], v4, s[52:55], 0 offen
attn_nobar0:
  s_waitcnt lgkmcnt(2)
  v_mfma_f32_32x32x16_bf16 v[152:167], v[12:15], v[32:35], v[104:119]
  v_exp_f32 v136, v136
  v_exp_f32 v137, v137
  v_exp_f32 v138, v138
  v_exp_f32 v139, v139
  v_exp_f32 v140, v140
  v_mfma_f32_32x32x16_bf16 v[184:199], v[12:15], v[36:39], v[120:135]
  ds_read_b128 v[8:11], v2 offset:16384
  s_mov_b64 exec, s[24:25]
  ds_read_b128 v[16:19], v2 offset:13312
  ds_read_b128 v[20:23], v2 offset:13568
  s_mov_b64 exec, -1
  v_exp_f32 v141, v141
  v_exp_f32 v142, v142
  v_exp_f32 v143, v143
  v_exp_f32 v144, v144
  v_exp_f32 v145, v145
  v_exp_f32 v146, v146
  s_waitcnt lgkmcnt(3)
  v_mfma_f32_32x32x16_bf16 v[72:87], v[24:27], v[48:51], v[72:87]
  v_exp_f32 v147, v147
  v_exp_f32 v148, v148
  v_exp_f32 v149, v149
  v_exp_f32 v150, v150
  v_exp_f32 v151, v151
  v_cvt_pk_bf16_f32 v40, v136, v137
  v_mfma_f32_32x32x16_bf16 v[72:87], v[28:31], v[52:55], v[72:87]
  v_cvt_pk_bf16_f32 v41, v138, v139
  v_cvt_pk_bf16_f32 v42, v140, v141
  v_cvt_pk_bf16_f32 v43, v142, v143
  v_cvt_pk_bf16_f32 v44, v144, v145
  v_cvt_pk_bf16_f32 v45, v146, v147
  v_cvt_pk_bf16_f32 v46, v148, v149
  v_cvt_pk_bf16_f32 v47, v150, v151
  v_exp_f32 v168, v168
  v_exp_f32 v169, v169
  v_exp_f32 v170, v170
  v_mfma_f32_32x32x16_bf16 v[88:103], v[24:27], v[64:67], v[88:103]
  v_exp_f32 v171, v171
  v_exp_f32 v172, v172
  v_exp_f32 v173, v173
  v_exp_f32 v174, v174
  v_exp_f32 v175, v175
  v_exp_f32 v176, v176
  v_mfma_f32_32x32x16_bf16 v[88:103], v[28:31], v[68:71], v[88:103]
  v_exp_f32 v177, v177
  v_exp_f32 v178, v178
  v_exp_f32 v179, v179
  v_exp_f32 v180, v180
  v_exp_f32 v181, v181
  v_exp_f32 v182, v182
  v_exp_f32 v183, v183
  v_cvt_pk_bf16_f32 v56, v168, v169
  v_cvt_pk_bf16_f32 v57, v170, v171
  v_cvt_pk_bf16_f32 v58, v172, v173
  v_cvt_pk_bf16_f32 v59, v174, v175
  v_cvt_pk_bf16_f32 v60, v176, v177
  v_cvt_pk_bf16_f32 v61, v178, v179
  v_cvt_pk_bf16_f32 v62, v180, v181
  v_cvt_pk_bf16_f32 v63, v182, v183
  s_waitcnt lgkmcnt(2)
  v_mfma_f32_32x32x16_bf16 v[136:151], v[8:11], v[32:35], v[104:119]
  v_exp_f32 v152, v152
  v_exp_f32 v153, v153
  v_exp_f32 v154, v154
  v_exp_f32 v155, v155
  v_exp_f32 v156, v156
  v_mfma_f32_32x32x16_bf16 v[168:183], v[8:11], v[36:39], v[120:135]
  s_add_u32 s46, s19, 1
  v_mov_b32 v219, s46
  ds_write_b32 v216, v219
  ds_read_b32 v218, v217
  ds_read_b128 v[12:15], v2 offset:18432
  s_mov_b64 exec, s[24:25]
  ds_read_b128 v[24:27], v2 offset:15360
  ds_read_b128 v[28:31], v2 offset:15616
  s_mov_b64 exec, -1
  v_exp_f32 v157, v157
  v_exp_f32 v158, v158
  v_exp_f32 v159, v159
  v_exp_f32 v160, v160
  v_exp_f32 v161, v161
  v_exp_f32 v162, v162
  s_waitcnt lgkmcnt(3)
  v_mfma_f32_32x32x16_bf16 v[72:87], v[16:19], v[40:43], v[72:87]
  v_exp_f32 v163, v163
  v_exp_f32 v164, v164
  v_exp_f32 v165, v165
  v_exp_f32 v166, v166
  v_exp_f32 v167, v167
  v_cvt_pk_bf16_f32 v48, v152, v153
  v_mfma_f32_32x32x16_bf16 v[72:87], v[20:23], v[44:47], v[72:87]
  v_cvt_pk_bf16_f32 v49, v154, v155
  v_cvt_pk_bf16_f32 v50, v156, v157
  v_cvt_pk_bf16_f32 v51, v158, v159
  v_cvt_pk_bf16_f32 v52, v160, v161
  v_cvt_pk_bf16_f32 v53, v162, v163
  v_cvt_pk_bf16_f32 v54, v164, v165
  v_cvt_pk_bf16_f32 v55, v166, v167
  v_exp_f32 v184, v184
  v_exp_f32 v185, v185
  v_exp_f32 v186, v186
  v_mfma_f32_32x32x16_bf16 v[88:103], v[16:19], v[56:59], v[88:103]
  v_exp_f32 v187, v187
  v_exp_f32 v188, v188
  v_exp_f32 v189, v189
  v_exp_f32 v190, v190
  v_exp_f32 v191, v191
  v_exp_f32 v192, v192
  v_mfma_f32_32x32x16_bf16 v[88:103], v[20:23], v[60:63], v[88:103]
  v_exp_f32 v193, v193
  v_exp_f32 v194, v194
  v_exp_f32 v195, v195
  v_exp_f32 v196, v196
  v_exp_f32 v197, v197
  v_exp_f32 v198, v198
  v_exp_f32 v199, v199
  v_cvt_pk_bf16_f32 v64, v184, v185
  v_cvt_pk_bf16_f32 v65, v186, v187
  v_cvt_pk_bf16_f32 v66, v188, v189
  v_cvt_pk_bf16_f32 v67, v190, v191
  v_cvt_pk_bf16_f32 v68, v192, v193
  v_cvt_pk_bf16_f32 v69, v194, v195
  v_cvt_pk_bf16_f32 v70, v196, v197
  v_cvt_pk_bf16_f32 v71, v198, v199
  v_cmp_ngt_f32 vcc, s20, v80
  v_cmp_ngt_f32 s[26:27], s20, v96
  v_add_u32 v2, 16384, v2
  s_add_u32 s19, s19, 1
  s_or_b64 vcc, vcc, s[26:27]
  s_cbranch_vccnz attn_rare0
attn_rare_ret0:
  s_cmp_lt_u32 s19, 8
  s_cbranch_scc1 attn_loop0
  s_branch attn_tail
.p2align 6
attn_loop1:
  s_cmp_lg_u32 s19, 0
  s_cbranch_scc1 attn_nodma1_0
  s_add_u32 s17, s17, 16384
  s_add_u32 m0, s18, 49152
  s_nop 0
  buffer_load_dwordx4 v2, s[8:11], s17 offen lds
  buffer_load_dwordx4 v2, s[8:11], s17 offen offset:1024 lds
attn_nodma1_0:
  s_waitcnt lgkmcnt(2)
  v_readfirstlane_b32 s46, v218
  s_cmp_eq_u32 s19, s46
  s_cbranch_scc1 attn_ptie1
  s_cmp_gt_u32 s19, s46
  s_cbranch_scc1 attn_plow1
  s_setprio 2
  s_branch attn_pdone1
attn_plow1:
  s_setprio 0
  s_branch attn_pdone1
attn_ptie1:
  s_setprio 1
attn_pdone1:
  v_mfma_f32_32x32x16_bf16 v[152:167], v[12:15], v[32:35], v[104:119]
  v_exp_f32 v136, v136
  v_exp_f32 v137, v137
  v_exp_f32 v138, v138
  v_exp_f32 v139, v139
  v_exp_f32 v140, v140
  v_mfma_f32_32x32x16_bf16 v[184:199], v[12:15], v[36:39], v[120:135]
  ds_read_b128 v[8:11], v2 offset:4096
  s_mov_b64 exec, s[24:25]
  ds_read_b128 v[16:19], v2 offset:1024
  ds_read_b128 v[20:23], v2 offset:1280
  s_mov_b64 exec, -1
  v_exp_f32 v141, v141
  v_exp_f32 v142, v142
  v_exp_f32 v143, v143
  v_exp_f32 v144, v144
  v_exp_f32 v145, v145
  v_exp_f32 v146, v146
  s_waitcnt lgkmcnt(3)
  v_mfma_f32_32x32x16_bf16 v[72:87], v[24:27], v[48:51], v[72:87]
  v_exp_f32 v147, v147
  v_exp_f32 v148, v148
  v_exp_f32 v149, v149
  v_exp_f32 v150, v150
  v_exp_f32 v151, v151
  v_cvt_pk_bf16_f32 v40, v136, v137
  v_mfma_f32_32x32x16_bf16 v[72:87], v[28:31], v[52:55], v[72:87]
  v_cvt_pk_bf16_f32 v41, v138, v139
  v_cvt_pk_bf16_f32 v42, v140, v141
  v_cvt_pk_bf16_f32 v43, v142, v143
  v_cvt_pk_bf16_f32 v44, v144, v145
  v_cvt_pk_bf16_f32 v45, v146, v147
  v_cvt_pk_bf16_f32 v46, v148, v149
  v_cvt_pk_bf16_f32 v47, v150, v151
  v_exp_f32 v168, v168
  v_exp_f32 v169, v169
  v_exp_f32 v170, v170
  v_mfma_f32_32x32x16_bf16 v[88:103], v[24:27], v[64:67], v[88:103]
  v_exp_f32 v171, v171
  v_exp_f32 v172, v172
  v_exp_f32 v173, v173
  v_exp_f32 v174, v174
  v_exp_f32 v175, v175
  v_exp_f32 v176, v176
  v_mfma_f32_32x32x16_bf16 v[88:103], v[28:31], v[68:71], v[88:103]
  v_exp_f32 v177, v177
  v_exp_f32 v178, v178
  v_exp_f32 v179, v179
  v_exp_f32 v180, v180
  v_exp_f32 v181, v181
  v_exp_f32 v182, v182
  v_exp_f32 v183, v183
  v_cvt_pk_bf16_f32 v56, v168, v169
  v_cvt_pk_bf16_f32 v57, v170, v171
  v_cvt_pk_bf16_f32 v58, v172, v173
  v_cvt_pk_bf16_f32 v59, v174, v175
  v_cvt_pk_bf16_f32 v60, v176, v177
  v_cvt_pk_bf16_f32 v61, v178, v179
  v_cvt_pk_bf16_f32 v62, v180, v181
  v_cvt_pk_bf16_f32 v63, v182, v183
  s_cmp_lg_u32 s19, 0
  s_cbranch_scc1 attn_nodma1_1
  s_add_u32 s17, s17, 16384
  s_add_u32 m0, s18, 65536
  s_nop 0
  buffer_load_dwordx4 v2, s[8:11], s17 offen lds
  buffer_load_dwordx4 v2, s[8:11], s17 offen offset:1024 lds
attn_nodma1_1:
  s_waitcnt lgkmcnt(2)
  v_mfma_f32_32x32x16_bf16 v[136:151], v[8:11], v[32:35], v[104:119]
  v_exp_f32 v152, v152
  v_exp_f32 v153, v153
  v_exp_f32 v154, v154
  v_exp_f32 v155, v155
  v_exp_f32 v156, v156
  v_mfma_f32_32x32x16_bf16 v[168:183], v[8:11], v[36:39], v[120:135]
  ds_read_b128 v[12:15], v2 offset:6144
  s_mov_b64 exec, s[24:25]
  ds_read_b128 v[24:27], v2 offset:3072
  ds_read_b128 v[28:31], v2 offset:3328
  s_mov_b64 exec, -1
  v_exp_f32 v157, v157
  v_exp_f32 v158, v158
  v_exp_f32 v159, v159
  v_exp_f32 v160, v160
  v_exp_f32 v161, v161
  v_exp_f32 v162, v162
  s_waitcnt lgkmcnt(3)
  v_mfma_f32_32x32x16_bf16 v[72:87], v[16:19], v[40:43], v[72:87]
  v_exp_f32 v163, v163
  v_exp_f32 v164, v164
  v_exp_f32 v165, v165
  v_exp_f32 v166, v166
  v_exp_f32 v167, v167
  v_cvt_pk_bf16_f32 v48, v152, v153
  v_mfma_f32_32x32x16_bf16 v[72:87], v[20:23], v[44:47], v[72:87]
  v_cvt_pk_bf16_f32 v49, v154, v155
  v_cvt_pk_bf16_f32 v50, v156, v157
  v_cvt_pk_bf16_f32 v51, v158, v159
  v_cvt_pk_bf16_f32 v52, v160, v161
  v_cvt_pk_bf16_f32 v53, v162, v163
  v_cvt_pk_bf16_f32 v54, v164, v165
  v_cvt_pk_bf16_f32 v55, v166, v167
  v_exp_f32 v184, v184
  v_exp_f32 v185, v185
  v_exp_f32 v186, v186
  v_mfma_f32_32x32x16_bf16 v[88:103], v[16:19], v[56:59], v[88:103]
  v_exp_f32 v187, v187
  v_exp_f32 v188, v188
  v_exp_f32 v189, v189
  v_exp_f32 v190, v190
  v_exp_f32 v191, v191
  v_exp_f32 v192, v192
  v_mfma_f32_32x32x16_bf16 v[88:103], v[20:23], v[60:63], v[88:103]
  v_exp_f32 v193, v193
  v_exp_f32 v194, v194
  v_exp_f32 v195, v195
  v_exp_f32 v196, v196
  v_exp_f32 v197, v197
  v_exp_f32 v198, v198
  v_exp_f32 v199, v199
  v_cvt_pk_bf16_f32 v64, v184, v185
  v_cvt_pk_bf16_f32 v65, v186, v187
  v_cvt_pk_bf16_f32 v66, v188, v189
  v_cvt_pk_bf16_f32 v67, v190, v191
  v_cvt_pk_bf16_f32 v68, v192, v193
  v_cvt_pk_bf16_f32 v69, v194, v195
  v_cvt_pk_bf16_f32 v70, v196, v197
  v_cvt_pk_bf16_f32 v71, v198, v199
  s_cmp_lg_u32 s19, 0
  s_cbranch_scc1 attn_nodma1_2
  s_add_u32 s17, s17, 16384
  s_add_u32 m0, s18, 81920
  s_nop 0
  buffer_load_dwordx4 v2, s[8:11], s17 offen lds
  buffer_load_dwordx4 v2, s[8:11], s17 offen offset:1024 lds
attn_nodma1_2:
  s_waitcnt lgkmcnt(2)
  v_mfma_f32_32x32x16_bf16 v[152:167], v[12:15], v[32:35], v[104:119]
  v_exp_f32 v136, v136
  v_exp_f32 v137, v137
  v_exp_f32 v138, v138
  v_exp_f32 v139, v139
  v_exp_f32 v140, v140
  v_mfma_f32_32x32x16_bf16 v[184:199], v[12:15], v[36:39], v[120:135]
  ds_read_b128 v[8:11], v2 offset:8192
  s_mov_b64 exec, s[24:25]
  ds_read_b128 v[16:19], v2 offset:5120
  ds_read_b128 v[20:23], v2 offset:5376
  s_mov_b64 exec, -1
  v_exp_f32 v141, v141
  v_exp_f32 v142, v142
  v_exp_f32 v143, v143
  v_exp_f32 v144, v144
  v_exp_f32 v145, v145
  v_exp_f32 v146, v146
  s_waitcnt lgkmcnt(3)
  v_mfma_f32_32x32x16_bf16 v[72:87], v[24:27], v[48:51], v[72:87]
  v_exp_f32 v147, v147
  v_exp_f32 v148, v148
  v_exp_f32 v149, v149
  v_exp_f32 v150, v150
  v_exp_f32 v151, v151
  v_cvt_pk_bf16_f32 v40, v136, v137
  v_mfma_f32_32x32x16_bf16 v[72:87], v[28:31], v[52:55], v[72:87]
  v_cvt_pk_bf16_f32 v41, v138, v139
  v_cvt_pk_bf16_f32 v42, v140, v141
  v_cvt_pk_bf16_f32 v43, v142, v143
  v_cvt_pk_bf16_f32 v44, v144, v145
  v_cvt_pk_bf16_f32 v45, v146, v147
  v_cvt_pk_bf16_f32 v46, v148, v149
  v_cvt_pk_bf16_f32 v47, v150, v151
  v_exp_f32 v168, v168
  v_exp_f32 v169, v169
  v_exp_f32 v170, v170
  v_mfma_f32_32x32x16_bf16 v[88:103], v[24:27], v[64:67], v[88:103]
  v_exp_f32 v171, v171
  v_exp_f32 v172, v172
  v_exp_f32 v173, v173
  v_exp_f32 v174, v174
  v_exp_f32 v175, v175
  v_exp_f32 v176, v176
  v_mfma_f32_32x32x16_bf16 v[88:103], v[28:31], v[68:71], v[88:103]
  v_exp_f32 v177, v177
  v_exp_f32 v178, v178
  v_exp_f32 v179, v179
  v_exp_f32 v180, v180
  v_exp_f32 v181, v181
  v_exp_f32 v182, v182
  v_exp_f32 v183, v183
  v_cvt_pk_bf16_f32 v56, v168, v169
  v_cvt_pk_bf16_f32 v57, v170, v171
  v_cvt_pk_bf16_f32 v58, v172, v173
  v_cvt_pk_bf16_f32 v59, v174, v175
  v_cvt_pk_bf16_f32 v60, v176, v177
  v_cvt_pk_bf16_f32 v61, v178, v179
  v_cvt_pk_bf16_f32 v62, v180, v181
  v_cvt_pk_bf16_f32 v63, v182, v183
  s_cmp_lg_u32 s19, 0
  s_cbranch_scc1 attn_nodma1_3
  s_add_u32 s17, s17, 16384
  s_add_u32 m0, s18, 98304
  s_nop 0
  buffer_load_dwordx4 v2, s[8:11], s17 offen lds
  buffer_load_dwordx4 v2, s[8:11], s17 offen offset:1024 lds
attn_nodma1_3:
  s_waitcnt lgkmcnt(2)
  v_mfma_f32_32x32x16_bf16 v[136:151], v[8:11], v[32:35], v[104:119]
  v_exp_f32 v152, v152
  v_exp_f32 v153, v153
  v_exp_f32 v154, v154
  v_exp_f32 v155, v155
  v_exp_f32 v156, v156
  v_mfma_f32_32x32x16_bf16 v[168:183], v[8:11], v[36:39], v[120:135]
  ds_read_b128 v[12:15], v2 offset:10240
  s_mov_b64 exec, s[24:25]
  ds_read_b128 v[24:27], v2 offset:7168
  ds_read_b128 v[28:31], v2 offset:7424
  s_mov_b64 exec, -1
  v_exp_f32 v157, v157
  v_exp_f32 v158, v158
  v_exp_f32 v159, v159
  v_exp_f32 v160, v160
  v_exp_f32 v161, v161
  v_exp_f32 v162, v162
  s_waitcnt lgkmcnt(3)
  v_mfma_f32_32x32x16_bf16 v[72:87], v[16:19], v[40:43], v[72:87]
  v_exp_f32 v163, v163
  v_exp_f32 v164, v164
  v_exp_f32 v165, v165
  v_exp_f32 v166, v166
  v_exp_f32 v167, v167
  v_cvt_pk_bf16_f32 v48, v152, v153
  v_mfma_f32_32x32x16_bf16 v[72:87], v[20:23], v[44:47], v[72:87]
  v_cvt_pk_bf16_f32 v49, v154, v155
  v_cvt_pk_bf16_f32 v50, v156, v157
  v_cvt_pk_bf16_f32 v51, v158, v159
  v_cvt_pk_bf16_f32 v52, v160, v161
  v_cvt_pk_bf16_f32 v53, v162, v163
  v_cvt_pk_bf16_f32 v54, v164, v165
  v_cvt_pk_bf16_f32 v55, v166, v167
  v_exp_f32 v184, v184
  v_exp_f32 v185, v185
  v_exp_f32 v186, v186
  v_mfma_f32_32x32x16_bf16 v[88:103], v[16:19], v[56:59], v[88:103]
  v_exp_f32 v187, v187
  v_exp_f32 v188, v188
  v_exp_f32 v189, v189
  v_exp_f32 v190, v190
  v_exp_f32 v191, v191
  v_exp_f32 v192, v192
  v_mfma_f32_32x32x16_bf16 v[88:103], v[20:23], v[60:63], v[88:103]
  v_exp_f32 v193, v193
  v_exp_f32 v194, v194
  v_exp_f32 v195, v195
  v_exp_f32 v196, v196
  v_exp_f32 v197, v197
  v_exp_f32 v198, v198
  v_exp_f32 v199, v199
  v_cvt_pk_bf16_f32 v64, v184, v185
  v_cvt_pk_bf16_f32 v65, v186, v187
  v_cvt_pk_bf16_f32 v66, v188, v189
  v_cvt_pk_bf16_f32 v67, v190, v191
  v_cvt_pk_bf16_f32 v68, v192, v193
  v_cvt_pk_bf16_f32 v69, v194, v195
  v_cvt_pk_bf16_f32 v70, v196, v197
  v_cvt_pk_bf16_f32 v71, v198, v199
  s_cmp_lg_u32 s19, 0
  s_cbranch_scc1 attn_nodma1_4
  s_add_u32 s17, s17, 16384
  s_add_u32 m0, s18, 114688
  s_nop 0
  buffer_load_dwordx4 v2, s[8:11], s17 offen lds
  buffer_load_dwordx4 v2, s[8:11], s17 offen offset:1024 lds
attn_nodma1_4:
  s_waitcnt lgkmcnt(2)
  v_mfma_f32_32x32x16_bf16 v[152:167], v[12:15], v[32:35], v[104:119]
  v_exp_f32 v136, v136
  v_exp_f32 v137, v137
  v_exp_f32 v138, v138
  v_exp_f32 v139, v139
  v_exp_f32 v140, v140
  v_mfma_f32_32x32x16_bf16 v[184:199], v[12:15], v[36:39], v[120:135]
  ds_read_b128 v[8:11], v2 offset:12288
  s_mov_b64 exec, s[24:25]
  ds_read_b128 v[16:19], v2 offset:9216
  ds_read_b128 v[20:23], v2 offset:9472
  s_mov_b64 exec, -1
  v_exp_f32 v141, v141
  v_exp_f32 v142, v142
  v_exp_f32 v143, v143
  v_exp_f32 v144, v144
  v_exp_f32 v145, v145
  v_exp_f32 v146, v146
  s_waitcnt lgkmcnt(3)
  v_mfma_f32_32x32x16_bf16 v[72:87], v[24:27], v[48:51], v[72:87]
  v_exp_f32 v147, v147
  v_exp_f32 v148, v148
  v_exp_f32 v149, v149
  v_exp_f32 v150, v150
  v_exp_f32 v151, v151
  v_cvt_pk_bf16_f32 v40, v136, v137
  v_mfma_f32_32x32x16_bf16 v[72:87], v[28:31], v[52:55], v[72:87]
  v_cvt_pk_bf16_f32 v41, v138, v139
  v_cvt_pk_bf16_f32 v42, v140, v141
  v_cvt_pk_bf16_f32 v43, v142, v143
  v_cvt_pk_bf16_f32 v44, v144, v145
  v_cvt_pk_bf16_f32 v45, v146, v147
  v_cvt_pk_bf16_f32 v46, v148, v149
  v_cvt_pk_bf16_f32 v47, v150, v151
  v_exp_f32 v168, v168
  v_exp_f32 v169, v169
  v_exp_f32 v170, v170
  v_mfma_f32_32x32x16_bf16 v[88:103], v[24:27], v[64:67], v[88:103]
  v_exp_f32 v171, v171
  v_exp_f32 v172, v172
  v_exp_f32 v173, v173
  v_exp_f32 v174, v174
  v_exp_f32 v175, v175
  v_exp_f32 v176, v176
  v_mfma_f32_32x32x16_bf16 v[88:103], v[28:31], v[68:71], v[88:103]
  v_exp_f32 v177, v177
  v_exp_f32 v178, v178
  v_exp_f32 v179, v179
  v_exp_f32 v180, v180
  v_exp_f32 v181, v181
  v_exp_f32 v182, v182
  v_exp_f32 v183, v183
  v_cvt_pk_bf16_f32 v56, v168, v169
  v_cvt_pk_bf16_f32 v57, v170, v171
  v_cvt_pk_bf16_f32 v58, v172, v173
  v_cvt_pk_bf16_f32 v59, v174, v175
  v_cvt_pk_bf16_f32 v60, v176, v177
  v_cvt_pk_bf16_f32 v61, v178, v179
  v_cvt_pk_bf16_f32 v62, v180, v181
  v_cvt_pk_bf16_f32 v63, v182, v183
  s_cmp_lg_u32 s19, 0
  s_cbranch_scc1 attn_nobarA1
  s_waitcnt vmcnt(10)
  s_barrier
attn_nobarA1:
  s_waitcnt lgkmcnt(2)
  v_mfma_f32_32x32x16_bf16 v[136:151], v[8:11], v[32:35], v[104:119]
  v_exp_f32 v152, v152
  v_exp_f32 v153, v153
  v_exp_f32 v154, v154
  v_exp_f32 v155, v155
  v_exp_f32 v156, v156
  v_mfma_f32_32x32x16_bf16 v[168:183], v[8:11], v[36:39], v[120:135]
  ds_read_b128 v[12:15], v2 offset:14336
  s_mov_b64 exec, s[24:25]
  ds_read_b128 v[24:27], v2 offset:11264
  ds_read_b128 v[28:31], v2 offset:11520
  s_mov_b64 exec, -1
  v_exp_f32 v157, v157
  v_exp_f32 v158, v158
  v_exp_f32 v159, v159
  v_exp_f32 v160, v160
  v_exp_f32 v161, v161
  v_exp_f32 v162, v162
  s_waitcnt lgkmcnt(3)
  v_mfma_f32_32x32x16_bf16 v[72:87], v[16:19], v[40:43], v[72:87]
  v_exp_f32 v163, v163
  v_exp_f32 v164, v164
  v_exp_f32 v165, v165
  v_exp_f32 v166, v166
  v_exp_f32 v167, v167
  v_cvt_pk_bf16_f32 v48, v152, v153
  v_mfma_f32_32x32x16_bf16 v[72:87], v[20:23], v[44:47], v[72:87]
  v_cvt_pk_bf16_f32 v49, v154, v155
  v_cvt_pk_bf16_f32 v50, v156, v157
  v_cvt_pk_bf16_f32 v51, v158, v159
  v_cvt_pk_bf16_f32 v52, v160, v161
  v_cvt_pk_bf16_f32 v53, v162, v163
  v_cvt_pk_bf16_f32 v54, v164, v165
  v_cvt_pk_bf16_f32 v55, v166, v167
  v_exp_f32 v184, v184
  v_exp_f32 v185, v185
  v_exp_f32 v186, v186
  v_mfma_f32_32x32x16_bf16 v[88:103], v[16:19], v[56:59], v[88:103]
  v_exp_f32 v187, v187
  v_exp_f32 v188, v188
  v_exp_f32 v189, v189
  v_exp_f32 v190, v190
  v_exp_f32 v191, v191
  v_exp_f32 v192, v192
  v_mfma_f32_32x32x16_bf16 v[88:103], v[20:23], v[60:63], v[88:103]
  v_exp_f32 v193, v193
  v_exp_f32 v194, v194
  v_exp_f32 v195, v195
  v_exp_f32 v196, v196
  v_exp_f32 v197, v197
  v_exp_f32 v198, v198
  v_exp_f32 v199, v199
  v_cvt_pk_bf16_f32 v64, v184, v185
  v_cvt_pk_bf16_f32 v65, v186, v187
  v_cvt_pk_bf16_f32 v66, v188, v189
  v_cvt_pk_bf16_f32 v67, v190, v191
  v_cvt_pk_bf16_f32 v68, v192, v193
  v_cvt_pk_bf16_f32 v69, v194, v195
  v_cvt_pk_bf16_f32 v70, v196, v197
  v_cvt_pk_bf16_f32 v71, v198, v199
  s_cmp_lg_u32 s19, 1
  s_cbranch_scc1 attn_nobar1
  s_waitcnt vmcnt(0)
  s_barrier
  v_lshlrev_b32 v4, 4, v1
  s_and_b32 s17, s2, 0xf8
  s_add_u32 s17, s17, s12
  s_cmp_lt_u32 s17, 128
  s_cselect_b32 s30, s56, s58
  s_cselect_b32 s31, s57, s59
  s_mov_b32 s60, s30
  s_and_b32 s61, s31, 0xffff
  s_mov_b32 s62, 524288
  s_mov_b32 s63, 0x00020000
  s_and_b32 s17, s17, 127
  s_lshl_b32 s17, s17, 12
  buffer_load_dwordx4 v[200:203], v4, s[60:63], s17 offen offset:0
  buffer_load_dwordx4 v[200:203], v4, s[60:63], s17 offen offset:1024
  buffer_load_dwordx4 v[200:203], v4, s[60:63], s17 offen offset:2048
  buffer_load_dwordx4 v[200:203], v4, s[60:63], s17 offen offset:3072
attn_nobar1:
  s_waitcnt lgkmcnt(2)
  v_mfma_f32_32x32x16_bf16 v[152:167], v[12:15], v[32:35], v[104:119]
  v_exp_f32 v136, v136
  v_exp_f32 v137, v137
  v_exp_f32 v138, v138
  v_exp_f32 v139, v139
  v_exp_f32 v140, v140
  v_mfma_f32_32x32x16_bf16 v[184:199], v[12:15], v[36:39], v[120:135]
  ds_read_b128 v[8:11], v2 offset:16384
  s_mov_b64 exec, s[24:25]
  ds_read_b128 v[16:19], v2 offset:13312
  ds_read_b128 v[20:23], v2 offset:13568
  s_mov_b64 exec, -1
  v_exp_f32 v141, v141
  v_exp_f32 v142, v142
  v_exp_f32 v143, v143
  v_exp_f32 v144, v144
  v_exp_f32 v145, v145
  v_exp_f32 v146, v146
  s_waitcnt lgkmcnt(3)
  v_mfma_f32_32x32x16_bf16 v[72:87], v[24:27], v[48:51], v[72:87]
  v_exp_f32 v147, v147
  v_exp_f32 v148, v148
  v_exp_f32 v149, v149
  v_exp_f32 v150, v150
  v_exp_f32 v151, v151
  v_cvt_pk_bf16_f32 v40, v136, v137
  v_mfma_f32_32x32x16_bf16 v[72:87], v[28:31], v[52:55], v[72:87]
  v_cvt_pk_bf16_f32 v41, v138, v139
  v_cvt_pk_bf16_f32 v42, v140, v141
  v_cvt_pk_bf16_f32 v43, v142, v143
  v_cvt_pk_bf16_f32 v44, v144, v145
  v_cvt_pk_bf16_f32 v45, v146, v147
  v_cvt_pk_bf16_f32 v46, v148, v149
  v_cvt_pk_bf16_f32 v47, v150, v151
  v_exp_f32 v168, v168
  v_exp_f32 v169, v169
  v_exp_f32 v170, v170
  v_mfma_f32_32x32x16_bf16 v[88:103], v[24:27], v[64:67], v[88:103]
  v_exp_f32 v171, v171
  v_exp_f32 v172, v172
  v_exp_f32 v173, v173
  v_exp_f32 v174, v174
  v_exp_f32 v175, v175
  v_exp_f32 v176, v176
  v_mfma_f32_32x32x16_bf16 v[88:103], v[28:31], v[68:71], v[88:103]
  v_exp_f32 v177, v177
  v_exp_f32 v178, v178
  v_exp_f32 v179, v179
  v_exp_f32 v180, v180
  v_exp_f32 v181, v181
  v_exp_f32 v182, v182
  v_exp_f32 v183, v183
  v_cvt_pk_bf16_f32 v56, v168, v169
  v_cvt_pk_bf16_f32 v57, v170, v171
  v_cvt_pk_bf16_f32 v58, v172, v173
  v_cvt_pk_bf16_f32 v59, v174, v175
  v_cvt_pk_bf16_f32 v60, v176, v177
  v_cvt_pk_bf16_f32 v61, v178, v179
  v_cvt_pk_bf16_f32 v62, v180, v181
  v_cvt_pk_bf16_f32 v63, v182, v183
  s_waitcnt lgkmcnt(2)
  v_mfma_f32_32x32x16_bf16 v[136:151], v[8:11], v[32:35], v[104:119]
  v_exp_f32 v152, v152
  v_exp_f32 v153, v153
  v_exp_f32 v154, v154
  v_exp_f32 v155, v155
  v_exp_f32 v156, v156
  v_mfma_f32_32x32x16_bf16 v[168:183], v[8:11], v[36:39], v[120:135]
  s_add_u32 s46, s19, 1
  v_mov_b32 v219, s46
  ds_write_b32 v216, v219
  ds_read_b32 v218, v217
  ds_read_b128 v[12:15], v2 offset:18432
  s_mov_b64 exec, s[24:25]
  ds_read_b128 v[24:27], v2 offset:15360
  ds_read_b128 v[28:31], v2 offset:15616
  s_mov_b64 exec, -1
  v_exp_f32 v157, v157
  v_exp_f32 v158, v158
  v_exp_f32 v159, v159
  v_exp_f32 v160, v160
  v_exp_f32 v161, v161
  v_exp_f32 v162, v162
  s_waitcnt lgkmcnt(3)
  v_mfma_f32_32x32x16_bf16 v[72:87], v[16:19], v[40:43], v[72:87]
  v_exp_f32 v163, v163
  v_exp_f32 v164, v164
  v_exp_f32 v165, v165
  v_exp_f32 v166, v166
  v_exp_f32 v167, v167
  v_cvt_pk_bf16_f32 v48, v152, v153
  v_mfma_f32_32x32x16_bf16 v[72:87], v[20:23], v[44:47], v[72:87]
  v_cvt_pk_bf16_f32 v49, v154, v155
  v_cvt_pk_bf16_f32 v50, v156, v157
  v_cvt_pk_bf16_f32 v51, v158, v159
  v_cvt_pk_bf16_f32 v52, v160, v161
  v_cvt_pk_bf16_f32 v53, v162, v163
  v_cvt_pk_bf16_f32 v54, v164, v165
  v_cvt_pk_bf16_f32 v55, v166, v167
  v_exp_f32 v184, v184
  v_exp_f32 v185, v185
  v_exp_f32 v186, v186
  v_mfma_f32_32x32x16_bf16 v[88:103], v[16:19], v[56:59], v[88:103]
  v_exp_f32 v187, v187
  v_exp_f32 v188, v188
  v_exp_f32 v189, v189
  v_exp_f32 v190, v190
  v_exp_f32 v191, v191
  v_exp_f32 v192, v192
  v_mfma_f32_32x32x16_bf16 v[88:103], v[20:23], v[60:63], v[88:103]
  v_exp_f32 v193, v193
  v_exp_f32 v194, v194
  v_exp_f32 v195, v195
  v_exp_f32 v196, v196
  v_exp_f32 v197, v197
  v_exp_f32 v198, v198
  v_exp_f32 v199, v199
  v_cvt_pk_bf16_f32 v64, v184, v185
  v_cvt_pk_bf16_f32 v65, v186, v187
  v_cvt_pk_bf16_f32 v66, v188, v189
  v_cvt_pk_bf16_f32 v67, v190, v191
  v_cvt_pk_bf16_f32 v68, v192, v193
  v_cvt_pk_bf16_f32 v69, v194, v195
  v_cvt_pk_bf16_f32 v70, v196, v197
  v_cvt_pk_bf16_f32 v71, v198, v199
  v_cmp_ngt_f32 vcc, s20, v80
  v_cmp_ngt_f32 s[26:27], s20, v96
  v_add_u32 v2, 16384, v2
  s_add_u32 s19, s19, 1
  s_or_b64 vcc, vcc, s[26:27]
  s_cbranch_vccnz attn_rare1
attn_rare_ret1:
  s_cmp_lt_u32 s19, 8
  s_cbranch_scc1 attn_loop1
attn_tail:
  s_setprio 0
  s_waitcnt lgkmcnt(0)
  v_mfma_f32_32x32x16_bf16 v[72:87], v[24:27], v[48:51], v[72:87]
  v_mfma_f32_32x32x16_bf16 v[72:87], v[28:31], v[52:55], v[72:87]
  v_mfma_f32_32x32x16_bf16 v[88:103], v[24:27], v[64:67], v[88:103]
  v_mfma_f32_32x32x16_bf16 v[88:103], v[28:31], v[68:71], v[88:103]
  s_nop 15
  v_mov_b32 v5, 0x207
  s_mov_b64 s[26:27], 0
  v_cmp_class_f32 vcc, v72, v5
  s_or_b64 s[26:27], s[26:27], vcc
  v_cmp_class_f32 vcc, v73, v5
  s_or_b64 s[26:27], s[26:27], vcc
  v_cmp_class_f32 vcc, v74, v5
  s_or_b64 s[26:27], s[26:27], vcc
  v_cmp_class_f32 vcc, v75, v5
  s_or_b64 s[26:27], s[26:27], vcc
  v_cmp_class_f32 vcc, v76, v5
  s_or_b64 s[26:27], s[26:27], vcc
  v_cmp_class_f32 vcc, v77, v5
  s_or_b64 s[26:27], s[26:27], vcc
  v_cmp_class_f32 vcc, v78, v5
  s_or_b64 s[26:27], s[26:27], vcc
  v_cmp_class_f32 vcc, v79, v5
  s_or_b64 s[26:27], s[26:27], vcc
  v_cmp_class_f32 vcc, v80, v5
  s_or_b64 s[26:27], s[26:27], vcc
  v_cmp_class_f32 vcc, v88, v5
  s_or_b64 s[26:27], s[26:27], vcc
  v_cmp_class_f32 vcc, v89, v5
  s_or_b64 s[26:27], s[26:27], vcc
  v_cmp_class_f32 vcc, v90, v5
  s_or_b64 s[26:27], s[26:27], vcc
  v_cmp_class_f32 vcc, v91, v5
  s_or_b64 s[26:27], s[26:27], vcc
  v_cmp_class_f32 vcc, v92, v5
  s_or_b64 s[26:27], s[26:27], vcc
  v_cmp_class_f32 vcc, v93, v5
  s_or_b64 s[26:27], s[26:27], vcc
  v_cmp_class_f32 vcc, v94, v5
  s_or_b64 s[26:27], s[26:27], vcc
  v_cmp_class_f32 vcc, v95, v5
  s_or_b64 s[26:27], s[26:27], vcc
  v_cmp_class_f32 vcc, v96, v5
  s_or_b64 s[26:27], s[26:27], vcc
  s_cmp_lg_u64 s[26:27], 0
  s_cselect_b32 s17, 1, 0
  s_or_b32 s22, s22, s17
  s_cmp_lg_u32 s22, 0
  s_cbranch_scc1 attn_fallback
attn_epilogue:
  s_lshl_b32 s17, s14, 6
  s_add_u32 s17, s17, s16
  s_lshl_b32 s17, s17, 5
  s_add_u32 s17, s17, s15
  s_lshl_b32 s17, s17, 10
  s_add_u32 s17, s17, 12582912
  v_lshlrev_b32 v5, 4, v1
  v_rcp_f32 v4, v80
  s_nop 0
  v_mul_f32 v72, v72, v4
  v_mul_f32 v73, v73, v4
  v_mul_f32 v74, v74, v4
  v_mul_f32 v75, v75, v4
  v_mul_f32 v76, v76, v4
  v_mul_f32 v77, v77, v4
  v_mul_f32 v78, v78, v4
  v_mul_f32 v79, v79, v4
  v_cvt_pk_bf16_f32 v40, v72, v73
  v_cvt_pk_bf16_f32 v41, v74, v75
  v_cvt_pk_bf16_f32 v42, v76, v77
  v_cvt_pk_bf16_f32 v43, v78, v79
  buffer_store_dwordx4 v[40:43], v5, s[8:11], s17 offen sc0 sc1
  s_add_u32 s17, s17, 32768
  v_rcp_f32 v4, v96
  s_nop 0
  v_mul_f32 v88, v88, v4
  v_mul_f32 v89, v89, v4
  v_mul_f32 v90, v90, v4
  v_mul_f32 v91, v91, v4
  v_mul_f32 v92, v92, v4
  v_mul_f32 v93, v93, v4
  v_mul_f32 v94, v94, v4
  v_mul_f32 v95, v95, v4
  v_cvt_pk_bf16_f32 v56, v88, v89
  v_cvt_pk_bf16_f32 v57, v90, v91
  v_cvt_pk_bf16_f32 v58, v92, v93
  v_cvt_pk_bf16_f32 v59, v94, v95
  buffer_store_dwordx4 v[56:59], v5, s[8:11], s17 offen sc0 sc1
  s_cmp_ge_u32 s12, 4
  s_cbranch_scc1 attn_nogate
  s_waitcnt vmcnt(2)
  v_mov_b32 v4, 0
  v_mov_b32 v6, 0
  v_dot2_f32_bf16 v4, v204, v212, v4
  v_dot2_f32_bf16 v6, v208, v212, v6
  v_dot2_f32_bf16 v4, v205, v213, v4
  v_dot2_f32_bf16 v6, v209, v213, v6
  v_dot2_f32_bf16 v4, v206, v214, v4
  v_dot2_f32_bf16 v6, v210, v214, v6
  v_dot2_f32_bf16 v4, v207, v215, v4
  v_dot2_f32_bf16 v6, v211, v215, v6
  s_nop 2
  ds_swizzle_b32 v5, v4 offset:0x41f
  ds_swizzle_b32 v7, v6 offset:0x41f
  s_waitcnt lgkmcnt(0)
  v_add_f32 v4, v4, v5
  v_add_f32 v6, v6, v7
  ds_swizzle_b32 v5, v4 offset:0x81f
  ds_swizzle_b32 v7, v6 offset:0x81f
  s_waitcnt lgkmcnt(0)
  v_add_f32 v4, v4, v5
  v_add_f32 v6, v6, v7
  ds_swizzle_b32 v5, v4 offset:0x101f
  ds_swizzle_b32 v7, v6 offset:0x101f
  s_waitcnt lgkmcnt(0)
  v_add_f32 v4, v4, v5
  v_add_f32 v6, v6, v7
  ds_swizzle_b32 v5, v4 offset:0x201f
  ds_swizzle_b32 v7, v6 offset:0x201f
  s_waitcnt lgkmcnt(0)
  v_add_f32 v4, v4, v5
  v_add_f32 v6, v6, v7
  ds_swizzle_b32 v5, v4 offset:0x401f
  ds_swizzle_b32 v7, v6 offset:0x401f
  s_waitcnt lgkmcnt(0)
  v_add_f32 v4, v4, v5
  v_add_f32 v6, v6, v7
  s_nop 1
  v_permlane32_swap_b32 v4, v6
  v_add_f32 v4, v4, v6
  v_cvt_pk_bf16_f32 v4, v4, v4
  v_lshlrev_b32 v4, 16, v4
  v_mul_f32 v4, 0xbfb8aa3b, v4
  v_exp_f32 v4, v4
  s_nop 0
  v_add_f32 v4, 1.0, v4
  v_rcp_f32 v4, v4
  s_nop 0
  v_cvt_pk_bf16_f32 v4, v4, v4
  v_lshlrev_b32 v4, 16, v4
  s_lshl_b32 s23, s23, 2
  s_add_u32 s23, s23, 16777216
  v_lshrrev_b32 v5, 5, v1
  v_lshlrev_b32 v5, 2, v5
  s_mov_b32 exec_lo, 1
  s_mov_b32 exec_hi, 1
  buffer_store_dword v4, v5, s[8:11], s23 offen sc0 sc1
  s_mov_b64 exec, -1
attn_nogate:
attn_done:
  s_endpgm
attn_rare0:
  s_mov_b32 s18, 0
  s_branch attn_rare
attn_rare1:
  s_mov_b32 s18, 1
attn_rare:
  v_cmp_ngt_f32 vcc, s21, v80
  v_cmp_ngt_f32 s[26:27], s21, v96
  s_or_b64 vcc, vcc, s[26:27]
  s_cbranch_vccz attn_rare_ok
  s_mov_b32 s22, 1
  s_branch attn_rare_back
attn_rare_ok:
  v_frexp_exp_i32_f32 v4, v80
  v_add_u32 v4, 40, v4
  v_sub_u32 v5, 0, v4
  v_cvt_f32_i32 v4, v4
  v_ldexp_f32 v72, v72, v5
  v_ldexp_f32 v73, v73, v5
  v_ldexp_f32 v74, v74, v5
  v_ldexp_f32 v75, v75, v5
  v_ldexp_f32 v76, v76, v5
  v_ldexp_f32 v77, v77, v5
  v_ldexp_f32 v78, v78, v5
  v_ldexp_f32 v79, v79, v5
  v_ldexp_f32 v80, v80, v5
  v_lshlrev_b32 v6, 16, v48
  v_and_b32 v7, 0xffff0000, v48
  v_ldexp_f32 v6, v6, v5
  v_ldexp_f32 v7, v7, v5
  v_cvt_pk_bf16_f32 v48, v6, v7
  v_lshlrev_b32 v6, 16, v49
  v_and_b32 v7, 0xffff0000, v49
  v_ldexp_f32 v6, v6, v5
  v_ldexp_f32 v7, v7, v5
  v_cvt_pk_bf16_f32 v49, v6, v7
  v_lshlrev_b32 v6, 16, v50
  v_and_b32 v7, 0xffff0000, v50
  v_ldexp_f32 v6, v6, v5
  v_ldexp_f32 v7, v7, v5
  v_cvt_pk_bf16_f32 v50, v6, v7
  v_lshlrev_b32 v6, 16, v51
  v_and_b32 v7, 0xffff0000, v51
  v_ldexp_f32 v6, v6, v5
  v_ldexp_f32 v7, v7, v5
  v_cvt_pk_bf16_f32 v51, v6, v7
  v_lshlrev_b32 v6, 16, v52
  v_and_b32 v7, 0xffff0000, v52
  v_ldexp_f32 v6, v6, v5
  v_ldexp_f32 v7, v7, v5
  v_cvt_pk_bf16_f32 v52, v6, v7
  v_lshlrev_b32 v6, 16, v53
  v_and_b32 v7, 0xffff0000, v53
  v_ldexp_f32 v6, v6, v5
  v_ldexp_f32 v7, v7, v5
  v_cvt_pk_bf16_f32 v53, v6, v7
  v_lshlrev_b32 v6, 16, v54
  v_and_b32 v7, 0xffff0000, v54
  v_ldexp_f32 v6, v6, v5
  v_ldexp_f32 v7, v7, v5
  v_cvt_pk_bf16_f32 v54, v6, v7
  v_lshlrev_b32 v6, 16, v55
  v_and_b32 v7, 0xffff0000, v55
  v_ldexp_f32 v6, v6, v5
  v_ldexp_f32 v7, v7, v5
  v_cvt_pk_bf16_f32 v55, v6, v7
  v_sub_f32 v136, v136, v4
  v_sub_f32 v137, v137, v4
  v_sub_f32 v138, v138, v4
  v_sub_f32 v139, v139, v4
  v_sub_f32 v140, v140, v4
  v_sub_f32 v141, v141, v4
  v_sub_f32 v142, v142, v4
  v_sub_f32 v143, v143, v4
  v_sub_f32 v144, v144, v4
  v_sub_f32 v145, v145, v4
  v_sub_f32 v146, v146, v4
  v_sub_f32 v147, v147, v4
  v_sub_f32 v148, v148, v4
  v_sub_f32 v149, v149, v4
  v_sub_f32 v150, v150, v4
  v_sub_f32 v151, v151, v4
  v_sub_f32 v104, v104, v4
  v_sub_f32 v105, v105, v4
  v_sub_f32 v106, v106, v4
  v_sub_f32 v107, v107, v4
  v_sub_f32 v108, v108, v4
  v_sub_f32 v109, v109, v4
  v_sub_f32 v110, v110, v4
  v_sub_f32 v111, v111, v4
  v_sub_f32 v112, v112, v4
  v_sub_f32 v113, v113, v4
  v_sub_f32 v114, v114, v4
  v_sub_f32 v115, v115, v4
  v_sub_f32 v116, v116, v4
  v_sub_f32 v117, v117, v4
  v_sub_f32 v118, v118, v4
  v_sub_f32 v119, v119, v4
  v_frexp_exp_i32_f32 v4, v96
  v_add_u32 v4, 40, v4
  v_sub_u32 v5, 0, v4
  v_cvt_f32_i32 v4, v4
  v_ldexp_f32 v88, v88, v5
  v_ldexp_f32 v89, v89, v5
  v_ldexp_f32 v90, v90, v5
  v_ldexp_f32 v91, v91, v5
  v_ldexp_f32 v92, v92, v5
  v_ldexp_f32 v93, v93, v5
  v_ldexp_f32 v94, v94, v5
  v_ldexp_f32 v95, v95, v5
  v_ldexp_f32 v96, v96, v5
  v_lshlrev_b32 v6, 16, v64
  v_and_b32 v7, 0xffff0000, v64
  v_ldexp_f32 v6, v6, v5
  v_ldexp_f32 v7, v7, v5
  v_cvt_pk_bf16_f32 v64, v6, v7
  v_lshlrev_b32 v6, 16, v65
  v_and_b32 v7, 0xffff0000, v65
  v_ldexp_f32 v6, v6, v5
  v_ldexp_f32 v7, v7, v5
  v_cvt_pk_bf16_f32 v65, v6, v7
  v_lshlrev_b32 v6, 16, v66
  v_and_b32 v7, 0xffff0000, v66
  v_ldexp_f32 v6, v6, v5
  v_ldexp_f32 v7, v7, v5
  v_cvt_pk_bf16_f32 v66, v6, v7
  v_lshlrev_b32 v6, 16, v67
  v_and_b32 v7, 0xffff0000, v67
  v_ldexp_f32 v6, v6, v5
  v_ldexp_f32 v7, v7, v5
  v_cvt_pk_bf16_f32 v67, v6, v7
  v_lshlrev_b32 v6, 16, v68
  v_and_b32 v7, 0xffff0000, v68
  v_ldexp_f32 v6, v6, v5
  v_ldexp_f32 v7, v7, v5
  v_cvt_pk_bf16_f32 v68, v6, v7
  v_lshlrev_b32 v6, 16, v69
  v_and_b32 v7, 0xffff0000, v69
  v_ldexp_f32 v6, v6, v5
  v_ldexp_f32 v7, v7, v5
  v_cvt_pk_bf16_f32 v69, v6, v7
  v_lshlrev_b32 v6, 16, v70
  v_and_b32 v7, 0xffff0000, v70
  v_ldexp_f32 v6, v6, v5
  v_ldexp_f32 v7, v7, v5
  v_cvt_pk_bf16_f32 v70, v6, v7
  v_lshlrev_b32 v6, 16, v71
  v_and_b32 v7, 0xffff0000, v71
  v_ldexp_f32 v6, v6, v5
  v_ldexp_f32 v7, v7, v5
  v_cvt_pk_bf16_f32 v71, v6, v7
  v_sub_f32 v168, v168, v4
  v_sub_f32 v169, v169, v4
  v_sub_f32 v170, v170, v4
  v_sub_f32 v171, v171, v4
  v_sub_f32 v172, v172, v4
  v_sub_f32 v173, v173, v4
  v_sub_f32 v174, v174, v4
  v_sub_f32 v175, v175, v4
  v_sub_f32 v176, v176, v4
  v_sub_f32 v177, v177, v4
  v_sub_f32 v178, v178, v4
  v_sub_f32 v179, v179, v4
  v_sub_f32 v180, v180, v4
  v_sub_f32 v181, v181, v4
  v_sub_f32 v182, v182, v4
  v_sub_f32 v183, v183, v4
  v_sub_f32 v120, v120, v4
  v_sub_f32 v121, v121, v4
  v_sub_f32 v122, v122, v4
  v_sub_f32 v123, v123, v4
  v_sub_f32 v124, v124, v4
  v_sub_f32 v125, v125, v4
  v_sub_f32 v126, v126, v4
  v_sub_f32 v127, v127, v4
  v_sub_f32 v128, v128, v4
  v_sub_f32 v129, v129, v4
  v_sub_f32 v130, v130, v4
  v_sub_f32 v131, v131, v4
  v_sub_f32 v132, v132, v4
  v_sub_f32 v133, v133, v4
  v_sub_f32 v134, v134, v4
  v_sub_f32 v135, v135, v4
attn_rare_back:
  s_cmp_eq_u32 s18, 0
  s_cbranch_scc1 attn_rare_ret0
  s_branch attn_rare_ret1
attn_fallback:
  v_lshlrev_b32 v2, 4, v1
  v_mov_b32 v72, 0
  v_mov_b32 v73, 0
  v_mov_b32 v74, 0
  v_mov_b32 v75, 0
  v_mov_b32 v76, 0
  v_mov_b32 v77, 0
  v_mov_b32 v78, 0
  v_mov_b32 v79, 0
  v_mov_b32 v80, 0
  v_mov_b32 v81, 0
  v_mov_b32 v82, 0
  v_mov_b32 v83, 0
  v_mov_b32 v84, 0
  v_mov_b32 v85, 0
  v_mov_b32 v86, 0
  v_mov_b32 v87, 0
  v_mov_b32 v3, 0xff7fffff
  s_mov_b32 s19, 0
attn_fb_loop0:
  ds_read_b128 v[8:11], v2 offset:0
  s_mov_b64 exec, s[24:25]
  ds_read_b128 v[16:19], v2 offset:1024
  ds_read_b128 v[20:23], v2 offset:1280
  s_mov_b64 exec, -1
  s_waitcnt lgkmcnt(0)
  v_mfma_f32_32x32x16_bf16 v[136:151], v[8:11], v[32:35], 0
  s_nop 15
  s_nop 3
  v_max3_f32 v4, v136, v137, v138
  v_max3_f32 v4, v4, v139, v140
  v_max3_f32 v4, v4, v141, v142
  v_max3_f32 v4, v4, v143, v144
  v_max3_f32 v4, v4, v145, v146
  v_max3_f32 v4, v4, v147, v148
  v_max3_f32 v4, v4, v149, v150
  v_max_f32 v4, v4, v151
  v_mov_b32 v5, v4
  s_nop 1
  v_permlane32_swap_b32 v4, v5
  v_max_f32 v4, v4, v5
  v_max_f32 v4, v4, v3
  v_sub_f32 v5, v3, v4
  v_exp_f32 v5, v5
  v_mov_b32 v3, v4
  v_sub_f32 v136, v136, v4
  v_sub_f32 v137, v137, v4
  v_sub_f32 v138, v138, v4
  v_sub_f32 v139, v139, v4
  v_sub_f32 v140, v140, v4
  v_sub_f32 v141, v141, v4
  v_sub_f32 v142, v142, v4
  v_sub_f32 v143, v143, v4
  v_sub_f32 v144, v144, v4
  v_sub_f32 v145, v145, v4
  v_sub_f32 v146, v146, v4
  v_sub_f32 v147, v147, v4
  v_sub_f32 v148, v148, v4
  v_sub_f32 v149, v149, v4
  v_sub_f32 v150, v150, v4
  v_sub_f32 v151, v151, v4
  v_exp_f32 v136, v136
  v_exp_f32 v137, v137
  v_exp_f32 v138, v138
  v_exp_f32 v139, v139
  v_exp_f32 v140, v140
  v_exp_f32 v141, v141
  v_exp_f32 v142, v142
  v_exp_f32 v143, v143
  v_exp_f32 v144, v144
  v_exp_f32 v145, v145
  v_exp_f32 v146, v146
  v_exp_f32 v147, v147
  v_exp_f32 v148, v148
  v_exp_f32 v149, v149
  v_exp_f32 v150, v150
  v_exp_f32 v151, v151
  v_mul_f32 v72, v72, v5
  v_mul_f32 v73, v73, v5
  v_mul_f32 v74, v74, v5
  v_mul_f32 v75, v75, v5
  v_mul_f32 v76, v76, v5
  v_mul_f32 v77, v77, v5
  v_mul_f32 v78, v78, v5
  v_mul_f32 v79, v79, v5
  v_mul_f32 v80, v80, v5
  v_cvt_pk_bf16_f32 v40, v136, v137
  v_cvt_pk_bf16_f32 v41, v138, v139
  v_cvt_pk_bf16_f32 v42, v140, v141
  v_cvt_pk_bf16_f32 v43, v142, v143
  v_cvt_pk_bf16_f32 v44, v144, v145
  v_cvt_pk_bf16_f32 v45, v146, v147
  v_cvt_pk_bf16_f32 v46, v148, v149
  v_cvt_pk_bf16_f32 v47, v150, v151
  s_nop 1
  v_mfma_f32_32x32x16_bf16 v[72:87], v[16:19], v[40:43], v[72:87]
  v_mfma_f32_32x32x16_bf16 v[72:87], v[20:23], v[44:47], v[72:87]
  v_add_u32 v2, 2048, v2
  s_nop 15
  s_nop 3
  s_add_u32 s19, s19, 1
  s_cmp_lt_u32 s19, 64
  s_cbranch_scc1 attn_fb_loop0
  v_lshlrev_b32 v2, 4, v1
  v_mov_b32 v88, 0
  v_mov_b32 v89, 0
  v_mov_b32 v90, 0
  v_mov_b32 v91, 0
  v_mov_b32 v92, 0
  v_mov_b32 v93, 0
  v_mov_b32 v94, 0
  v_mov_b32 v95, 0
  v_mov_b32 v96, 0
  v_mov_b32 v97, 0
  v_mov_b32 v98, 0
  v_mov_b32 v99, 0
  v_mov_b32 v100, 0
  v_mov_b32 v101, 0
  v_mov_b32 v102, 0
  v_mov_b32 v103, 0
  v_mov_b32 v3, 0xff7fffff
  s_mov_b32 s19, 0
attn_fb_loop1:
  ds_read_b128 v[8:11], v2 offset:0
  s_mov_b64 exec, s[24:25]
  ds_read_b128 v[16:19], v2 offset:1024
  ds_read_b128 v[20:23], v2 offset:1280
  s_mov_b64 exec, -1
  s_waitcnt lgkmcnt(0)
  v_mfma_f32_32x32x16_bf16 v[168:183], v[8:11], v[36:39], 0
  s_nop 15
  s_nop 3
  v_max3_f32 v4, v168, v169, v170
  v_max3_f32 v4, v4, v171, v172
  v_max3_f32 v4, v4, v173, v174
  v_max3_f32 v4, v4, v175, v176
  v_max3_f32 v4, v4, v177, v178
  v_max3_f32 v4, v4, v179, v180
  v_max3_f32 v4, v4, v181, v182
  v_max_f32 v4, v4, v183
  v_mov_b32 v5, v4
  s_nop 1
  v_permlane32_swap_b32 v4, v5
  v_max_f32 v4, v4, v5
  v_max_f32 v4, v4, v3
  v_sub_f32 v5, v3, v4
  v_exp_f32 v5, v5
  v_mov_b32 v3, v4
  v_sub_f32 v168, v168, v4
  v_sub_f32 v169, v169, v4
  v_sub_f32 v170, v170, v4
  v_sub_f32 v171, v171, v4
  v_sub_f32 v172, v172, v4
  v_sub_f32 v173, v173, v4
  v_sub_f32 v174, v174, v4
  v_sub_f32 v175, v175, v4
  v_sub_f32 v176, v176, v4
  v_sub_f32 v177, v177, v4
  v_sub_f32 v178, v178, v4
  v_sub_f32 v179, v179, v4
  v_sub_f32 v180, v180, v4
  v_sub_f32 v181, v181, v4
  v_sub_f32 v182, v182, v4
  v_sub_f32 v183, v183, v4
  v_exp_f32 v168, v168
  v_exp_f32 v169, v169
  v_exp_f32 v170, v170
  v_exp_f32 v171, v171
  v_exp_f32 v172, v172
  v_exp_f32 v173, v173
  v_exp_f32 v174, v174
  v_exp_f32 v175, v175
  v_exp_f32 v176, v176
  v_exp_f32 v177, v177
  v_exp_f32 v178, v178
  v_exp_f32 v179, v179
  v_exp_f32 v180, v180
  v_exp_f32 v181, v181
  v_exp_f32 v182, v182
  v_exp_f32 v183, v183
  v_mul_f32 v88, v88, v5
  v_mul_f32 v89, v89, v5
  v_mul_f32 v90, v90, v5
  v_mul_f32 v91, v91, v5
  v_mul_f32 v92, v92, v5
  v_mul_f32 v93, v93, v5
  v_mul_f32 v94, v94, v5
  v_mul_f32 v95, v95, v5
  v_mul_f32 v96, v96, v5
  v_cvt_pk_bf16_f32 v56, v168, v169
  v_cvt_pk_bf16_f32 v57, v170, v171
  v_cvt_pk_bf16_f32 v58, v172, v173
  v_cvt_pk_bf16_f32 v59, v174, v175
  v_cvt_pk_bf16_f32 v60, v176, v177
  v_cvt_pk_bf16_f32 v61, v178, v179
  v_cvt_pk_bf16_f32 v62, v180, v181
  v_cvt_pk_bf16_f32 v63, v182, v183
  s_nop 1
  v_mfma_f32_32x32x16_bf16 v[88:103], v[16:19], v[56:59], v[88:103]
  v_mfma_f32_32x32x16_bf16 v[88:103], v[20:23], v[60:63], v[88:103]
  v_add_u32 v2, 2048, v2
  s_nop 15
  s_nop 3
  s_add_u32 s19, s19, 1
  s_cmp_lt_u32 s19, 64
  s_cbranch_scc1 attn_fb_loop1
  s_branch attn_epilogue
.globl outp_kernel
.p2align 8
.type outp_kernel,@function
outp_kernel:
  s_cmp_ge_u32 s2, 256
  s_cbranch_scc1 outp_done
  s_load_dwordx2 s[4:5], s[0:1], 32
  s_load_dwordx2 s[6:7], s[0:1], 56
  s_load_dwordx2 s[8:9], s[0:1], 72
  s_load_dwordx2 s[10:11], s[0:1], 88
  v_and_b32 v1, 63, v0
  v_lshrrev_b32 v7, 6, v0
  s_nop 0
  v_readfirstlane_b32 s28, v7
  s_and_b32 s34, s2, 7
  s_lshl_b32 s34, s34, 2
  s_bfe_u32 s35, s2, 0x20003
  s_add_u32 s30, s34, s35
  s_lshr_b32 s29, s2, 5
  s_lshr_b32 s31, s28, 2
  s_bfe_u32 s32, s28, 0x10001
  s_and_b32 s33, s28, 1
  s_lshl_b32 s36, s30, 1
  s_add_u32 s36, s36, s32
  s_lshl_b32 s40, s31, 1
  s_add_u32 s40, s40, s33
  v_lshrrev_b32 v7, 3, v1
  v_and_b32 v8, 7, v1
  v_bfe_u32 v9, v1, 4, 1
  v_lshlrev_b32 v9, 2, v9
  v_xor_b32 v8, v8, v9
  v_lshlrev_b32 v8, 4, v8
  v_lshl_add_u32 v2, v7, 10, v8
  v_lshlrev_b32 v6, 4, v1
  s_waitcnt lgkmcnt(0)
  s_cmp_eq_u32 s31, 0
  s_cselect_b32 s34, s4, s6
  s_cselect_b32 s35, s5, s7
  s_mov_b32 s12, s34
  s_and_b32 s13, s35, 0xffff
  s_mov_b32 s14, 524288
  s_mov_b32 s15, 0x00020000
  s_mov_b32 s20, s8
  s_and_b32 s21, s9, 0xffff
  s_mov_b32 s22, 2097152
  s_mov_b32 s23, 0x00020000
  s_mov_b32 s24, s10
  s_and_b32 s25, s11, 0xffff
  s_mov_b32 s26, 268435456
  s_mov_b32 s27, 0x00020000
  s_and_b32 s34, s28, 3
  s_lshl_b32 s37, s34, 15
  s_lshl_b32 s35, s29, 7
  s_add_u32 s37, s37, s35
  s_lshl_b32 s38, s34, 12
  s_lshl_b32 s35, s31, 16
  s_add_u32 s38, s38, s35
  s_lshl_b32 s39, s31, 6
  s_add_u32 s39, s39, s36
  s_lshl_b32 s39, s39, 15
  s_lshl_b32 s35, s33, 14
  s_add_u32 s39, s39, s35
  s_add_u32 s39, s39, 12582912
  s_add_u32 m0, s38, 0
  s_add_u32 s34, s37, 0
  buffer_load_dwordx4 v2, s[12:15], s34 offen lds
  s_add_u32 m0, s38, 1024
  s_add_u32 s34, s37, 8192
  buffer_load_dwordx4 v2, s[12:15], s34 offen lds
  s_add_u32 m0, s38, 2048
  s_add_u32 s34, s37, 16384
  buffer_load_dwordx4 v2, s[12:15], s34 offen lds
  s_add_u32 m0, s38, 3072
  s_add_u32 s34, s37, 24576
  buffer_load_dwordx4 v2, s[12:15], s34 offen lds
  s_add_u32 m0, s38, 32768
  s_add_u32 s34, s37, 262144
  buffer_load_dwordx4 v2, s[12:15], s34 offen lds
  s_add_u32 m0, s38, 33792
  s_add_u32 s34, s37, 270336
  buffer_load_dwordx4 v2, s[12:15], s34 offen lds
  s_add_u32 m0, s38, 34816
  s_add_u32 s34, s37, 278528
  buffer_load_dwordx4 v2, s[12:15], s34 offen lds
  s_add_u32 m0, s38, 35840
  s_add_u32 s34, s37, 286720
  buffer_load_dwordx4 v2, s[12:15], s34 offen lds
  buffer_load_dwordx4 v[108:111], v6, s[24:27], s39 offen offset:0
  buffer_load_dwordx4 v[112:115], v6, s[24:27], s39 offen offset:1024
  buffer_load_dwordx4 v[116:119], v6, s[24:27], s39 offen offset:2048
  buffer_load_dwordx4 v[120:123], v6, s[24:27], s39 offen offset:3072
  s_add_u32 s39, s39, 4096
  buffer_load_dwordx4 v[124:127], v6, s[24:27], s39 offen offset:0
  buffer_load_dwordx4 v[128:131], v6, s[24:27], s39 offen offset:1024
  buffer_load_dwordx4 v[132:135], v6, s[24:27], s39 offen offset:2048
  buffer_load_dwordx4 v[136:139], v6, s[24:27], s39 offen offset:3072
  s_add_u32 s39, s39, 4096
  v_lshrrev_b32 v7, 4, v1
  v_and_b32 v8, 1, v7
  v_lshrrev_b32 v7, 1, v7
  v_bfe_u32 v9, v1, 2, 2
  v_lshl_add_u32 v7, v7, 3, v9
  v_lshlrev_b32 v7, 7, v7
  v_and_b32 v10, 3, v1
  v_lshl_add_u32 v8, v8, 2, v10
  v_and_b32 v10, 1, v8
  v_lshrrev_b32 v8, 1, v8
  v_lshl_add_u32 v8, v10, 2, v8
  v_and_b32 v10, 1, v8
  v_lshl_add_u32 v7, v10, 3, v7
  v_lshrrev_b32 v8, 1, v8
  v_lshrrev_b32 v9, 1, v9
  v_lshlrev_b32 v9, 2, v9
  v_xor_b32 v8, v8, v9
  v_lshl_add_u32 v3, v8, 4, v7
  v_xor_b32 v4, 64, v3
  s_lshl_b32 s34, s31, 16
  s_lshl_b32 s35, s33, 15
  s_add_u32 s34, s34, s35
  v_add_u32 v3, s34, v3
  v_add_u32 v4, s34, v4
  s_waitcnt vmcnt(8)
  s_barrier
  ds_read_b64_tr_b16 v[12:13], v3 offset:0
  ds_read_b64_tr_b16 v[14:15], v3 offset:512
  ds_read_b64_tr_b16 v[16:17], v4 offset:0
  ds_read_b64_tr_b16 v[18:19], v4 offset:512
  ds_read_b64_tr_b16 v[20:21], v3 offset:2048
  ds_read_b64_tr_b16 v[22:23], v3 offset:2560
  ds_read_b64_tr_b16 v[24:25], v4 offset:2048
  ds_read_b64_tr_b16 v[26:27], v4 offset:2560
  ds_read_b64_tr_b16 v[28:29], v3 offset:4096
  ds_read_b64_tr_b16 v[30:31], v3 offset:4608
  ds_read_b64_tr_b16 v[32:33], v4 offset:4096
  ds_read_b64_tr_b16 v[34:35], v4 offset:4608
  ds_read_b64_tr_b16 v[36:37], v3 offset:6144
  ds_read_b64_tr_b16 v[38:39], v3 offset:6656
  ds_read_b64_tr_b16 v[40:41], v4 offset:6144
  ds_read_b64_tr_b16 v[42:43], v4 offset:6656
  ds_read_b64_tr_b16 v[44:45], v3 offset:8192
  ds_read_b64_tr_b16 v[46:47], v3 offset:8704
  ds_read_b64_tr_b16 v[48:49], v4 offset:8192
  ds_read_b64_tr_b16 v[50:51], v4 offset:8704
  s_add_u32 m0, s38, 16384
  s_add_u32 s34, s37, 131072
  buffer_load_dwordx4 v2, s[12:15], s34 offen lds
  s_add_u32 m0, s38, 17408
  s_add_u32 s34, s37, 139264
  buffer_load_dwordx4 v2, s[12:15], s34 offen lds
  s_waitcnt vmcnt(9) lgkmcnt(15)
  v_mfma_f32_32x32x16_bf16 v[76:91], v[12:15], v[108:111], 0
  v_mfma_f32_32x32x16_bf16 v[92:107], v[16:19], v[108:111], 0
  ds_read_b64_tr_b16 v[52:53], v3 offset:10240
  ds_read_b64_tr_b16 v[54:55], v3 offset:10752
  ds_read_b64_tr_b16 v[56:57], v4 offset:10240
  ds_read_b64_tr_b16 v[58:59], v4 offset:10752
  s_add_u32 m0, s38, 18432
  s_add_u32 s34, s37, 147456
  buffer_load_dwordx4 v2, s[12:15], s34 offen lds
  s_add_u32 m0, s38, 19456
  s_add_u32 s34, s37, 155648
  buffer_load_dwordx4 v2, s[12:15], s34 offen lds
  s_waitcnt vmcnt(10) lgkmcnt(15)
  v_mfma_f32_32x32x16_bf16 v[76:91], v[20:23], v[112:115], v[76:91]
  v_mfma_f32_32x32x16_bf16 v[92:107], v[24:27], v[112:115], v[92:107]
  ds_read_b64_tr_b16 v[60:61], v3 offset:12288
  ds_read_b64_tr_b16 v[62:63], v3 offset:12800
  ds_read_b64_tr_b16 v[64:65], v4 offset:12288
  ds_read_b64_tr_b16 v[66:67], v4 offset:12800
  s_add_u32 m0, s38, 49152
  s_add_u32 s34, s37, 393216
  buffer_load_dwordx4 v2, s[12:15], s34 offen lds
  s_add_u32 m0, s38, 50176
  s_add_u32 s34, s37, 401408
  buffer_load_dwordx4 v2, s[12:15], s34 offen lds
  s_waitcnt vmcnt(11) lgkmcnt(15)
  v_mfma_f32_32x32x16_bf16 v[76:91], v[28:31], v[116:119], v[76:91]
  v_mfma_f32_32x32x16_bf16 v[92:107], v[32:35], v[116:119], v[92:107]
  ds_read_b64_tr_b16 v[68:69], v3 offset:14336
  ds_read_b64_tr_b16 v[70:71], v3 offset:14848
  ds_read_b64_tr_b16 v[72:73], v4 offset:14336
  ds_read_b64_tr_b16 v[74:75], v4 offset:14848
  s_add_u32 m0, s38, 51200
  s_add_u32 s34, s37, 409600
  buffer_load_dwordx4 v2, s[12:15], s34 offen lds
  s_add_u32 m0, s38, 52224
  s_add_u32 s34, s37, 417792
  buffer_load_dwordx4 v2, s[12:15], s34 offen lds
  s_waitcnt vmcnt(12) lgkmcnt(15)
  v_mfma_f32_32x32x16_bf16 v[76:91], v[36:39], v[120:123], v[76:91]
  v_mfma_f32_32x32x16_bf16 v[92:107], v[40:43], v[120:123], v[92:107]
  buffer_load_dwordx4 v[140:143], v6, s[24:27], s39 offen offset:0
  buffer_load_dwordx4 v[144:147], v6, s[24:27], s39 offen offset:1024
  s_waitcnt vmcnt(13) lgkmcnt(12)
  v_mfma_f32_32x32x16_bf16 v[76:91], v[44:47], v[124:127], v[76:91]
  v_mfma_f32_32x32x16_bf16 v[92:107], v[48:51], v[124:127], v[92:107]
  buffer_load_dwordx4 v[148:151], v6, s[24:27], s39 offen offset:2048
  buffer_load_dwordx4 v[152:155], v6, s[24:27], s39 offen offset:3072
  s_add_u32 s39, s39, 4096
  s_waitcnt vmcnt(14) lgkmcnt(8)
  v_mfma_f32_32x32x16_bf16 v[76:91], v[52:55], v[128:131], v[76:91]
  v_mfma_f32_32x32x16_bf16 v[92:107], v[56:59], v[128:131], v[92:107]
  buffer_load_dwordx4 v[156:159], v6, s[24:27], s39 offen offset:0
  buffer_load_dwordx4 v[160:163], v6, s[24:27], s39 offen offset:1024
  s_waitcnt vmcnt(15) lgkmcnt(4)
  v_mfma_f32_32x32x16_bf16 v[76:91], v[60:63], v[132:135], v[76:91]
  v_mfma_f32_32x32x16_bf16 v[92:107], v[64:67], v[132:135], v[92:107]
  buffer_load_dwordx4 v[164:167], v6, s[24:27], s39 offen offset:2048
  buffer_load_dwordx4 v[168:171], v6, s[24:27], s39 offen offset:3072
  s_add_u32 s39, s39, 4096
  s_waitcnt vmcnt(16) lgkmcnt(0)
  v_mfma_f32_32x32x16_bf16 v[76:91], v[68:71], v[136:139], v[76:91]
  v_mfma_f32_32x32x16_bf16 v[92:107], v[72:75], v[136:139], v[92:107]
  v_and_b32 v7, 31, v1
  v_lshlrev_b32 v7, 2, v7
  s_lshl_b32 s34, s36, 7
  s_add_u32 s34, s34, 16777216
  buffer_load_dword v5, v7, s[24:27], s34 offen
  s_waitcnt vmcnt(9)
  s_barrier
  ds_read_b64_tr_b16 v[12:13], v3 offset:16384
  ds_read_b64_tr_b16 v[14:15], v3 offset:16896
  ds_read_b64_tr_b16 v[16:17], v4 offset:16384
  ds_read_b64_tr_b16 v[18:19], v4 offset:16896
  ds_read_b64_tr_b16 v[20:21], v3 offset:18432
  ds_read_b64_tr_b16 v[22:23], v3 offset:18944
  ds_read_b64_tr_b16 v[24:25], v4 offset:18432
  ds_read_b64_tr_b16 v[26:27], v4 offset:18944
  ds_read_b64_tr_b16 v[28:29], v3 offset:20480
  ds_read_b64_tr_b16 v[30:31], v3 offset:20992
  ds_read_b64_tr_b16 v[32:33], v4 offset:20480
  ds_read_b64_tr_b16 v[34:35], v4 offset:20992
  ds_read_b64_tr_b16 v[36:37], v3 offset:22528
  ds_read_b64_tr_b16 v[38:39], v3 offset:23040
  ds_read_b64_tr_b16 v[40:41], v4 offset:22528
  ds_read_b64_tr_b16 v[42:43], v4 offset:23040
  ds_read_b64_tr_b16 v[44:45], v3 offset:24576
  ds_read_b64_tr_b16 v[46:47], v3 offset:25088
  ds_read_b64_tr_b16 v[48:49], v4 offset:24576
  ds_read_b64_tr_b16 v[50:51], v4 offset:25088
  s_waitcnt vmcnt(8) lgkmcnt(15)
  v_mfma_f32_32x32x16_bf16 v[76:91], v[12:15], v[140:143], v[76:91]
  v_mfma_f32_32x32x16_bf16 v[92:107], v[16:19], v[140:143], v[92:107]
  ds_read_b64_tr_b16 v[52:53], v3 offset:26624
  ds_read_b64_tr_b16 v[54:55], v3 offset:27136
  ds_read_b64_tr_b16 v[56:57], v4 offset:26624
  ds_read_b64_tr_b16 v[58:59], v4 offset:27136
  s_waitcnt vmcnt(7) lgkmcnt(15)
  v_mfma_f32_32x32x16_bf16 v[76:91], v[20:23], v[144:147], v[76:91]
  v_mfma_f32_32x32x16_bf16 v[92:107], v[24:27], v[144:147], v[92:107]
  ds_read_b64_tr_b16 v[60:61], v3 offset:28672
  ds_read_b64_tr_b16 v[62:63], v3 offset:29184
  ds_read_b64_tr_b16 v[64:65], v4 offset:28672
  ds_read_b64_tr_b16 v[66:67], v4 offset:29184
  s_waitcnt vmcnt(6) lgkmcnt(15)
  v_mfma_f32_32x32x16_bf16 v[76:91], v[28:31], v[148:151], v[76:91]
  v_mfma_f32_32x32x16_bf16 v[92:107], v[32:35], v[148:151], v[92:107]
  ds_read_b64_tr_b16 v[68:69], v3 offset:30720
  ds_read_b64_tr_b16 v[70:71], v3 offset:31232
  ds_read_b64_tr_b16 v[72:73], v4 offset:30720
  ds_read_b64_tr_b16 v[74:75], v4 offset:31232
  s_waitcnt vmcnt(5) lgkmcnt(15)
  v_mfma_f32_32x32x16_bf16 v[76:91], v[36:39], v[152:155], v[76:91]
  v_mfma_f32_32x32x16_bf16 v[92:107], v[40:43], v[152:155], v[92:107]
  s_waitcnt vmcnt(4) lgkmcnt(12)
  v_mfma_f32_32x32x16_bf16 v[76:91], v[44:47], v[156:159], v[76:91]
  v_mfma_f32_32x32x16_bf16 v[92:107], v[48:51], v[156:159], v[92:107]
  s_waitcnt vmcnt(3) lgkmcnt(8)
  v_mfma_f32_32x32x16_bf16 v[76:91], v[52:55], v[160:163], v[76:91]
  v_mfma_f32_32x32x16_bf16 v[92:107], v[56:59], v[160:163], v[92:107]
  s_waitcnt vmcnt(2) lgkmcnt(4)
  v_mfma_f32_32x32x16_bf16 v[76:91], v[60:63], v[164:167], v[76:91]
  v_mfma_f32_32x32x16_bf16 v[92:107], v[64:67], v[164:167], v[92:107]
  s_waitcnt vmcnt(1) lgkmcnt(0)
  v_mfma_f32_32x32x16_bf16 v[76:91], v[68:71], v[168:171], v[76:91]
  v_mfma_f32_32x32x16_bf16 v[92:107], v[72:75], v[168:171], v[92:107]
  s_barrier
  s_lshl_b32 s34, s28, 13
  v_add_u32 v7, s34, v6
  s_nop 8
  ds_write_b128 v7, v[76:79] offset:0
  ds_write_b128 v7, v[80:83] offset:1024
  ds_write_b128 v7, v[84:87] offset:2048
  ds_write_b128 v7, v[88:91] offset:3072
  ds_write_b128 v7, v[92:95] offset:4096
  ds_write_b128 v7, v[96:99] offset:5120
  ds_write_b128 v7, v[100:103] offset:6144
  ds_write_b128 v7, v[104:107] offset:7168
  s_lshl_b32 s34, s32, 14
  s_lshl_b32 s35, s40, 11
  s_add_u32 s34, s34, s35
  v_add_u32 v7, s34, v6
  s_waitcnt vmcnt(0) lgkmcnt(0)
  s_barrier
  ds_read_b128 v[12:15], v7 offset:0
  ds_read_b128 v[16:19], v7 offset:1024
  ds_read_b128 v[20:23], v7 offset:8192
  ds_read_b128 v[24:27], v7 offset:9216
  ds_read_b128 v[28:31], v7 offset:32768
  ds_read_b128 v[32:35], v7 offset:33792
  ds_read_b128 v[36:39], v7 offset:40960
  ds_read_b128 v[40:43], v7 offset:41984
  v_sub_f32 v8, 1.0, v5
  v_cvt_pk_bf16_f32 v8, v8, v8
  v_lshlrev_b32 v8, 16, v8
  s_mov_b32 s35, 0xffff0000
  v_and_b32 v7, 31, v1
  v_lshlrev_b32 v7, 10, v7
  v_lshrrev_b32 v9, 5, v1
  v_lshl_add_u32 v7, v9, 5, v7
  s_lshl_b32 s34, s36, 15
  s_lshl_b32 s37, s29, 7
  s_add_u32 s34, s34, s37
  s_lshl_b32 s37, s31, 6
  s_add_u32 s34, s34, s37
  s_lshl_b32 s37, s33, 4
  s_add_u32 s34, s34, s37
  s_waitcnt lgkmcnt(0)
  v_add_f32 v12, v12, v20
  v_add_f32 v28, v28, v36
  v_add_f32 v13, v13, v21
  v_add_f32 v29, v29, v37
  v_add_f32 v14, v14, v22
  v_add_f32 v30, v30, v38
  v_add_f32 v15, v15, v23
  v_add_f32 v31, v31, v39
  v_add_f32 v16, v16, v24
  v_add_f32 v32, v32, v40
  v_add_f32 v17, v17, v25
  v_add_f32 v33, v33, v41
  v_add_f32 v18, v18, v26
  v_add_f32 v34, v34, v42
  v_add_f32 v19, v19, v27
  v_add_f32 v35, v35, v43
  v_cvt_pk_bf16_f32 v9, v12, v13
  v_lshlrev_b32 v12, 16, v9
  v_and_b32 v13, s35, v9
  v_mul_f32 v12, v5, v12
  v_mul_f32 v13, v5, v13
  v_cvt_pk_bf16_f32 v9, v12, v13
  v_lshlrev_b32 v12, 16, v9
  v_and_b32 v13, s35, v9
  v_cvt_pk_bf16_f32 v10, v28, v29
  v_lshlrev_b32 v28, 16, v10
  v_and_b32 v29, s35, v10
  v_mul_f32 v28, v8, v28
  v_mul_f32 v29, v8, v29
  v_cvt_pk_bf16_f32 v10, v28, v29
  v_lshlrev_b32 v28, 16, v10
  v_and_b32 v29, s35, v10
  v_add_f32 v12, v12, v28
  v_add_f32 v13, v13, v29
  v_cvt_pk_bf16_f32 v108, v12, v13
  v_cvt_pk_bf16_f32 v9, v14, v15
  v_lshlrev_b32 v14, 16, v9
  v_and_b32 v15, s35, v9
  v_mul_f32 v14, v5, v14
  v_mul_f32 v15, v5, v15
  v_cvt_pk_bf16_f32 v9, v14, v15
  v_lshlrev_b32 v14, 16, v9
  v_and_b32 v15, s35, v9
  v_cvt_pk_bf16_f32 v10, v30, v31
  v_lshlrev_b32 v30, 16, v10
  v_and_b32 v31, s35, v10
  v_mul_f32 v30, v8, v30
  v_mul_f32 v31, v8, v31
  v_cvt_pk_bf16_f32 v10, v30, v31
  v_lshlrev_b32 v30, 16, v10
  v_and_b32 v31, s35, v10
  v_add_f32 v14, v14, v30
  v_add_f32 v15, v15, v31
  v_cvt_pk_bf16_f32 v109, v14, v15
  v_cvt_pk_bf16_f32 v9, v16, v17
  v_lshlrev_b32 v16, 16, v9
  v_and_b32 v17, s35, v9
  v_mul_f32 v16, v5, v16
  v_mul_f32 v17, v5, v17
  v_cvt_pk_bf16_f32 v9, v16, v17
  v_lshlrev_b32 v16, 16, v9
  v_and_b32 v17, s35, v9
  v_cvt_pk_bf16_f32 v10, v32, v33
  v_lshlrev_b32 v32, 16, v10
  v_and_b32 v33, s35, v10
  v_mul_f32 v32, v8, v32
  v_mul_f32 v33, v8, v33
  v_cvt_pk_bf16_f32 v10, v32, v33
  v_lshlrev_b32 v32, 16, v10
  v_and_b32 v33, s35, v10
  v_add_f32 v16, v16, v32
  v_add_f32 v17, v17, v33
  v_cvt_pk_bf16_f32 v110, v16, v17
  v_cvt_pk_bf16_f32 v9, v18, v19
  v_lshlrev_b32 v18, 16, v9
  v_and_b32 v19, s35, v9
  v_mul_f32 v18, v5, v18
  v_mul_f32 v19, v5, v19
  v_cvt_pk_bf16_f32 v9, v18, v19
  v_lshlrev_b32 v18, 16, v9
  v_and_b32 v19, s35, v9
  v_cvt_pk_bf16_f32 v10, v34, v35
  v_lshlrev_b32 v34, 16, v10
  v_and_b32 v35, s35, v10
  v_mul_f32 v34, v8, v34
  v_mul_f32 v35, v8, v35
  v_cvt_pk_bf16_f32 v10, v34, v35
  v_lshlrev_b32 v34, 16, v10
  v_and_b32 v35, s35, v10
  v_add_f32 v18, v18, v34
  v_add_f32 v19, v19, v35
  v_cvt_pk_bf16_f32 v111, v18, v19
  buffer_store_dwordx4 v[108:111], v7, s[20:23], s34 offen
outp_done:
  s_endpgm
.section .rodata,"a"
.p2align 6
.amdhsa_kernel proj_kernel
  .amdhsa_next_free_vgpr 204
  .amdhsa_next_free_sgpr 64
  .amdhsa_accum_offset 204
  .amdhsa_group_segment_fixed_size 0
  .amdhsa_kernarg_size 96
  .amdhsa_user_sgpr_count 2
  .amdhsa_user_sgpr_kernarg_segment_ptr 1
  .amdhsa_system_sgpr_workgroup_id_x 1
.end_amdhsa_kernel
.p2align 6
.amdhsa_kernel attn_kernel
  .amdhsa_next_free_vgpr 220
  .amdhsa_next_free_sgpr 64
  .amdhsa_accum_offset 220
  .amdhsa_group_segment_fixed_size 0
  .amdhsa_kernarg_size 96
  .amdhsa_user_sgpr_count 2
  .amdhsa_user_sgpr_kernarg_segment_ptr 1
  .amdhsa_system_sgpr_workgroup_id_x 1
.end_amdhsa_kernel
.p2align 6
.amdhsa_kernel outp_kernel
  .amdhsa_next_free_vgpr 172
  .amdhsa_next_free_sgpr 48
  .amdhsa_accum_offset 172
  .amdhsa_group_segment_fixed_size 0
  .amdhsa_kernarg_size 96
  .amdhsa_user_sgpr_count 2
  .amdhsa_user_sgpr_kernarg_segment_ptr 1
  .amdhsa_system_sgpr_workgroup_id_x 1
.end_amdhsa_kernel
```
